```python
import torch

def _softmax(x, axis=-1):
    return torch.softmax(x, dim=axis)
def _gelu(x):
    return torch.nn.functional.gelu(x, approximate="tanh")
def _silu(x):
    return torch.nn.functional.silu(x)
def _sigmoid(x):
    return torch.sigmoid(x)
def _layernorm(x, axis=-1, eps=1e-5):
    m = x.mean(dim=axis, keepdim=True)
    v = x.var(dim=axis, keepdim=True, unbiased=False)
    return (x - m) / torch.sqrt(v + eps)
def _scatter_add(tgt, idx, src, axis=0):
    return tgt.clone().index_add_(axis, idx, src)
def _segment_sum(src, seg, n):
    out = torch.zeros((n,) + src.shape[1:], dtype=src.dtype)
    return out.index_add_(0, seg, src)
def _pad(x, pw):
    flat = tuple(v for pair in reversed(pw) for v in pair)
    return torch.nn.functional.pad(x, flat)

kernel_name = 'standalone__sliding_block_cached__sampling'

def setup_inputs():

    _w = (lambda a: (lambda t: t.to(torch.bfloat16) if t.is_floating_point() else t)(torch.as_tensor(a)))
    B, Sq, D = 8, 4, 640
    Hq, Hkv, Sk, Dh = 32, 32, 4096, 192
    assert Hq % Hkv == 0, (Hq, Hkv)
    return {
        "x": _w((lambda *s: torch.randn(*s, dtype=torch.bfloat16) * 0.8)(B, Sq, D)),
        "k_cache": _w((lambda *s: torch.randn(*s, dtype=torch.bfloat16) * 0.8)(B, Hkv, Sk, Dh)),
        "v_cache": _w((lambda *s: torch.randn(*s, dtype=torch.bfloat16) * 0.05)(B, Hkv, Sk, Dh)),
        "wq": _w((lambda *s: torch.randn(*s, dtype=torch.bfloat16) * 0.8)(D, Hq * Dh) * (D ** -0.5)),
        "wo": _w((lambda *s: torch.randn(*s, dtype=torch.bfloat16) * 0.05)(Hq * Dh, D) * ((Hq * Dh) ** -0.5)),
    }

def reference(x, k_cache, v_cache, wq, wo):
    B, Sq, D = x.shape
    Hq, Dh = 32, 192
    Hkv, Sk = k_cache.shape[1], k_cache.shape[2]
    W = min(4096, max(256, Sk // 4))
    rep = Hq // Hkv
    q = (lambda x, *d: x.permute(*d))((x @ wq).reshape(B, Sq, Hq, Dh), 0, 2, 1, 3)
    k = (lambda x, n, axis: torch.repeat_interleave(x, n, dim=axis))(k_cache[:, :, Sk - W:, :], rep, axis=1)
    v = (lambda x, n, axis: torch.repeat_interleave(x, n, dim=axis))(v_cache[:, :, Sk - W:, :], rep, axis=1)
    scores = torch.einsum("bhqd,bhkd->bhqk", q, k) * (Dh ** -0.5)
    p = _softmax(scores, axis=-1)
    o = torch.einsum("bhqk,bhkd->bhqd", p, v)
    return (lambda x, *d: x.permute(*d))(o, 0, 2, 1, 3).reshape(B, Sq, Hq * Dh) @ wo
```

```asm
; @launch grid=(256,1,1) block=(256,1,1) lds=160512
.amdgcn_target "amdgcn-amd-amdhsa--gfx950"
.text
.globl standalone__sliding_block_cached__sampling_kernel
.p2align 8
.type standalone__sliding_block_cached__sampling_kernel,@function
standalone__sliding_block_cached__sampling_kernel:
    s_cmp_ge_u32 s2, 256
    s_cbranch_scc1 L_end
    s_load_dwordx16 s[4:19], s[0:1], 0
    v_lshrrev_b32 v40, 6, v0
    v_and_b32 v1, 63, v0
    v_readfirstlane_b32 s52, v40
    s_and_b32 s53, s2, 31
    s_lshr_b32 s54, s2, 5
    s_bfe_u32 s72, s2, 0x20003
    v_lshrrev_b32 v40, 3, v1
    v_lshrrev_b32 v41, 3, v1
    v_and_b32 v41, 6, v41
    v_xor_b32 v41, v41, v1
    v_and_b32 v41, 7, v41
    v_mul_u32_u24 v40, 12288, v40
    v_lshl_add_u32 v4, v41, 4, v40
    v_add_u32 v3, 896, v4
    v_add_u32 v2, 1792, v4
    v_lshlrev_b32 v44, 4, v1
    v_mul_u32_u24 v45, 2731, v1
    v_bfe_u32 v40, v45, 17, 3
    v_lshlrev_b32 v40, 4, v40
    v_xor_b32 v5, v44, v40
    v_add_u32 v45, 174784, v45
    v_bfe_u32 v40, v45, 17, 3
    v_lshlrev_b32 v40, 4, v40
    v_xor_b32 v6, v44, v40
    v_add_u32 v45, 174784, v45
    v_bfe_u32 v40, v45, 17, 3
    v_lshlrev_b32 v40, 4, v40
    v_xor_b32 v7, v44, v40
    s_mul_i32 s55, s52, 36864
    s_lshr_b32 s58, s2, 7
    s_add_u32 s58, s58, s54
    s_mul_i32 s73, s52, 10
    s_add_u32 s73, s73, s58
    s_mul_i32 s74, s73, 196608
    s_mul_i32 s58, s53, 384
    s_mul_i32 s59, s2, 1572864
    s_add_u32 s59, s59, 1179648
    s_mul_i32 s57, s53, 4
    s_mul_i32 s61, s54, 1
    s_add_u32 s57, s57, s61
    s_add_u32 s57, s57, s52
    s_and_b32 s57, s57, 63
    s_mul_i32 s57, s57, 6144
    s_waitcnt lgkmcnt(0)
    s_lshr_b32 s61, 3, s72
    s_bitcmp1_b32 s61, 0
    s_cbranch_scc0 L_firstK
    s_sub_u32 s28, s10, 1792
    s_subb_u32 s29, s11, 0
    s_add_u32 s28, s28, s58
    s_addc_u32 s29, s29, 0
    s_sub_u32 s30, 7866112, s58
    s_mov_b32 s31, 0x20000
    s_add_u32 m0, s55, 0
    s_nop 0
    buffer_load_dwordx4 v2, s[28:31], s74 offen offset:0 lds
    buffer_load_dwordx4 v3, s[28:31], s74 offen offset:1024 lds
    buffer_load_dwordx4 v4, s[28:31], s74 offen offset:2048 lds
    s_add_u32 m0, s55, 3072
    s_add_u32 s75, s74, 98304
    buffer_load_dwordx4 v2, s[28:31], s75 offen offset:0 lds
    buffer_load_dwordx4 v3, s[28:31], s75 offen offset:1024 lds
    v_add_u32 v45, 174784, v45
    v_bfe_u32 v40, v45, 17, 3
    v_lshlrev_b32 v40, 4, v40
    v_xor_b32 v8, v44, v40
    v_add_u32 v45, 174784, v45
    v_bfe_u32 v40, v45, 17, 3
    v_lshlrev_b32 v40, 4, v40
    v_xor_b32 v9, v44, v40
    v_add_u32 v45, 174784, v45
    v_bfe_u32 v40, v45, 17, 3
    v_lshlrev_b32 v40, 4, v40
    v_xor_b32 v10, v44, v40
    buffer_load_dwordx4 v4, s[28:31], s75 offen offset:2048 lds
    s_add_u32 s74, s74, 196608
    s_cmp_eq_u32 s74, 7864320
    s_cselect_b32 s74, 0, s74
    s_branch L_first
L_firstK:
    s_add_u32 s20, s6, s59
    s_addc_u32 s21, s7, 0
    s_mov_b32 s22, 393216
    s_mov_b32 s23, 0x20000
    s_add_u32 m0, s55, 0
    s_nop 0
    buffer_load_dwordx4 v5, s[20:23], s57 offen offset:0 nt lds
    buffer_load_dwordx4 v6, s[20:23], s57 offen offset:1024 nt lds
    buffer_load_dwordx4 v7, s[20:23], s57 offen offset:2048 nt lds
    v_add_u32 v45, 174784, v45
    v_bfe_u32 v40, v45, 17, 3
    v_lshlrev_b32 v40, 4, v40
    v_xor_b32 v8, v44, v40
    v_add_u32 v45, 174784, v45
    v_bfe_u32 v40, v45, 17, 3
    v_lshlrev_b32 v40, 4, v40
    v_xor_b32 v9, v44, v40
    v_add_u32 v45, 174784, v45
    v_bfe_u32 v40, v45, 17, 3
    v_lshlrev_b32 v40, 4, v40
    v_xor_b32 v10, v44, v40
    s_add_u32 m0, s55, 3072
    s_add_u32 s0, s57, 3072
    buffer_load_dwordx4 v8, s[20:23], s0 offen offset:0 nt lds
    buffer_load_dwordx4 v9, s[20:23], s0 offen offset:1024 nt lds
    buffer_load_dwordx4 v10, s[20:23], s0 offen offset:2048 nt lds
    s_add_u32 s57, s57, 24576
    s_sub_u32 s0, s57, 393216
    s_min_u32 s57, s57, s0
L_first:
    s_sub_u32 s28, s10, 1792
    s_subb_u32 s29, s11, 0
    s_add_u32 s28, s28, s58
    s_addc_u32 s29, s29, 0
    s_sub_u32 s30, 7866112, s58
    s_mov_b32 s31, 0x20000
    s_add_u32 s20, s6, s59
    s_addc_u32 s21, s7, 0
    s_mov_b32 s22, 393216
    s_mov_b32 s23, 0x20000
    s_lshl_b32 s73, s73, 1
    s_mul_i32 s3, s52, 3136
    s_add_u32 s3, s3, 147456
    s_mul_i32 s56, s54, 5120
    s_add_u32 s36, s4, s56
    s_addc_u32 s37, s5, 0
    s_sub_u32 s38, 40960, s56
    s_mov_b32 s39, 0x20000
    s_add_u32 s24, s8, s59
    s_addc_u32 s25, s9, 0
    s_mov_b32 s26, 393216
    s_mov_b32 s27, 0x20000
    v_add_u32 v41, 0, v1
    v_mul_u32_u24 v40, 3277, v41
    v_lshrrev_b32 v40, 16, v40
    v_mul_u32_u24 v42, 20, v40
    v_sub_u32 v41, v41, v42
    v_add_u32 v41, s73, v41
    v_subrev_u32 v42, 80, v41
    v_min_u32 v41, v41, v42
    v_mul_u32_u24 v40, 1280, v40
    v_lshl_add_u32 v27, v41, 4, v40
    v_add_u32 v41, 64, v1
    v_mul_u32_u24 v40, 3277, v41
    v_lshrrev_b32 v40, 16, v40
    v_mul_u32_u24 v42, 20, v40
    v_sub_u32 v41, v41, v42
    v_add_u32 v41, s73, v41
    v_subrev_u32 v42, 80, v41
    v_min_u32 v41, v41, v42
    v_mul_u32_u24 v40, 1280, v40
    v_lshl_add_u32 v252, v41, 4, v40
    s_mov_b32 m0, s3
    s_nop 0
    buffer_load_dwordx4 v27, s[36:39], 0 offen lds
    s_add_u32 m0, s3, 1024
    s_mov_b64 exec, 0xffff
    buffer_load_dwordx4 v252, s[36:39], 0 offen lds
    s_mov_b64 exec, -1
    s_cmp_eq_u32 s72, 2
    s_cbranch_scc1 L_G1
    s_cmp_eq_u32 s72, 3
    s_cbranch_scc1 L_G2
L_G0:
    s_add_u32 m0, s55, 6144
    s_nop 0
    buffer_load_dwordx4 v2, s[28:31], s74 offen offset:0 lds
    buffer_load_dwordx4 v3, s[28:31], s74 offen offset:1024 lds
    buffer_load_dwordx4 v4, s[28:31], s74 offen offset:2048 lds
    s_add_u32 m0, s55, 9216
    s_add_u32 s75, s74, 98304
    buffer_load_dwordx4 v2, s[28:31], s75 offen offset:0 lds
    v_lshrrev_b32 v46, 4, v1
    v_and_b32 v41, 3, v1
    v_mul_u32_u24 v40, 320, v41
    v_lshl_add_u32 v40, v46, 3, v40
    v_add_u32 v26, s3, v40
    v_lshl_add_u32 v41, v41, 3, s55
    v_bfe_u32 v40, v1, 2, 3
    v_lshl_add_u32 v41, v40, 7, v41
    v_lshrrev_b32 v40, 5, v1
    v_mul_u32_u24 v40, 3072, v40
    v_add_u32 v41, v40, v41
    v_bfe_u32 v42, v1, 3, 2
    v_xor_b32 v43, 0, v42
    v_lshl_add_u32 v252, v43, 5, v41
    v_xor_b32 v43, 1, v42
    v_lshl_add_u32 v253, v43, 5, v41
    v_xor_b32 v43, 2, v42
    v_lshl_add_u32 v254, v43, 5, v41
    v_xor_b32 v43, 3, v42
    v_lshl_add_u32 v255, v43, 5, v41
    s_waitcnt vmcnt(11)
    buffer_load_dwordx4 v3, s[28:31], s75 offen offset:1024 lds
    s_waitcnt vmcnt(11)
    buffer_load_dwordx4 v4, s[28:31], s75 offen offset:2048 lds
    s_add_u32 s74, s74, 196608
    s_cmp_eq_u32 s74, 7864320
    s_cselect_b32 s74, 0, s74
    s_add_u32 m0, s55, 12288
    s_waitcnt vmcnt(11)
    buffer_load_dwordx4 v2, s[28:31], s74 offen offset:0 lds
    s_waitcnt vmcnt(11)
    buffer_load_dwordx4 v3, s[28:31], s74 offen offset:1024 lds
    s_waitcnt vmcnt(11)
    buffer_load_dwordx4 v4, s[28:31], s74 offen offset:2048 lds
    s_add_u32 m0, s55, 15360
    s_add_u32 s75, s74, 98304
    s_waitcnt vmcnt(11)
    buffer_load_dwordx4 v2, s[28:31], s75 offen offset:0 lds
    ds_read_b64_tr_b16 v[140:141], v252 offset:0
    ds_read_b64_tr_b16 v[144:145], v253 offset:0
    ds_read_b64_tr_b16 v[148:149], v254 offset:0
    ds_read_b64_tr_b16 v[152:153], v255 offset:0
    ds_read_b64_tr_b16 v[156:157], v252 offset:1024
    ds_read_b64_tr_b16 v[160:161], v253 offset:1024
    ds_read_b64_tr_b16 v[164:165], v254 offset:1024
    ds_read_b64_tr_b16 v[168:169], v255 offset:1024
    ds_read_b64_tr_b16 v[172:173], v252 offset:2048
    ds_read_b64_tr_b16 v[176:177], v253 offset:2048
    ds_read_b64_tr_b16 v[180:181], v254 offset:2048
    ds_read_b64_tr_b16 v[184:185], v255 offset:2048
    s_waitcnt vmcnt(11)
    buffer_load_dwordx4 v3, s[28:31], s75 offen offset:1024 lds
    s_waitcnt vmcnt(11)
    buffer_load_dwordx4 v4, s[28:31], s75 offen offset:2048 lds
    s_add_u32 s74, s74, 196608
    s_cmp_eq_u32 s74, 7864320
    s_cselect_b32 s74, 0, s74
    s_add_u32 m0, s55, 18432
    s_waitcnt vmcnt(11)
    buffer_load_dwordx4 v2, s[28:31], s74 offen offset:0 lds
    s_waitcnt vmcnt(11)
    buffer_load_dwordx4 v3, s[28:31], s74 offen offset:1024 lds
    s_waitcnt vmcnt(11)
    buffer_load_dwordx4 v4, s[28:31], s74 offen offset:2048 lds
    s_add_u32 m0, s55, 21504
    s_add_u32 s75, s74, 98304
    s_waitcnt vmcnt(11)
    buffer_load_dwordx4 v2, s[28:31], s75 offen offset:0 lds
    s_waitcnt vmcnt(11)
    buffer_load_dwordx4 v3, s[28:31], s75 offen offset:1024 lds
    s_waitcnt vmcnt(11)
    buffer_load_dwordx4 v4, s[28:31], s75 offen offset:2048 lds
    s_add_u32 s74, s74, 196608
    s_cmp_eq_u32 s74, 7864320
    s_cselect_b32 s74, 0, s74
    ds_read_b64 v[48:49], v26 offset:0
    ds_read_b64 v[50:51], v26 offset:32
    ds_read_b64 v[52:53], v26 offset:64
    ds_read_b64 v[54:55], v26 offset:96
    ds_read_b64 v[56:57], v26 offset:128
    ds_read_b64 v[58:59], v26 offset:160
    ds_read_b64 v[60:61], v26 offset:192
    ds_read_b64 v[62:63], v26 offset:224
    ds_read_b64 v[64:65], v26 offset:256
    ds_read_b64 v[66:67], v26 offset:288
    ds_read_b64_tr_b16 v[142:143], v252 offset:6144
    ds_read_b64_tr_b16 v[146:147], v253 offset:6144
    ds_read_b64_tr_b16 v[150:151], v254 offset:6144
    ds_read_b64_tr_b16 v[154:155], v255 offset:6144
    ds_read_b64_tr_b16 v[158:159], v252 offset:7168
    ds_read_b64_tr_b16 v[162:163], v253 offset:7168
    ds_read_b64_tr_b16 v[166:167], v254 offset:7168
    ds_read_b64_tr_b16 v[170:171], v255 offset:7168
    ds_read_b64_tr_b16 v[174:175], v252 offset:8192
    ds_read_b64_tr_b16 v[178:179], v253 offset:8192
    ds_read_b64_tr_b16 v[182:183], v254 offset:8192
    ds_read_b64_tr_b16 v[186:187], v255 offset:8192
    s_waitcnt lgkmcnt(0)
    v_mfma_f32_16x16x32_bf16 v[92:95], v[140:143], v[48:51], 0
    v_mfma_f32_16x16x32_bf16 v[96:99], v[144:147], v[48:51], 0
    s_add_u32 m0, s55, 24576
    s_waitcnt vmcnt(11)
    buffer_load_dwordx4 v2, s[28:31], s74 offen offset:0 lds
    v_mfma_f32_16x16x32_bf16 v[100:103], v[148:151], v[48:51], 0
    v_mfma_f32_16x16x32_bf16 v[104:107], v[152:155], v[48:51], 0
    s_waitcnt vmcnt(11)
    buffer_load_dwordx4 v3, s[28:31], s74 offen offset:1024 lds
    v_mfma_f32_16x16x32_bf16 v[108:111], v[156:159], v[48:51], 0
    v_mfma_f32_16x16x32_bf16 v[112:115], v[160:163], v[48:51], 0
    s_waitcnt vmcnt(11)
    buffer_load_dwordx4 v4, s[28:31], s74 offen offset:2048 lds
    v_mfma_f32_16x16x32_bf16 v[116:119], v[164:167], v[48:51], 0
    v_mfma_f32_16x16x32_bf16 v[120:123], v[168:171], v[48:51], 0
    s_add_u32 m0, s55, 27648
    s_add_u32 s75, s74, 98304
    s_waitcnt vmcnt(11)
    buffer_load_dwordx4 v2, s[28:31], s75 offen offset:0 lds
    v_mfma_f32_16x16x32_bf16 v[124:127], v[172:175], v[48:51], 0
    v_mfma_f32_16x16x32_bf16 v[128:131], v[176:179], v[48:51], 0
    s_waitcnt vmcnt(11)
    buffer_load_dwordx4 v3, s[28:31], s75 offen offset:1024 lds
    v_mfma_f32_16x16x32_bf16 v[132:135], v[180:183], v[48:51], 0
    v_mfma_f32_16x16x32_bf16 v[136:139], v[184:187], v[48:51], 0
    s_waitcnt vmcnt(11)
    buffer_load_dwordx4 v4, s[28:31], s75 offen offset:2048 lds
    s_add_u32 s74, s74, 196608
    s_cmp_eq_u32 s74, 7864320
    s_cselect_b32 s74, 0, s74
    ds_read_b64_tr_b16 v[140:141], v252 offset:12288
    ds_read_b64_tr_b16 v[144:145], v253 offset:12288
    ds_read_b64_tr_b16 v[148:149], v254 offset:12288
    ds_read_b64_tr_b16 v[152:153], v255 offset:12288
    ds_read_b64_tr_b16 v[156:157], v252 offset:13312
    ds_read_b64_tr_b16 v[160:161], v253 offset:13312
    ds_read_b64_tr_b16 v[164:165], v254 offset:13312
    ds_read_b64_tr_b16 v[168:169], v255 offset:13312
    ds_read_b64_tr_b16 v[172:173], v252 offset:14336
    ds_read_b64_tr_b16 v[176:177], v253 offset:14336
    ds_read_b64_tr_b16 v[180:181], v254 offset:14336
    ds_read_b64_tr_b16 v[184:185], v255 offset:14336
    s_add_u32 m0, s55, 30720
    s_waitcnt vmcnt(11)
    buffer_load_dwordx4 v2, s[28:31], s74 offen offset:0 lds
    s_waitcnt vmcnt(11)
    buffer_load_dwordx4 v3, s[28:31], s74 offen offset:1024 lds
    s_waitcnt vmcnt(11)
    buffer_load_dwordx4 v4, s[28:31], s74 offen offset:2048 lds
    s_add_u32 m0, s55, 33792
    s_add_u32 s75, s74, 98304
    s_waitcnt vmcnt(11)
    buffer_load_dwordx4 v2, s[28:31], s75 offen offset:0 lds
    s_waitcnt vmcnt(11)
    buffer_load_dwordx4 v3, s[28:31], s75 offen offset:1024 lds
    s_waitcnt vmcnt(11)
    buffer_load_dwordx4 v4, s[28:31], s75 offen offset:2048 lds
    s_add_u32 s74, s74, 196608
    s_cmp_eq_u32 s74, 7864320
    s_cselect_b32 s74, 0, s74
    ds_read_b64_tr_b16 v[142:143], v252 offset:18432
    ds_read_b64_tr_b16 v[146:147], v253 offset:18432
    ds_read_b64_tr_b16 v[150:151], v254 offset:18432
    ds_read_b64_tr_b16 v[154:155], v255 offset:18432
    ds_read_b64_tr_b16 v[158:159], v252 offset:19456
    ds_read_b64_tr_b16 v[162:163], v253 offset:19456
    ds_read_b64_tr_b16 v[166:167], v254 offset:19456
    ds_read_b64_tr_b16 v[170:171], v255 offset:19456
    ds_read_b64_tr_b16 v[174:175], v252 offset:20480
    ds_read_b64_tr_b16 v[178:179], v253 offset:20480
    ds_read_b64_tr_b16 v[182:183], v254 offset:20480
    ds_read_b64_tr_b16 v[186:187], v255 offset:20480
    s_waitcnt lgkmcnt(0)
    v_mfma_f32_16x16x32_bf16 v[92:95], v[140:143], v[52:55], v[92:95]
    v_mfma_f32_16x16x32_bf16 v[96:99], v[144:147], v[52:55], v[96:99]
    s_add_u32 m0, s55, 0
    s_waitcnt vmcnt(11)
    buffer_load_dwordx4 v2, s[28:31], s74 offen offset:0 lds
    v_mfma_f32_16x16x32_bf16 v[100:103], v[148:151], v[52:55], v[100:103]
    v_mfma_f32_16x16x32_bf16 v[104:107], v[152:155], v[52:55], v[104:107]
    s_waitcnt vmcnt(11)
    buffer_load_dwordx4 v3, s[28:31], s74 offen offset:1024 lds
    v_mfma_f32_16x16x32_bf16 v[108:111], v[156:159], v[52:55], v[108:111]
    v_mfma_f32_16x16x32_bf16 v[112:115], v[160:163], v[52:55], v[112:115]
    s_waitcnt vmcnt(11)
    buffer_load_dwordx4 v4, s[28:31], s74 offen offset:2048 lds
    v_mfma_f32_16x16x32_bf16 v[116:119], v[164:167], v[52:55], v[116:119]
    v_mfma_f32_16x16x32_bf16 v[120:123], v[168:171], v[52:55], v[120:123]
    s_add_u32 m0, s55, 3072
    s_add_u32 s75, s74, 98304
    s_waitcnt vmcnt(11)
    buffer_load_dwordx4 v2, s[28:31], s75 offen offset:0 lds
    v_mfma_f32_16x16x32_bf16 v[124:127], v[172:175], v[52:55], v[124:127]
    v_mfma_f32_16x16x32_bf16 v[128:131], v[176:179], v[52:55], v[128:131]
    s_waitcnt vmcnt(11)
    buffer_load_dwordx4 v3, s[28:31], s75 offen offset:1024 lds
    v_mfma_f32_16x16x32_bf16 v[132:135], v[180:183], v[52:55], v[132:135]
    v_mfma_f32_16x16x32_bf16 v[136:139], v[184:187], v[52:55], v[136:139]
    s_waitcnt vmcnt(11)
    buffer_load_dwordx4 v4, s[28:31], s75 offen offset:2048 lds
    s_add_u32 s74, s74, 196608
    s_cmp_eq_u32 s74, 7864320
    s_cselect_b32 s74, 0, s74
    ds_read_b64_tr_b16 v[140:141], v252 offset:24576
    ds_read_b64_tr_b16 v[144:145], v253 offset:24576
    ds_read_b64_tr_b16 v[148:149], v254 offset:24576
    ds_read_b64_tr_b16 v[152:153], v255 offset:24576
    ds_read_b64_tr_b16 v[156:157], v252 offset:25600
    ds_read_b64_tr_b16 v[160:161], v253 offset:25600
    ds_read_b64_tr_b16 v[164:165], v254 offset:25600
    ds_read_b64_tr_b16 v[168:169], v255 offset:25600
    ds_read_b64_tr_b16 v[172:173], v252 offset:26624
    ds_read_b64_tr_b16 v[176:177], v253 offset:26624
    ds_read_b64_tr_b16 v[180:181], v254 offset:26624
    ds_read_b64_tr_b16 v[184:185], v255 offset:26624
    s_add_u32 m0, s55, 6144
    s_waitcnt vmcnt(11)
    buffer_load_dwordx4 v2, s[28:31], s74 offen offset:0 lds
    s_waitcnt vmcnt(11)
    buffer_load_dwordx4 v3, s[28:31], s74 offen offset:1024 lds
    s_waitcnt vmcnt(11)
    buffer_load_dwordx4 v4, s[28:31], s74 offen offset:2048 lds
    s_add_u32 m0, s55, 9216
    s_add_u32 s75, s74, 98304
    s_waitcnt vmcnt(11)
    buffer_load_dwordx4 v2, s[28:31], s75 offen offset:0 lds
    s_waitcnt vmcnt(11)
    buffer_load_dwordx4 v3, s[28:31], s75 offen offset:1024 lds
    s_waitcnt vmcnt(11)
    buffer_load_dwordx4 v4, s[28:31], s75 offen offset:2048 lds
    s_add_u32 s74, s74, 196608
    s_cmp_eq_u32 s74, 7864320
    s_cselect_b32 s74, 0, s74
    ds_read_b64_tr_b16 v[142:143], v252 offset:30720
    ds_read_b64_tr_b16 v[146:147], v253 offset:30720
    ds_read_b64_tr_b16 v[150:151], v254 offset:30720
    ds_read_b64_tr_b16 v[154:155], v255 offset:30720
    ds_read_b64_tr_b16 v[158:159], v252 offset:31744
    ds_read_b64_tr_b16 v[162:163], v253 offset:31744
    ds_read_b64_tr_b16 v[166:167], v254 offset:31744
    ds_read_b64_tr_b16 v[170:171], v255 offset:31744
    ds_read_b64_tr_b16 v[174:175], v252 offset:32768
    ds_read_b64_tr_b16 v[178:179], v253 offset:32768
    ds_read_b64_tr_b16 v[182:183], v254 offset:32768
    ds_read_b64_tr_b16 v[186:187], v255 offset:32768
    s_waitcnt lgkmcnt(0)
    v_mfma_f32_16x16x32_bf16 v[92:95], v[140:143], v[56:59], v[92:95]
    v_mfma_f32_16x16x32_bf16 v[96:99], v[144:147], v[56:59], v[96:99]
    s_add_u32 m0, s55, 12288
    s_waitcnt vmcnt(11)
    buffer_load_dwordx4 v2, s[28:31], s74 offen offset:0 lds
    v_mfma_f32_16x16x32_bf16 v[100:103], v[148:151], v[56:59], v[100:103]
    v_mfma_f32_16x16x32_bf16 v[104:107], v[152:155], v[56:59], v[104:107]
    s_waitcnt vmcnt(11)
    buffer_load_dwordx4 v3, s[28:31], s74 offen offset:1024 lds
    v_mfma_f32_16x16x32_bf16 v[108:111], v[156:159], v[56:59], v[108:111]
    v_mfma_f32_16x16x32_bf16 v[112:115], v[160:163], v[56:59], v[112:115]
    s_waitcnt vmcnt(11)
    buffer_load_dwordx4 v4, s[28:31], s74 offen offset:2048 lds
    v_mfma_f32_16x16x32_bf16 v[116:119], v[164:167], v[56:59], v[116:119]
    v_mfma_f32_16x16x32_bf16 v[120:123], v[168:171], v[56:59], v[120:123]
    s_add_u32 m0, s55, 15360
    s_add_u32 s75, s74, 98304
    s_waitcnt vmcnt(11)
    buffer_load_dwordx4 v2, s[28:31], s75 offen offset:0 lds
    v_mfma_f32_16x16x32_bf16 v[124:127], v[172:175], v[56:59], v[124:127]
    v_mfma_f32_16x16x32_bf16 v[128:131], v[176:179], v[56:59], v[128:131]
    s_waitcnt vmcnt(11)
    buffer_load_dwordx4 v3, s[28:31], s75 offen offset:1024 lds
    v_mfma_f32_16x16x32_bf16 v[132:135], v[180:183], v[56:59], v[132:135]
    v_mfma_f32_16x16x32_bf16 v[136:139], v[184:187], v[56:59], v[136:139]
    s_waitcnt vmcnt(11)
    buffer_load_dwordx4 v4, s[28:31], s75 offen offset:2048 lds
    s_add_u32 s74, s74, 196608
    s_cmp_eq_u32 s74, 7864320
    s_cselect_b32 s74, 0, s74
    ds_read_b64_tr_b16 v[140:141], v252 offset:0
    ds_read_b64_tr_b16 v[144:145], v253 offset:0
    ds_read_b64_tr_b16 v[148:149], v254 offset:0
    ds_read_b64_tr_b16 v[152:153], v255 offset:0
    ds_read_b64_tr_b16 v[156:157], v252 offset:1024
    ds_read_b64_tr_b16 v[160:161], v253 offset:1024
    ds_read_b64_tr_b16 v[164:165], v254 offset:1024
    ds_read_b64_tr_b16 v[168:169], v255 offset:1024
    ds_read_b64_tr_b16 v[172:173], v252 offset:2048
    ds_read_b64_tr_b16 v[176:177], v253 offset:2048
    ds_read_b64_tr_b16 v[180:181], v254 offset:2048
    ds_read_b64_tr_b16 v[184:185], v255 offset:2048
    s_add_u32 m0, s55, 18432
    s_waitcnt vmcnt(11)
    buffer_load_dwordx4 v2, s[28:31], s74 offen offset:0 lds
    s_waitcnt vmcnt(11)
    buffer_load_dwordx4 v3, s[28:31], s74 offen offset:1024 lds
    s_waitcnt vmcnt(11)
    buffer_load_dwordx4 v4, s[28:31], s74 offen offset:2048 lds
    s_add_u32 m0, s55, 21504
    s_add_u32 s75, s74, 98304
    s_waitcnt vmcnt(11)
    buffer_load_dwordx4 v2, s[28:31], s75 offen offset:0 lds
    s_waitcnt vmcnt(11)
    buffer_load_dwordx4 v3, s[28:31], s75 offen offset:1024 lds
    s_waitcnt vmcnt(11)
    buffer_load_dwordx4 v4, s[28:31], s75 offen offset:2048 lds
    s_add_u32 s74, s74, 196608
    s_cmp_eq_u32 s74, 7864320
    s_cselect_b32 s74, 0, s74
    ds_read_b64_tr_b16 v[142:143], v252 offset:6144
    ds_read_b64_tr_b16 v[146:147], v253 offset:6144
    ds_read_b64_tr_b16 v[150:151], v254 offset:6144
    ds_read_b64_tr_b16 v[154:155], v255 offset:6144
    ds_read_b64_tr_b16 v[158:159], v252 offset:7168
    ds_read_b64_tr_b16 v[162:163], v253 offset:7168
    ds_read_b64_tr_b16 v[166:167], v254 offset:7168
    ds_read_b64_tr_b16 v[170:171], v255 offset:7168
    ds_read_b64_tr_b16 v[174:175], v252 offset:8192
    ds_read_b64_tr_b16 v[178:179], v253 offset:8192
    ds_read_b64_tr_b16 v[182:183], v254 offset:8192
    ds_read_b64_tr_b16 v[186:187], v255 offset:8192
    s_waitcnt lgkmcnt(0)
    v_mfma_f32_16x16x32_bf16 v[92:95], v[140:143], v[60:63], v[92:95]
    v_mfma_f32_16x16x32_bf16 v[96:99], v[144:147], v[60:63], v[96:99]
    s_add_u32 m0, s55, 24576
    s_waitcnt vmcnt(11)
    buffer_load_dwordx4 v5, s[20:23], s57 offen offset:0 nt lds
    v_mfma_f32_16x16x32_bf16 v[100:103], v[148:151], v[60:63], v[100:103]
    v_mfma_f32_16x16x32_bf16 v[104:107], v[152:155], v[60:63], v[104:107]
    s_waitcnt vmcnt(11)
    buffer_load_dwordx4 v6, s[20:23], s57 offen offset:1024 nt lds
    v_mfma_f32_16x16x32_bf16 v[108:111], v[156:159], v[60:63], v[108:111]
    v_mfma_f32_16x16x32_bf16 v[112:115], v[160:163], v[60:63], v[112:115]
    s_waitcnt vmcnt(11)
    buffer_load_dwordx4 v7, s[20:23], s57 offen offset:2048 nt lds
    v_mfma_f32_16x16x32_bf16 v[116:119], v[164:167], v[60:63], v[116:119]
    v_mfma_f32_16x16x32_bf16 v[120:123], v[168:171], v[60:63], v[120:123]
    s_add_u32 m0, s55, 27648
    s_add_u32 s0, s57, 3072
    s_waitcnt vmcnt(11)
    buffer_load_dwordx4 v8, s[20:23], s0 offen offset:0 nt lds
    v_mfma_f32_16x16x32_bf16 v[124:127], v[172:175], v[60:63], v[124:127]
    v_mfma_f32_16x16x32_bf16 v[128:131], v[176:179], v[60:63], v[128:131]
    s_waitcnt vmcnt(11)
    buffer_load_dwordx4 v9, s[20:23], s0 offen offset:1024 nt lds
    v_mfma_f32_16x16x32_bf16 v[132:135], v[180:183], v[60:63], v[132:135]
    v_mfma_f32_16x16x32_bf16 v[136:139], v[184:187], v[60:63], v[136:139]
    s_waitcnt vmcnt(11)
    buffer_load_dwordx4 v10, s[20:23], s0 offen offset:2048 nt lds
    s_add_u32 s57, s57, 24576
    s_sub_u32 s0, s57, 393216
    s_min_u32 s57, s57, s0
    v_lshlrev_b32 v44, 4, v1
    v_xor_b32 v40, v44, v5
    v_lshlrev_b32 v40, 1, v40
    v_xor_b32 v11, v44, v40
    v_xor_b32 v40, v44, v6
    v_lshlrev_b32 v40, 1, v40
    v_xor_b32 v12, v44, v40
    v_xor_b32 v40, v44, v7
    v_lshlrev_b32 v40, 1, v40
    v_xor_b32 v13, v44, v40
    v_lshrrev_b32 v40, 3, v1
    v_and_b32 v41, 6, v40
    s_add_u32 m0, s55, 30720
    s_waitcnt vmcnt(11)
    buffer_load_dwordx4 v5, s[20:23], s57 offen offset:0 nt lds
    v_xor_b32 v41, v41, v1
    v_and_b32 v41, 7, v41
    v_mul_u32_u24 v40, 384, v40
    v_lshl_add_u32 v27, v41, 4, v40
    v_add_u32 v41, 0, v1
    v_mul_u32_u24 v40, 3277, v41
    v_lshrrev_b32 v40, 16, v40
    v_mul_u32_u24 v42, 20, v40
    v_sub_u32 v41, v41, v42
    v_mul_u32_u24 v40, 1280, v40
    v_lshl_add_u32 v14, v41, 4, v40
    v_add_u32 v41, 64, v1
    s_waitcnt vmcnt(11)
    buffer_load_dwordx4 v6, s[20:23], s57 offen offset:1024 nt lds
    v_mul_u32_u24 v40, 3277, v41
    v_lshrrev_b32 v40, 16, v40
    v_mul_u32_u24 v42, 20, v40
    v_sub_u32 v41, v41, v42
    v_mul_u32_u24 v40, 1280, v40
    v_lshl_add_u32 v15, v41, 4, v40
    v_subrev_u32 v15, 1024, v15
    v_add_u32 v41, 128, v1
    v_mul_u32_u24 v40, 3277, v41
    v_lshrrev_b32 v40, 16, v40
    v_mul_u32_u24 v42, 20, v40
    v_sub_u32 v41, v41, v42
    s_waitcnt vmcnt(11)
    buffer_load_dwordx4 v7, s[20:23], s57 offen offset:2048 nt lds
    v_mul_u32_u24 v40, 1280, v40
    v_lshl_add_u32 v16, v41, 4, v40
    v_subrev_u32 v16, 2048, v16
    v_add_u32 v41, 192, v1
    v_mul_u32_u24 v40, 3277, v41
    v_lshrrev_b32 v40, 16, v40
    v_mul_u32_u24 v42, 20, v40
    v_sub_u32 v41, v41, v42
    v_mul_u32_u24 v40, 1280, v40
    v_lshl_add_u32 v17, v41, 4, v40
    v_subrev_u32 v17, 3072, v17
    v_add_u32 v41, 256, v1
    s_add_u32 m0, s55, 33792
    s_add_u32 s0, s57, 3072
    s_waitcnt vmcnt(11)
    buffer_load_dwordx4 v8, s[20:23], s0 offen offset:0 nt lds
    v_mul_u32_u24 v40, 3277, v41
    v_lshrrev_b32 v40, 16, v40
    v_mul_u32_u24 v42, 20, v40
    v_sub_u32 v41, v41, v42
    v_mul_u32_u24 v40, 1280, v40
    v_lshl_add_u32 v18, v41, 4, v40
    v_lshrrev_b32 v40, 2, v1
    v_and_b32 v41, 3, v1
    v_lshlrev_b32 v41, 3, v41
    v_add_u32 v41, s55, v41
    v_mul_u32_u24 v42, 320, v40
    v_add_u32 v25, v42, v41
    s_waitcnt vmcnt(11)
    buffer_load_dwordx4 v9, s[20:23], s0 offen offset:1024 nt lds
    v_mul_u32_u24 v42, 384, v40
    v_add_u32 v41, v42, v41
    v_bfe_u32 v42, v1, 3, 2
    v_xor_b32 v43, 0, v42
    v_lshl_add_u32 v19, v43, 5, v41
    v_xor_b32 v43, 1, v42
    v_lshl_add_u32 v20, v43, 5, v41
    v_xor_b32 v43, 2, v42
    v_lshl_add_u32 v21, v43, 5, v41
    v_xor_b32 v43, 3, v42
    v_lshl_add_u32 v22, v43, 5, v41
    v_and_b32 v45, 15, v1
    s_waitcnt vmcnt(11)
    buffer_load_dwordx4 v10, s[20:23], s0 offen offset:2048 nt lds
    s_add_u32 s57, s57, 24576
    s_sub_u32 s0, s57, 393216
    s_min_u32 s57, s57, s0
    v_lshrrev_b32 v46, 4, v1
    v_mul_u32_u24 v40, 384, v45
    v_add_u32 v40, s55, v40
    v_lshrrev_b32 v41, 1, v45
    v_xor_b32 v41, v41, v46
    v_lshl_add_u32 v23, v41, 4, v40
    v_xor_b32 v41, 4, v41
    v_lshl_add_u32 v24, v41, 4, v40
    v_mul_u32_u24 v40, 784, v45
    v_add_u32 v40, 147456, v40
    v_lshl_add_u32 v29, v46, 5, v40
    s_mul_i32 s58, s52, 3136
    v_lshl_add_u32 v28, v46, 4, v40
    s_add_u32 m0, s55, 0
    s_waitcnt vmcnt(11)
    buffer_load_dwordx4 v5, s[20:23], s57 offen offset:0 nt lds
    v_add_u32 v28, s58, v28
    v_and_b32 v40, 3, v1
    v_lshlrev_b32 v40, 7, v40
    v_add_u32 v31, 160000, v40
    s_lshl_b32 s58, s52, 5
    v_lshl_add_u32 v30, v46, 3, v31
    v_add_u32 v30, s58, v30
    v_add_u32 v33, 147456, v44
    s_lshl_b32 s58, s52, 6
    v_add_u32 v32, s58, v33
    v_lshrrev_b32 v40, 5, v1
    v_and_b32 v41, 31, v1
    s_waitcnt vmcnt(11)
    buffer_load_dwordx4 v6, s[20:23], s57 offen offset:1024 nt lds
    v_lshlrev_b32 v41, 4, v41
    v_lshl_add_u32 v34, v40, 14, v41
    v_lshlrev_b32 v41, 4, v45
    v_lshl_add_u32 v35, v40, 8, v41
    v_bfe_u32 v40, v1, 4, 1
    v_lshl_add_u32 v35, v40, 3, v35
    v_lshrrev_b32 v40, 3, v1
    v_and_b32 v41, 7, v1
    v_lshlrev_b32 v42, 4, v41
    v_lshl_add_u32 v36, v40, 9, v42
    v_mul_u32_u24 v40, 1280, v46
    v_lshl_add_u32 v37, v41, 1, v40
    s_waitcnt vmcnt(11)
    buffer_load_dwordx4 v7, s[20:23], s57 offen offset:2048 nt lds
    s_lshl_b32 s58, s54, 7
    s_add_u32 s58, s58, 2621440
    v_mov_b32 v38, s58
    v_add_u32 v26, s55, v44
    s_mov_b32 s1, 0xfffff000
    s_mov_b32 s60, 0x3dd53b95
    s_mov_b32 s62, 0xf000f
    s_mov_b32 s63, 0xf000f
    s_mov_b32 s66, 0x550055
    s_mov_b32 s67, 0x550055
    s_mov_b32 s68, 4096
    s_mov_b32 s69, 8192
    s_mov_b32 s70, 12288
    s_mov_b32 s71, 32768
    s_mov_b32 s4, 65536
    s_mul_i32 s58, s53, 245760
    s_mul_i32 s59, s52, 320
    s_add_u32 s58, s58, s59
    s_add_u32 s32, s12, s58
    s_addc_u32 s33, s13, 0
    s_sub_u32 s34, 7864320, s58
    s_mov_b32 s35, 0x20000
    s_mul_i32 s58, s54, 20
    s_mul_i32 s59, s52, 5
    s_add_u32 s59, s58, s59
    s_lshl_b32 s59, s59, 5
    s_add_u32 s59, s59, s53
    s_lshl_b32 s59, s59, 9
    s_add_u32 s40, s18, s59
    s_addc_u32 s41, s19, 0
    s_sub_u32 s42, 2621440, s59
    s_mov_b32 s43, 0x20000
    s_add_u32 s58, s58, s53
    s_lshl_b32 s58, s58, 14
    s_lshl_b32 s59, s52, 7
    s_add_u32 s58, s58, s59
    s_add_u32 s44, s18, s58
    s_addc_u32 s45, s19, 0
    s_mov_b32 s46, 16384
    s_mov_b32 s47, 0x20000
    s_mul_i32 s58, s54, 5120
    s_lshl_b32 s59, s53, 6
    s_add_u32 s58, s58, s59
    s_lshl_b32 s59, s52, 4
    s_add_u32 s58, s58, s59
    s_add_u32 s48, s14, s58
    s_addc_u32 s49, s15, 0
    s_sub_u32 s50, 40960, s58
    s_mov_b32 s51, 0x20000
    global_load_dword v39, v38, s[18:19] sc1
    ds_read_b64_tr_b16 v[140:141], v252 offset:12288
    ds_read_b64_tr_b16 v[144:145], v253 offset:12288
    ds_read_b64_tr_b16 v[148:149], v254 offset:12288
    ds_read_b64_tr_b16 v[152:153], v255 offset:12288
    ds_read_b64_tr_b16 v[156:157], v252 offset:13312
    ds_read_b64_tr_b16 v[160:161], v253 offset:13312
    ds_read_b64_tr_b16 v[164:165], v254 offset:13312
    ds_read_b64_tr_b16 v[168:169], v255 offset:13312
    ds_read_b64_tr_b16 v[172:173], v252 offset:14336
    ds_read_b64_tr_b16 v[176:177], v253 offset:14336
    ds_read_b64_tr_b16 v[180:181], v254 offset:14336
    ds_read_b64_tr_b16 v[184:185], v255 offset:14336
    ds_read_b64_tr_b16 v[142:143], v252 offset:18432
    ds_read_b64_tr_b16 v[146:147], v253 offset:18432
    ds_read_b64_tr_b16 v[150:151], v254 offset:18432
    ds_read_b64_tr_b16 v[154:155], v255 offset:18432
    ds_read_b64_tr_b16 v[158:159], v252 offset:19456
    ds_read_b64_tr_b16 v[162:163], v253 offset:19456
    ds_read_b64_tr_b16 v[166:167], v254 offset:19456
    ds_read_b64_tr_b16 v[170:171], v255 offset:19456
    ds_read_b64_tr_b16 v[174:175], v252 offset:20480
    ds_read_b64_tr_b16 v[178:179], v253 offset:20480
    ds_read_b64_tr_b16 v[182:183], v254 offset:20480
    ds_read_b64_tr_b16 v[186:187], v255 offset:20480
    s_waitcnt lgkmcnt(0)
    v_mfma_f32_16x16x32_bf16 v[92:95], v[140:143], v[64:67], v[92:95]
    v_mfma_f32_16x16x32_bf16 v[96:99], v[144:147], v[64:67], v[96:99]
    s_add_u32 m0, s55, 3072
    s_add_u32 s0, s57, 3072
    s_waitcnt vmcnt(11)
    buffer_load_dwordx4 v8, s[20:23], s0 offen offset:0 nt lds
    v_mfma_f32_16x16x32_bf16 v[100:103], v[148:151], v[64:67], v[100:103]
    v_mfma_f32_16x16x32_bf16 v[104:107], v[152:155], v[64:67], v[104:107]
    s_waitcnt vmcnt(11)
    buffer_load_dwordx4 v9, s[20:23], s0 offen offset:1024 nt lds
    v_mfma_f32_16x16x32_bf16 v[108:111], v[156:159], v[64:67], v[108:111]
    v_mfma_f32_16x16x32_bf16 v[112:115], v[160:163], v[64:67], v[112:115]
    s_waitcnt vmcnt(11)
    buffer_load_dwordx4 v10, s[20:23], s0 offen offset:2048 nt lds
    s_add_u32 s57, s57, 24576
    s_sub_u32 s0, s57, 393216
    s_min_u32 s57, s57, s0
    v_mfma_f32_16x16x32_bf16 v[116:119], v[164:167], v[64:67], v[116:119]
    v_mfma_f32_16x16x32_bf16 v[120:123], v[168:171], v[64:67], v[120:123]
    s_add_u32 m0, s55, 6144
    s_waitcnt vmcnt(11)
    buffer_load_dwordx4 v5, s[20:23], s57 offen offset:0 nt lds
    v_mfma_f32_16x16x32_bf16 v[124:127], v[172:175], v[64:67], v[124:127]
    v_mfma_f32_16x16x32_bf16 v[128:131], v[176:179], v[64:67], v[128:131]
    s_waitcnt vmcnt(11)
    buffer_load_dwordx4 v6, s[20:23], s57 offen offset:1024 nt lds
    v_mfma_f32_16x16x32_bf16 v[132:135], v[180:183], v[64:67], v[132:135]
    v_mfma_f32_16x16x32_bf16 v[136:139], v[184:187], v[64:67], v[136:139]
    s_waitcnt vmcnt(11)
    buffer_load_dwordx4 v7, s[20:23], s57 offen offset:2048 nt lds
    s_mov_b64 exec, s[62:63]
    ds_write_b128 v28, v[92:95] offset:0
    ds_write_b128 v28, v[96:99] offset:64
    ds_write_b128 v28, v[100:103] offset:128
    ds_write_b128 v28, v[104:107] offset:192
    ds_write_b128 v28, v[108:111] offset:256
    ds_write_b128 v28, v[112:115] offset:320
    ds_write_b128 v28, v[116:119] offset:384
    ds_write_b128 v28, v[120:123] offset:448
    ds_write_b128 v28, v[124:127] offset:512
    ds_write_b128 v28, v[128:131] offset:576
    ds_write_b128 v28, v[132:135] offset:640
    ds_write_b128 v28, v[136:139] offset:704
    s_mov_b64 exec, -1
    s_waitcnt lgkmcnt(0)
    s_barrier
    ds_read_b128 v[188:191], v29 offset:0
    ds_read_b128 v[192:195], v29 offset:16
    ds_read_b128 v[196:199], v29 offset:128
    ds_read_b128 v[200:203], v29 offset:144
    ds_read_b128 v[204:207], v29 offset:256
    ds_read_b128 v[208:211], v29 offset:272
    ds_read_b128 v[212:215], v29 offset:384
    ds_read_b128 v[216:219], v29 offset:400
    ds_read_b128 v[220:223], v29 offset:512
    ds_read_b128 v[224:227], v29 offset:528
    ds_read_b128 v[228:231], v29 offset:640
    ds_read_b128 v[232:235], v29 offset:656
    s_waitcnt lgkmcnt(0)
    v_add_f32_dpp v188, v188, v188 row_ror:4 row_mask:0xf bank_mask:0xf
    v_add_f32_dpp v189, v189, v189 row_ror:4 row_mask:0xf bank_mask:0xf
    v_add_f32_dpp v190, v190, v190 row_ror:4 row_mask:0xf bank_mask:0xf
    v_add_f32_dpp v191, v191, v191 row_ror:4 row_mask:0xf bank_mask:0xf
    v_add_f32_dpp v192, v192, v192 row_ror:4 row_mask:0xf bank_mask:0xf
    v_add_f32_dpp v193, v193, v193 row_ror:4 row_mask:0xf bank_mask:0xf
    v_add_f32_dpp v194, v194, v194 row_ror:4 row_mask:0xf bank_mask:0xf
    v_add_f32_dpp v195, v195, v195 row_ror:4 row_mask:0xf bank_mask:0xf
    v_add_f32_dpp v196, v196, v196 row_ror:4 row_mask:0xf bank_mask:0xf
    v_add_f32_dpp v197, v197, v197 row_ror:4 row_mask:0xf bank_mask:0xf
    v_add_f32_dpp v198, v198, v198 row_ror:4 row_mask:0xf bank_mask:0xf
    v_add_f32_dpp v199, v199, v199 row_ror:4 row_mask:0xf bank_mask:0xf
    v_add_f32_dpp v200, v200, v200 row_ror:4 row_mask:0xf bank_mask:0xf
    v_add_f32_dpp v201, v201, v201 row_ror:4 row_mask:0xf bank_mask:0xf
    v_add_f32_dpp v202, v202, v202 row_ror:4 row_mask:0xf bank_mask:0xf
    v_add_f32_dpp v203, v203, v203 row_ror:4 row_mask:0xf bank_mask:0xf
    v_add_f32_dpp v204, v204, v204 row_ror:4 row_mask:0xf bank_mask:0xf
    v_add_f32_dpp v205, v205, v205 row_ror:4 row_mask:0xf bank_mask:0xf
    v_add_f32_dpp v206, v206, v206 row_ror:4 row_mask:0xf bank_mask:0xf
    v_add_f32_dpp v207, v207, v207 row_ror:4 row_mask:0xf bank_mask:0xf
    v_add_f32_dpp v208, v208, v208 row_ror:4 row_mask:0xf bank_mask:0xf
    v_add_f32_dpp v209, v209, v209 row_ror:4 row_mask:0xf bank_mask:0xf
    v_add_f32_dpp v210, v210, v210 row_ror:4 row_mask:0xf bank_mask:0xf
    v_add_f32_dpp v211, v211, v211 row_ror:4 row_mask:0xf bank_mask:0xf
    s_add_u32 m0, s55, 9216
    s_add_u32 s0, s57, 3072
    s_waitcnt vmcnt(11)
    buffer_load_dwordx4 v8, s[20:23], s0 offen offset:0 nt lds
    v_add_f32_dpp v212, v212, v212 row_ror:4 row_mask:0xf bank_mask:0xf
    v_add_f32_dpp v213, v213, v213 row_ror:4 row_mask:0xf bank_mask:0xf
    v_add_f32_dpp v214, v214, v214 row_ror:4 row_mask:0xf bank_mask:0xf
    v_add_f32_dpp v215, v215, v215 row_ror:4 row_mask:0xf bank_mask:0xf
    v_add_f32_dpp v216, v216, v216 row_ror:4 row_mask:0xf bank_mask:0xf
    v_add_f32_dpp v217, v217, v217 row_ror:4 row_mask:0xf bank_mask:0xf
    v_add_f32_dpp v218, v218, v218 row_ror:4 row_mask:0xf bank_mask:0xf
    v_add_f32_dpp v219, v219, v219 row_ror:4 row_mask:0xf bank_mask:0xf
    v_add_f32_dpp v220, v220, v220 row_ror:4 row_mask:0xf bank_mask:0xf
    v_add_f32_dpp v221, v221, v221 row_ror:4 row_mask:0xf bank_mask:0xf
    v_add_f32_dpp v222, v222, v222 row_ror:4 row_mask:0xf bank_mask:0xf
    v_add_f32_dpp v223, v223, v223 row_ror:4 row_mask:0xf bank_mask:0xf
    v_add_f32_dpp v224, v224, v224 row_ror:4 row_mask:0xf bank_mask:0xf
    v_add_f32_dpp v225, v225, v225 row_ror:4 row_mask:0xf bank_mask:0xf
    v_add_f32_dpp v226, v226, v226 row_ror:4 row_mask:0xf bank_mask:0xf
    v_add_f32_dpp v227, v227, v227 row_ror:4 row_mask:0xf bank_mask:0xf
    v_add_f32_dpp v228, v228, v228 row_ror:4 row_mask:0xf bank_mask:0xf
    v_add_f32_dpp v229, v229, v229 row_ror:4 row_mask:0xf bank_mask:0xf
    v_add_f32_dpp v230, v230, v230 row_ror:4 row_mask:0xf bank_mask:0xf
    v_add_f32_dpp v231, v231, v231 row_ror:4 row_mask:0xf bank_mask:0xf
    v_add_f32_dpp v232, v232, v232 row_ror:4 row_mask:0xf bank_mask:0xf
    v_add_f32_dpp v233, v233, v233 row_ror:4 row_mask:0xf bank_mask:0xf
    v_add_f32_dpp v234, v234, v234 row_ror:4 row_mask:0xf bank_mask:0xf
    v_add_f32_dpp v235, v235, v235 row_ror:4 row_mask:0xf bank_mask:0xf
    s_waitcnt vmcnt(11)
    buffer_load_dwordx4 v9, s[20:23], s0 offen offset:1024 nt lds
    v_add_f32_dpp v188, v188, v188 row_ror:8 row_mask:0xf bank_mask:0xf
    v_add_f32_dpp v189, v189, v189 row_ror:8 row_mask:0xf bank_mask:0xf
    v_add_f32_dpp v190, v190, v190 row_ror:8 row_mask:0xf bank_mask:0xf
    v_add_f32_dpp v191, v191, v191 row_ror:8 row_mask:0xf bank_mask:0xf
    v_add_f32_dpp v192, v192, v192 row_ror:8 row_mask:0xf bank_mask:0xf
    v_add_f32_dpp v193, v193, v193 row_ror:8 row_mask:0xf bank_mask:0xf
    v_add_f32_dpp v194, v194, v194 row_ror:8 row_mask:0xf bank_mask:0xf
    v_add_f32_dpp v195, v195, v195 row_ror:8 row_mask:0xf bank_mask:0xf
    v_add_f32_dpp v196, v196, v196 row_ror:8 row_mask:0xf bank_mask:0xf
    v_add_f32_dpp v197, v197, v197 row_ror:8 row_mask:0xf bank_mask:0xf
    v_add_f32_dpp v198, v198, v198 row_ror:8 row_mask:0xf bank_mask:0xf
    v_add_f32_dpp v199, v199, v199 row_ror:8 row_mask:0xf bank_mask:0xf
    v_add_f32_dpp v200, v200, v200 row_ror:8 row_mask:0xf bank_mask:0xf
    v_add_f32_dpp v201, v201, v201 row_ror:8 row_mask:0xf bank_mask:0xf
    v_add_f32_dpp v202, v202, v202 row_ror:8 row_mask:0xf bank_mask:0xf
    v_add_f32_dpp v203, v203, v203 row_ror:8 row_mask:0xf bank_mask:0xf
    v_add_f32_dpp v204, v204, v204 row_ror:8 row_mask:0xf bank_mask:0xf
    v_add_f32_dpp v205, v205, v205 row_ror:8 row_mask:0xf bank_mask:0xf
    v_add_f32_dpp v206, v206, v206 row_ror:8 row_mask:0xf bank_mask:0xf
    v_add_f32_dpp v207, v207, v207 row_ror:8 row_mask:0xf bank_mask:0xf
    v_add_f32_dpp v208, v208, v208 row_ror:8 row_mask:0xf bank_mask:0xf
    v_add_f32_dpp v209, v209, v209 row_ror:8 row_mask:0xf bank_mask:0xf
    v_add_f32_dpp v210, v210, v210 row_ror:8 row_mask:0xf bank_mask:0xf
    v_add_f32_dpp v211, v211, v211 row_ror:8 row_mask:0xf bank_mask:0xf
    s_waitcnt vmcnt(11)
    buffer_load_dwordx4 v10, s[20:23], s0 offen offset:2048 nt lds
    s_add_u32 s57, s57, 24576
    s_sub_u32 s0, s57, 393216
    s_min_u32 s57, s57, s0
    v_add_f32_dpp v212, v212, v212 row_ror:8 row_mask:0xf bank_mask:0xf
    v_add_f32_dpp v213, v213, v213 row_ror:8 row_mask:0xf bank_mask:0xf
    v_add_f32_dpp v214, v214, v214 row_ror:8 row_mask:0xf bank_mask:0xf
    v_add_f32_dpp v215, v215, v215 row_ror:8 row_mask:0xf bank_mask:0xf
    v_add_f32_dpp v216, v216, v216 row_ror:8 row_mask:0xf bank_mask:0xf
    v_add_f32_dpp v217, v217, v217 row_ror:8 row_mask:0xf bank_mask:0xf
    v_add_f32_dpp v218, v218, v218 row_ror:8 row_mask:0xf bank_mask:0xf
    v_add_f32_dpp v219, v219, v219 row_ror:8 row_mask:0xf bank_mask:0xf
    v_add_f32_dpp v220, v220, v220 row_ror:8 row_mask:0xf bank_mask:0xf
    v_add_f32_dpp v221, v221, v221 row_ror:8 row_mask:0xf bank_mask:0xf
    v_add_f32_dpp v222, v222, v222 row_ror:8 row_mask:0xf bank_mask:0xf
    v_add_f32_dpp v223, v223, v223 row_ror:8 row_mask:0xf bank_mask:0xf
    v_add_f32_dpp v224, v224, v224 row_ror:8 row_mask:0xf bank_mask:0xf
    v_add_f32_dpp v225, v225, v225 row_ror:8 row_mask:0xf bank_mask:0xf
    v_add_f32_dpp v226, v226, v226 row_ror:8 row_mask:0xf bank_mask:0xf
    v_add_f32_dpp v227, v227, v227 row_ror:8 row_mask:0xf bank_mask:0xf
    v_add_f32_dpp v228, v228, v228 row_ror:8 row_mask:0xf bank_mask:0xf
    v_add_f32_dpp v229, v229, v229 row_ror:8 row_mask:0xf bank_mask:0xf
    v_add_f32_dpp v230, v230, v230 row_ror:8 row_mask:0xf bank_mask:0xf
    v_add_f32_dpp v231, v231, v231 row_ror:8 row_mask:0xf bank_mask:0xf
    v_add_f32_dpp v232, v232, v232 row_ror:8 row_mask:0xf bank_mask:0xf
    v_add_f32_dpp v233, v233, v233 row_ror:8 row_mask:0xf bank_mask:0xf
    v_add_f32_dpp v234, v234, v234 row_ror:8 row_mask:0xf bank_mask:0xf
    v_add_f32_dpp v235, v235, v235 row_ror:8 row_mask:0xf bank_mask:0xf
    s_add_u32 m0, s55, 12288
    s_waitcnt vmcnt(11)
    buffer_load_dwordx4 v5, s[20:23], s57 offen offset:0 nt lds
    v_cvt_pk_bf16_f32 v68, v188, v189
    v_cvt_pk_bf16_f32 v69, v190, v191
    v_cvt_pk_bf16_f32 v70, v192, v193
    v_cvt_pk_bf16_f32 v71, v194, v195
    v_cvt_pk_bf16_f32 v72, v196, v197
    v_cvt_pk_bf16_f32 v73, v198, v199
    v_cvt_pk_bf16_f32 v74, v200, v201
    v_cvt_pk_bf16_f32 v75, v202, v203
    v_cvt_pk_bf16_f32 v76, v204, v205
    v_cvt_pk_bf16_f32 v77, v206, v207
    v_cvt_pk_bf16_f32 v78, v208, v209
    v_cvt_pk_bf16_f32 v79, v210, v211
    v_cvt_pk_bf16_f32 v80, v212, v213
    v_cvt_pk_bf16_f32 v81, v214, v215
    v_cvt_pk_bf16_f32 v82, v216, v217
    v_cvt_pk_bf16_f32 v83, v218, v219
    v_cvt_pk_bf16_f32 v84, v220, v221
    v_cvt_pk_bf16_f32 v85, v222, v223
    v_cvt_pk_bf16_f32 v86, v224, v225
    v_cvt_pk_bf16_f32 v87, v226, v227
    v_cvt_pk_bf16_f32 v88, v228, v229
    v_cvt_pk_bf16_f32 v89, v230, v231
    v_cvt_pk_bf16_f32 v90, v232, v233
    v_cvt_pk_bf16_f32 v91, v234, v235
    s_waitcnt vmcnt(11)
    buffer_load_dwordx4 v6, s[20:23], s57 offen offset:1024 nt lds
    ds_read_b128 v[140:143], v23 offset:24576
    ds_read_b128 v[144:147], v24 offset:24576
    ds_read_b128 v[148:151], v23 offset:24704
    ds_read_b128 v[152:155], v24 offset:24704
    ds_read_b128 v[156:159], v23 offset:24832
    ds_read_b128 v[160:163], v24 offset:24832
    s_waitcnt vmcnt(11)
    buffer_load_dwordx4 v7, s[20:23], s57 offen offset:2048 nt lds
    s_waitcnt lgkmcnt(0)
    v_mfma_f32_16x16x32_bf16 v[188:191], v[140:143], v[68:71], 0
    v_mfma_f32_16x16x32_bf16 v[188:191], v[144:147], v[72:75], v[188:191]
    v_mfma_f32_16x16x32_bf16 v[188:191], v[148:151], v[76:79], v[188:191]
    v_mfma_f32_16x16x32_bf16 v[188:191], v[152:155], v[80:83], v[188:191]
    v_mfma_f32_16x16x32_bf16 v[188:191], v[156:159], v[84:87], v[188:191]
    v_mfma_f32_16x16x32_bf16 v[188:191], v[160:163], v[88:91], v[188:191]
    s_add_u32 m0, s55, 15360
    s_add_u32 s0, s57, 3072
    s_waitcnt vmcnt(11)
    buffer_load_dwordx4 v8, s[20:23], s0 offen offset:0 nt lds
    ds_read_b128 v[140:143], v23 offset:30720
    ds_read_b128 v[144:147], v24 offset:30720
    ds_read_b128 v[148:151], v23 offset:30848
    ds_read_b128 v[152:155], v24 offset:30848
    ds_read_b128 v[156:159], v23 offset:30976
    ds_read_b128 v[160:163], v24 offset:30976
    s_waitcnt vmcnt(11)
    buffer_load_dwordx4 v9, s[20:23], s0 offen offset:1024 nt lds
    s_waitcnt lgkmcnt(0)
    v_mfma_f32_16x16x32_bf16 v[192:195], v[140:143], v[68:71], 0
    v_mfma_f32_16x16x32_bf16 v[192:195], v[144:147], v[72:75], v[192:195]
    v_mfma_f32_16x16x32_bf16 v[192:195], v[148:151], v[76:79], v[192:195]
    v_mfma_f32_16x16x32_bf16 v[192:195], v[152:155], v[80:83], v[192:195]
    v_mfma_f32_16x16x32_bf16 v[192:195], v[156:159], v[84:87], v[192:195]
    v_mfma_f32_16x16x32_bf16 v[192:195], v[160:163], v[88:91], v[192:195]
    s_waitcnt vmcnt(11)
    buffer_load_dwordx4 v10, s[20:23], s0 offen offset:2048 nt lds
    s_add_u32 s57, s57, 24576
    s_sub_u32 s0, s57, 393216
    s_min_u32 s57, s57, s0
    ds_read_b128 v[140:143], v23 offset:0
    ds_read_b128 v[144:147], v24 offset:0
    ds_read_b128 v[148:151], v23 offset:128
    ds_read_b128 v[152:155], v24 offset:128
    ds_read_b128 v[156:159], v23 offset:256
    ds_read_b128 v[160:163], v24 offset:256
    s_add_u32 m0, s55, 18432
    s_waitcnt vmcnt(11)
    buffer_load_dwordx4 v5, s[20:23], s57 offen offset:0 nt lds
    s_waitcnt lgkmcnt(0)
    v_mfma_f32_16x16x32_bf16 v[196:199], v[140:143], v[68:71], 0
    v_mfma_f32_16x16x32_bf16 v[196:199], v[144:147], v[72:75], v[196:199]
    v_mfma_f32_16x16x32_bf16 v[196:199], v[148:151], v[76:79], v[196:199]
    v_mfma_f32_16x16x32_bf16 v[196:199], v[152:155], v[80:83], v[196:199]
    v_mfma_f32_16x16x32_bf16 v[196:199], v[156:159], v[84:87], v[196:199]
    v_mfma_f32_16x16x32_bf16 v[196:199], v[160:163], v[88:91], v[196:199]
    s_mov_b32 s75, 0
    s_add_u32 m0, s55, 24576
    s_waitcnt vmcnt(11)
    buffer_load_dwordx4 v14, s[32:35], s75 offen offset:0 lds
    s_add_u32 m0, s55, 18432
    s_waitcnt vmcnt(11)
    buffer_load_dwordx4 v6, s[20:23], s57 offen offset:1024 nt lds
    s_waitcnt vmcnt(11)
    buffer_load_dwordx4 v7, s[20:23], s57 offen offset:2048 nt lds
    s_add_u32 m0, s55, 21504
    s_add_u32 s0, s57, 3072
    s_waitcnt vmcnt(11)
    buffer_load_dwordx4 v8, s[20:23], s0 offen offset:0 nt lds
    s_add_u32 m0, s55, 24576
    s_waitcnt vmcnt(11)
    buffer_load_dwordx4 v15, s[32:35], s75 offen offset:1024 lds
    ds_read_b128 v[140:143], v23 offset:6144
    ds_read_b128 v[144:147], v24 offset:6144
    ds_read_b128 v[148:151], v23 offset:6272
    ds_read_b128 v[152:155], v24 offset:6272
    ds_read_b128 v[156:159], v23 offset:6400
    ds_read_b128 v[160:163], v24 offset:6400
    s_add_u32 m0, s55, 21504
    s_waitcnt vmcnt(11)
    buffer_load_dwordx4 v9, s[20:23], s0 offen offset:1024 nt lds
    s_waitcnt lgkmcnt(0)
    v_mfma_f32_16x16x32_bf16 v[200:203], v[140:143], v[68:71], 0
    v_mfma_f32_16x16x32_bf16 v[200:203], v[144:147], v[72:75], v[200:203]
    v_mfma_f32_16x16x32_bf16 v[200:203], v[148:151], v[76:79], v[200:203]
    v_mfma_f32_16x16x32_bf16 v[200:203], v[152:155], v[80:83], v[200:203]
    v_mfma_f32_16x16x32_bf16 v[200:203], v[156:159], v[84:87], v[200:203]
    v_mfma_f32_16x16x32_bf16 v[200:203], v[160:163], v[88:91], v[200:203]
    s_waitcnt vmcnt(11)
    buffer_load_dwordx4 v10, s[20:23], s0 offen offset:2048 nt lds
    s_add_u32 s57, s57, 24576
    s_sub_u32 s0, s57, 393216
    s_min_u32 s57, s57, s0
    s_add_u32 m0, s55, 24576
    s_waitcnt vmcnt(11)
    buffer_load_dwordx4 v16, s[32:35], s75 offen offset:2048 lds
    s_add_u32 m0, s55, 30720
    s_waitcnt vmcnt(11)
    buffer_load_dwordx4 v5, s[20:23], s57 offen offset:0 nt lds
    s_waitcnt vmcnt(11)
    buffer_load_dwordx4 v6, s[20:23], s57 offen offset:1024 nt lds
    s_waitcnt vmcnt(11)
    buffer_load_dwordx4 v7, s[20:23], s57 offen offset:2048 nt lds
    ds_read_b128 v[140:143], v23 offset:12288
    ds_read_b128 v[144:147], v24 offset:12288
    ds_read_b128 v[148:151], v23 offset:12416
    ds_read_b128 v[152:155], v24 offset:12416
    ds_read_b128 v[156:159], v23 offset:12544
    ds_read_b128 v[160:163], v24 offset:12544
    s_add_u32 m0, s55, 24576
    s_waitcnt vmcnt(11)
    buffer_load_dwordx4 v17, s[32:35], s75 offen offset:3072 lds
    s_waitcnt lgkmcnt(0)
    v_mfma_f32_16x16x32_bf16 v[204:207], v[140:143], v[68:71], 0
    v_mfma_f32_16x16x32_bf16 v[204:207], v[144:147], v[72:75], v[204:207]
    v_mfma_f32_16x16x32_bf16 v[204:207], v[148:151], v[76:79], v[204:207]
    v_mfma_f32_16x16x32_bf16 v[204:207], v[152:155], v[80:83], v[204:207]
    v_mfma_f32_16x16x32_bf16 v[204:207], v[156:159], v[84:87], v[204:207]
    v_mfma_f32_16x16x32_bf16 v[204:207], v[160:163], v[88:91], v[204:207]
    s_add_u32 m0, s55, 33792
    s_add_u32 s0, s57, 3072
    s_waitcnt vmcnt(11)
    buffer_load_dwordx4 v8, s[20:23], s0 offen offset:0 nt lds
    s_waitcnt vmcnt(11)
    buffer_load_dwordx4 v9, s[20:23], s0 offen offset:1024 nt lds
    s_add_u32 m0, s55, 28672
    s_waitcnt vmcnt(11)
    buffer_load_dwordx4 v18, s[32:35], s75 offen offset:0 lds
    s_add_u32 m0, s55, 33792
    s_waitcnt vmcnt(11)
    buffer_load_dwordx4 v10, s[20:23], s0 offen offset:2048 nt lds
    s_add_u32 s57, s57, 24576
    s_sub_u32 s0, s57, 393216
    s_min_u32 s57, s57, s0
    s_add_u32 m0, s55, 0
    s_waitcnt vmcnt(8)
    buffer_load_dwordx4 v5, s[20:23], s57 offen offset:0 nt lds
    ds_read_b128 v[140:143], v23 offset:18432
    ds_read_b128 v[144:147], v24 offset:18432
    ds_read_b128 v[148:151], v23 offset:18560
    ds_read_b128 v[152:155], v24 offset:18560
    ds_read_b128 v[156:159], v23 offset:18688
    ds_read_b128 v[160:163], v24 offset:18688
    s_mov_b32 s75, 20480
    s_add_u32 m0, s55, 6144
    s_waitcnt vmcnt(8)
    buffer_load_dwordx4 v14, s[32:35], s75 offen offset:0 lds
    s_waitcnt lgkmcnt(0)
    v_mfma_f32_16x16x32_bf16 v[208:211], v[140:143], v[68:71], 0
    v_mfma_f32_16x16x32_bf16 v[208:211], v[144:147], v[72:75], v[208:211]
    v_mfma_f32_16x16x32_bf16 v[208:211], v[148:151], v[76:79], v[208:211]
    v_mfma_f32_16x16x32_bf16 v[208:211], v[152:155], v[80:83], v[208:211]
    v_mfma_f32_16x16x32_bf16 v[208:211], v[156:159], v[84:87], v[208:211]
    v_mfma_f32_16x16x32_bf16 v[208:211], v[160:163], v[88:91], v[208:211]
    s_add_u32 m0, s55, 0
    s_waitcnt vmcnt(8)
    buffer_load_dwordx4 v6, s[20:23], s57 offen offset:1024 nt lds
    s_waitcnt vmcnt(8)
    buffer_load_dwordx4 v7, s[20:23], s57 offen offset:2048 nt lds
    s_add_u32 m0, s55, 3072
    s_add_u32 s0, s57, 3072
    s_waitcnt vmcnt(8)
    buffer_load_dwordx4 v8, s[20:23], s0 offen offset:0 nt lds
    s_add_u32 m0, s55, 6144
    s_waitcnt vmcnt(8)
    buffer_load_dwordx4 v15, s[32:35], s75 offen offset:1024 lds
    s_add_u32 m0, s55, 3072
    s_waitcnt vmcnt(8)
    buffer_load_dwordx4 v9, s[20:23], s0 offen offset:1024 nt lds
    s_waitcnt vmcnt(8)
    buffer_load_dwordx4 v10, s[20:23], s0 offen offset:2048 nt lds
    s_add_u32 s57, s57, 24576
    s_sub_u32 s0, s57, 393216
    s_min_u32 s57, s57, s0
    ds_read_b64_tr_b16 a[0:1], v25 offset:24576
    ds_read_b64_tr_b16 a[4:5], v25 offset:24608
    ds_read_b64_tr_b16 a[8:9], v25 offset:24640
    ds_read_b64_tr_b16 a[12:13], v25 offset:24672
    ds_read_b64_tr_b16 a[16:17], v25 offset:24704
    ds_read_b64_tr_b16 a[20:21], v25 offset:24736
    ds_read_b64_tr_b16 a[24:25], v25 offset:24768
    ds_read_b64_tr_b16 a[28:29], v25 offset:24800
    ds_read_b64_tr_b16 a[32:33], v25 offset:24832
    ds_read_b64_tr_b16 a[36:37], v25 offset:24864
    s_add_u32 m0, s55, 6144
    s_waitcnt vmcnt(8)
    buffer_load_dwordx4 v16, s[32:35], s75 offen offset:2048 lds
    ds_read_b128 v[140:143], v23 offset:30720
    ds_read_b128 v[144:147], v24 offset:30720
    ds_read_b128 v[148:151], v23 offset:30848
    ds_read_b128 v[152:155], v24 offset:30848
    ds_read_b128 v[156:159], v23 offset:30976
    ds_read_b128 v[160:163], v24 offset:30976
    s_add_u32 m0, s55, 12288
    s_waitcnt vmcnt(8)
    buffer_load_dwordx4 v5, s[20:23], s57 offen offset:0 nt lds
    s_waitcnt lgkmcnt(0)
    v_mfma_f32_16x16x32_bf16 v[212:215], v[140:143], v[68:71], 0
    v_mfma_f32_16x16x32_bf16 v[212:215], v[144:147], v[72:75], v[212:215]
    v_mfma_f32_16x16x32_bf16 v[212:215], v[148:151], v[76:79], v[212:215]
    v_mfma_f32_16x16x32_bf16 v[212:215], v[152:155], v[80:83], v[212:215]
    v_mfma_f32_16x16x32_bf16 v[212:215], v[156:159], v[84:87], v[212:215]
    v_mfma_f32_16x16x32_bf16 v[212:215], v[160:163], v[88:91], v[212:215]
    s_waitcnt vmcnt(8)
    buffer_load_dwordx4 v6, s[20:23], s57 offen offset:1024 nt lds
    s_waitcnt vmcnt(8)
    buffer_load_dwordx4 v7, s[20:23], s57 offen offset:2048 nt lds
    s_add_u32 m0, s55, 6144
    s_waitcnt vmcnt(8)
    buffer_load_dwordx4 v17, s[32:35], s75 offen offset:3072 lds
    s_add_u32 m0, s55, 15360
    s_add_u32 s0, s57, 3072
    s_waitcnt vmcnt(8)
    buffer_load_dwordx4 v8, s[20:23], s0 offen offset:0 nt lds
    s_waitcnt vmcnt(8)
    buffer_load_dwordx4 v9, s[20:23], s0 offen offset:1024 nt lds
    s_add_u32 m0, s55, 10240
    s_waitcnt vmcnt(8)
    buffer_load_dwordx4 v18, s[32:35], s75 offen offset:0 lds
    s_add_u32 m0, s55, 15360
    s_waitcnt vmcnt(8)
    buffer_load_dwordx4 v10, s[20:23], s0 offen offset:2048 nt lds
    s_add_u32 s57, s57, 24576
    s_sub_u32 s0, s57, 393216
    s_min_u32 s57, s57, s0
    ds_read_b128 v[140:143], v23 offset:0
    ds_read_b128 v[144:147], v24 offset:0
    ds_read_b128 v[148:151], v23 offset:128
    ds_read_b128 v[152:155], v24 offset:128
    ds_read_b128 v[156:159], v23 offset:256
    ds_read_b128 v[160:163], v24 offset:256
    s_add_u32 m0, s55, 18432
    s_waitcnt vmcnt(8)
    buffer_load_dwordx4 v5, s[20:23], s57 offen offset:0 nt lds
    s_waitcnt lgkmcnt(0)
    v_mfma_f32_16x16x32_bf16 v[216:219], v[140:143], v[68:71], 0
    v_mfma_f32_16x16x32_bf16 v[216:219], v[144:147], v[72:75], v[216:219]
    v_mfma_f32_16x16x32_bf16 v[216:219], v[148:151], v[76:79], v[216:219]
    v_mfma_f32_16x16x32_bf16 v[216:219], v[152:155], v[80:83], v[216:219]
    v_mfma_f32_16x16x32_bf16 v[216:219], v[156:159], v[84:87], v[216:219]
    v_mfma_f32_16x16x32_bf16 v[216:219], v[160:163], v[88:91], v[216:219]
    s_mov_b32 s75, 40960
    s_add_u32 m0, s55, 24576
    s_waitcnt vmcnt(8)
    buffer_load_dwordx4 v14, s[32:35], s75 offen offset:0 lds
    s_add_u32 m0, s55, 18432
    s_waitcnt vmcnt(8)
    buffer_load_dwordx4 v6, s[20:23], s57 offen offset:1024 nt lds
    s_waitcnt vmcnt(8)
    buffer_load_dwordx4 v7, s[20:23], s57 offen offset:2048 nt lds
    s_add_u32 m0, s55, 21504
    s_add_u32 s0, s57, 3072
    s_waitcnt vmcnt(8)
    buffer_load_dwordx4 v8, s[20:23], s0 offen offset:0 nt lds
    s_add_u32 m0, s55, 24576
    s_waitcnt vmcnt(8)
    buffer_load_dwordx4 v15, s[32:35], s75 offen offset:1024 lds
    s_add_u32 m0, s55, 21504
    s_waitcnt vmcnt(8)
    buffer_load_dwordx4 v9, s[20:23], s0 offen offset:1024 nt lds
    s_waitcnt vmcnt(8)
    buffer_load_dwordx4 v10, s[20:23], s0 offen offset:2048 nt lds
    s_add_u32 s57, s57, 24576
    s_sub_u32 s0, s57, 393216
    s_min_u32 s57, s57, s0
    ds_read_b64_tr_b16 a[2:3], v25 offset:6144
    ds_read_b64_tr_b16 a[6:7], v25 offset:6176
    ds_read_b64_tr_b16 a[10:11], v25 offset:6208
    ds_read_b64_tr_b16 a[14:15], v25 offset:6240
    ds_read_b64_tr_b16 a[18:19], v25 offset:6272
    ds_read_b64_tr_b16 a[22:23], v25 offset:6304
    ds_read_b64_tr_b16 a[26:27], v25 offset:6336
    ds_read_b64_tr_b16 a[30:31], v25 offset:6368
    ds_read_b64_tr_b16 a[34:35], v25 offset:6400
    ds_read_b64_tr_b16 a[38:39], v25 offset:6432
    s_add_u32 m0, s55, 24576
    s_waitcnt vmcnt(8)
    buffer_load_dwordx4 v16, s[32:35], s75 offen offset:2048 lds
    ds_read_b128 v[140:143], v23 offset:12288
    ds_read_b128 v[144:147], v24 offset:12288
    ds_read_b128 v[148:151], v23 offset:12416
    ds_read_b128 v[152:155], v24 offset:12416
    ds_read_b128 v[156:159], v23 offset:12544
    ds_read_b128 v[160:163], v24 offset:12544
    s_add_u32 m0, s55, 30720
    s_waitcnt vmcnt(8)
    buffer_load_dwordx4 v5, s[20:23], s57 offen offset:0 nt lds
    s_waitcnt lgkmcnt(0)
    v_mfma_f32_16x16x32_bf16 v[220:223], v[140:143], v[68:71], 0
    v_mfma_f32_16x16x32_bf16 v[220:223], v[144:147], v[72:75], v[220:223]
    v_mfma_f32_16x16x32_bf16 v[220:223], v[148:151], v[76:79], v[220:223]
    v_mfma_f32_16x16x32_bf16 v[220:223], v[152:155], v[80:83], v[220:223]
    v_mfma_f32_16x16x32_bf16 v[220:223], v[156:159], v[84:87], v[220:223]
    v_mfma_f32_16x16x32_bf16 v[220:223], v[160:163], v[88:91], v[220:223]
    s_waitcnt vmcnt(8)
    buffer_load_dwordx4 v6, s[20:23], s57 offen offset:1024 nt lds
    s_waitcnt vmcnt(8)
    buffer_load_dwordx4 v7, s[20:23], s57 offen offset:2048 nt lds
    s_add_u32 m0, s55, 24576
    s_waitcnt vmcnt(8)
    buffer_load_dwordx4 v17, s[32:35], s75 offen offset:3072 lds
    s_add_u32 m0, s55, 33792
    s_add_u32 s0, s57, 3072
    s_waitcnt vmcnt(8)
    buffer_load_dwordx4 v8, s[20:23], s0 offen offset:0 nt lds
    s_waitcnt vmcnt(8)
    buffer_load_dwordx4 v9, s[20:23], s0 offen offset:1024 nt lds
    s_add_u32 m0, s55, 28672
    s_waitcnt vmcnt(8)
    buffer_load_dwordx4 v18, s[32:35], s75 offen offset:0 lds
    s_add_u32 m0, s55, 33792
    s_waitcnt vmcnt(8)
    buffer_load_dwordx4 v10, s[20:23], s0 offen offset:2048 nt lds
    s_add_u32 s57, s57, 24576
    s_sub_u32 s0, s57, 393216
    s_min_u32 s57, s57, s0
    ds_read_b128 v[140:143], v23 offset:18432
    ds_read_b128 v[144:147], v24 offset:18432
    ds_read_b128 v[148:151], v23 offset:18560
    ds_read_b128 v[152:155], v24 offset:18560
    ds_read_b128 v[156:159], v23 offset:18688
    ds_read_b128 v[160:163], v24 offset:18688
    s_add_u32 m0, s55, 0
    s_waitcnt vmcnt(8)
    buffer_load_dwordx4 v5, s[20:23], s57 offen offset:0 nt lds
    s_waitcnt lgkmcnt(0)
    v_mfma_f32_16x16x32_bf16 v[224:227], v[140:143], v[68:71], 0
    v_mfma_f32_16x16x32_bf16 v[224:227], v[144:147], v[72:75], v[224:227]
    v_mfma_f32_16x16x32_bf16 v[224:227], v[148:151], v[76:79], v[224:227]
    v_mfma_f32_16x16x32_bf16 v[224:227], v[152:155], v[80:83], v[224:227]
    v_mfma_f32_16x16x32_bf16 v[224:227], v[156:159], v[84:87], v[224:227]
    v_mfma_f32_16x16x32_bf16 v[224:227], v[160:163], v[88:91], v[224:227]
    s_mov_b32 s75, 61440
    s_add_u32 m0, s55, 6144
    s_waitcnt vmcnt(8)
    buffer_load_dwordx4 v14, s[32:35], s75 offen offset:0 lds
    s_add_u32 m0, s55, 0
    s_waitcnt vmcnt(8)
    buffer_load_dwordx4 v6, s[20:23], s57 offen offset:1024 nt lds
    s_waitcnt vmcnt(8)
    buffer_load_dwordx4 v7, s[20:23], s57 offen offset:2048 nt lds
    s_add_u32 m0, s55, 3072
    s_add_u32 s0, s57, 3072
    s_waitcnt vmcnt(8)
    buffer_load_dwordx4 v8, s[20:23], s0 offen offset:0 nt lds
    s_add_u32 m0, s55, 6144
    s_waitcnt vmcnt(8)
    buffer_load_dwordx4 v15, s[32:35], s75 offen offset:1024 lds
    s_add_u32 m0, s55, 3072
    s_waitcnt vmcnt(8)
    buffer_load_dwordx4 v9, s[20:23], s0 offen offset:1024 nt lds
    s_waitcnt vmcnt(8)
    buffer_load_dwordx4 v10, s[20:23], s0 offen offset:2048 nt lds
    s_add_u32 s57, s57, 24576
    s_sub_u32 s0, s57, 393216
    s_min_u32 s57, s57, s0
    ds_read_b64_tr_b16 a[40:41], v25 offset:24576
    ds_read_b64_tr_b16 a[44:45], v25 offset:24608
    ds_read_b64_tr_b16 a[48:49], v25 offset:24640
    ds_read_b64_tr_b16 a[52:53], v25 offset:24672
    ds_read_b64_tr_b16 a[56:57], v25 offset:24704
    ds_read_b64_tr_b16 a[60:61], v25 offset:24736
    ds_read_b64_tr_b16 a[64:65], v25 offset:24768
    ds_read_b64_tr_b16 a[68:69], v25 offset:24800
    ds_read_b64_tr_b16 a[72:73], v25 offset:24832
    ds_read_b64_tr_b16 a[76:77], v25 offset:24864
    s_add_u32 m0, s55, 6144
    s_waitcnt vmcnt(8)
    buffer_load_dwordx4 v16, s[32:35], s75 offen offset:2048 lds
    ds_read_b128 v[140:143], v23 offset:30720
    ds_read_b128 v[144:147], v24 offset:30720
    ds_read_b128 v[148:151], v23 offset:30848
    ds_read_b128 v[152:155], v24 offset:30848
    ds_read_b128 v[156:159], v23 offset:30976
    ds_read_b128 v[160:163], v24 offset:30976
    s_add_u32 m0, s55, 12288
    s_waitcnt vmcnt(8)
    buffer_load_dwordx4 v5, s[20:23], s57 offen offset:0 nt lds
    s_waitcnt lgkmcnt(0)
    v_mfma_f32_16x16x32_bf16 v[228:231], v[140:143], v[68:71], 0
    v_mfma_f32_16x16x32_bf16 v[228:231], v[144:147], v[72:75], v[228:231]
    v_mfma_f32_16x16x32_bf16 v[228:231], v[148:151], v[76:79], v[228:231]
    v_mfma_f32_16x16x32_bf16 v[228:231], v[152:155], v[80:83], v[228:231]
    v_mfma_f32_16x16x32_bf16 v[228:231], v[156:159], v[84:87], v[228:231]
    v_mfma_f32_16x16x32_bf16 v[228:231], v[160:163], v[88:91], v[228:231]
    s_waitcnt vmcnt(8)
    buffer_load_dwordx4 v6, s[20:23], s57 offen offset:1024 nt lds
    s_waitcnt vmcnt(8)
    buffer_load_dwordx4 v7, s[20:23], s57 offen offset:2048 nt lds
    s_add_u32 m0, s55, 6144
    s_waitcnt vmcnt(8)
    buffer_load_dwordx4 v17, s[32:35], s75 offen offset:3072 lds
    s_add_u32 m0, s55, 15360
    s_add_u32 s0, s57, 3072
    s_waitcnt vmcnt(8)
    buffer_load_dwordx4 v8, s[20:23], s0 offen offset:0 nt lds
    s_waitcnt vmcnt(8)
    buffer_load_dwordx4 v9, s[20:23], s0 offen offset:1024 nt lds
    s_add_u32 m0, s55, 10240
    s_waitcnt vmcnt(8)
    buffer_load_dwordx4 v18, s[32:35], s75 offen offset:0 lds
    s_add_u32 m0, s55, 15360
    s_waitcnt vmcnt(8)
    buffer_load_dwordx4 v10, s[20:23], s0 offen offset:2048 nt lds
    s_add_u32 s57, s57, 24576
    s_sub_u32 s0, s57, 393216
    s_min_u32 s57, s57, s0
    ds_read_b128 v[140:143], v23 offset:0
    ds_read_b128 v[144:147], v24 offset:0
    ds_read_b128 v[148:151], v23 offset:128
    ds_read_b128 v[152:155], v24 offset:128
    ds_read_b128 v[156:159], v23 offset:256
    ds_read_b128 v[160:163], v24 offset:256
    s_add_u32 m0, s55, 18432
    s_waitcnt vmcnt(8)
    buffer_load_dwordx4 v5, s[20:23], s57 offen offset:0 nt lds
    s_waitcnt lgkmcnt(0)
    v_mfma_f32_16x16x32_bf16 v[232:235], v[140:143], v[68:71], 0
    v_mfma_f32_16x16x32_bf16 v[232:235], v[144:147], v[72:75], v[232:235]
    v_mfma_f32_16x16x32_bf16 v[232:235], v[148:151], v[76:79], v[232:235]
    v_mfma_f32_16x16x32_bf16 v[232:235], v[152:155], v[80:83], v[232:235]
    v_mfma_f32_16x16x32_bf16 v[232:235], v[156:159], v[84:87], v[232:235]
    v_mfma_f32_16x16x32_bf16 v[232:235], v[160:163], v[88:91], v[232:235]
    s_mov_b32 s75, 81920
    s_add_u32 m0, s55, 24576
    s_waitcnt vmcnt(8)
    buffer_load_dwordx4 v14, s[32:35], s75 offen offset:0 lds
    s_add_u32 m0, s55, 18432
    s_waitcnt vmcnt(8)
    buffer_load_dwordx4 v6, s[20:23], s57 offen offset:1024 nt lds
    s_waitcnt vmcnt(8)
    buffer_load_dwordx4 v7, s[20:23], s57 offen offset:2048 nt lds
    s_add_u32 m0, s55, 21504
    s_add_u32 s0, s57, 3072
    s_waitcnt vmcnt(8)
    buffer_load_dwordx4 v8, s[20:23], s0 offen offset:0 nt lds
    s_add_u32 m0, s55, 24576
    s_waitcnt vmcnt(8)
    buffer_load_dwordx4 v15, s[32:35], s75 offen offset:1024 lds
    s_add_u32 m0, s55, 21504
    s_waitcnt vmcnt(8)
    buffer_load_dwordx4 v9, s[20:23], s0 offen offset:1024 nt lds
    s_waitcnt vmcnt(8)
    buffer_load_dwordx4 v10, s[20:23], s0 offen offset:2048 nt lds
    s_add_u32 s57, s57, 24576
    s_sub_u32 s0, s57, 393216
    s_min_u32 s57, s57, s0
    ds_read_b64_tr_b16 a[42:43], v25 offset:6144
    ds_read_b64_tr_b16 a[46:47], v25 offset:6176
    ds_read_b64_tr_b16 a[50:51], v25 offset:6208
    ds_read_b64_tr_b16 a[54:55], v25 offset:6240
    ds_read_b64_tr_b16 a[58:59], v25 offset:6272
    ds_read_b64_tr_b16 a[62:63], v25 offset:6304
    ds_read_b64_tr_b16 a[66:67], v25 offset:6336
    ds_read_b64_tr_b16 a[70:71], v25 offset:6368
    ds_read_b64_tr_b16 a[74:75], v25 offset:6400
    ds_read_b64_tr_b16 a[78:79], v25 offset:6432
    s_add_u32 m0, s55, 24576
    s_waitcnt vmcnt(8)
    buffer_load_dwordx4 v16, s[32:35], s75 offen offset:2048 lds
    ds_read_b128 v[140:143], v23 offset:12288
    ds_read_b128 v[144:147], v24 offset:12288
    ds_read_b128 v[148:151], v23 offset:12416
    ds_read_b128 v[152:155], v24 offset:12416
    ds_read_b128 v[156:159], v23 offset:12544
    ds_read_b128 v[160:163], v24 offset:12544
    s_add_u32 m0, s55, 30720
    s_waitcnt vmcnt(8)
    buffer_load_dwordx4 v5, s[20:23], s57 offen offset:0 nt lds
    s_waitcnt lgkmcnt(0)
    v_mfma_f32_16x16x32_bf16 v[236:239], v[140:143], v[68:71], 0
    v_mfma_f32_16x16x32_bf16 v[236:239], v[144:147], v[72:75], v[236:239]
    v_mfma_f32_16x16x32_bf16 v[236:239], v[148:151], v[76:79], v[236:239]
    v_mfma_f32_16x16x32_bf16 v[236:239], v[152:155], v[80:83], v[236:239]
    v_mfma_f32_16x16x32_bf16 v[236:239], v[156:159], v[84:87], v[236:239]
    v_mfma_f32_16x16x32_bf16 v[236:239], v[160:163], v[88:91], v[236:239]
    s_waitcnt vmcnt(8)
    buffer_load_dwordx4 v6, s[20:23], s57 offen offset:1024 nt lds
    s_waitcnt vmcnt(8)
    buffer_load_dwordx4 v7, s[20:23], s57 offen offset:2048 nt lds
    s_add_u32 m0, s55, 24576
    s_waitcnt vmcnt(8)
    buffer_load_dwordx4 v17, s[32:35], s75 offen offset:3072 lds
    s_add_u32 m0, s55, 33792
    s_add_u32 s0, s57, 3072
    s_waitcnt vmcnt(8)
    buffer_load_dwordx4 v8, s[20:23], s0 offen offset:0 nt lds
    s_waitcnt vmcnt(8)
    buffer_load_dwordx4 v9, s[20:23], s0 offen offset:1024 nt lds
    s_add_u32 m0, s55, 28672
    s_waitcnt vmcnt(8)
    buffer_load_dwordx4 v18, s[32:35], s75 offen offset:0 lds
    s_add_u32 m0, s55, 33792
    s_waitcnt vmcnt(8)
    buffer_load_dwordx4 v10, s[20:23], s0 offen offset:2048 nt lds
    s_add_u32 s57, s57, 24576
    s_sub_u32 s0, s57, 393216
    s_min_u32 s57, s57, s0
    ds_read_b128 v[140:143], v23 offset:18432
    ds_read_b128 v[144:147], v24 offset:18432
    ds_read_b128 v[148:151], v23 offset:18560
    ds_read_b128 v[152:155], v24 offset:18560
    ds_read_b128 v[156:159], v23 offset:18688
    ds_read_b128 v[160:163], v24 offset:18688
    s_add_u32 m0, s55, 0
    s_waitcnt vmcnt(8)
    buffer_load_dwordx4 v5, s[20:23], s57 offen offset:0 nt lds
    s_waitcnt lgkmcnt(0)
    v_mfma_f32_16x16x32_bf16 v[240:243], v[140:143], v[68:71], 0
    v_mfma_f32_16x16x32_bf16 v[240:243], v[144:147], v[72:75], v[240:243]
    v_mfma_f32_16x16x32_bf16 v[240:243], v[148:151], v[76:79], v[240:243]
    v_mfma_f32_16x16x32_bf16 v[240:243], v[152:155], v[80:83], v[240:243]
    v_mfma_f32_16x16x32_bf16 v[240:243], v[156:159], v[84:87], v[240:243]
    v_mfma_f32_16x16x32_bf16 v[240:243], v[160:163], v[88:91], v[240:243]
    s_mov_b32 s75, 102400
    s_add_u32 m0, s55, 6144
    s_waitcnt vmcnt(8)
    buffer_load_dwordx4 v14, s[32:35], s75 offen offset:0 lds
    s_add_u32 m0, s55, 0
    s_waitcnt vmcnt(8)
    buffer_load_dwordx4 v6, s[20:23], s57 offen offset:1024 nt lds
    s_waitcnt vmcnt(8)
    buffer_load_dwordx4 v7, s[20:23], s57 offen offset:2048 nt lds
    s_add_u32 m0, s55, 3072
    s_add_u32 s0, s57, 3072
    s_waitcnt vmcnt(8)
    buffer_load_dwordx4 v8, s[20:23], s0 offen offset:0 nt lds
    s_add_u32 m0, s55, 6144
    s_waitcnt vmcnt(8)
    buffer_load_dwordx4 v15, s[32:35], s75 offen offset:1024 lds
    s_add_u32 m0, s55, 3072
    s_waitcnt vmcnt(8)
    buffer_load_dwordx4 v9, s[20:23], s0 offen offset:1024 nt lds
    s_waitcnt vmcnt(8)
    buffer_load_dwordx4 v10, s[20:23], s0 offen offset:2048 nt lds
    s_add_u32 s57, s57, 24576
    s_sub_u32 s0, s57, 393216
    s_min_u32 s57, s57, s0
    ds_read_b64_tr_b16 a[80:81], v25 offset:24576
    ds_read_b64_tr_b16 a[84:85], v25 offset:24608
    ds_read_b64_tr_b16 a[88:89], v25 offset:24640
    ds_read_b64_tr_b16 a[92:93], v25 offset:24672
    ds_read_b64_tr_b16 a[96:97], v25 offset:24704
    ds_read_b64_tr_b16 a[100:101], v25 offset:24736
    ds_read_b64_tr_b16 a[104:105], v25 offset:24768
    ds_read_b64_tr_b16 a[108:109], v25 offset:24800
    ds_read_b64_tr_b16 a[112:113], v25 offset:24832
    ds_read_b64_tr_b16 a[116:117], v25 offset:24864
    s_add_u32 m0, s55, 6144
    s_waitcnt vmcnt(8)
    buffer_load_dwordx4 v16, s[32:35], s75 offen offset:2048 lds
    ds_read_b128 v[140:143], v23 offset:30720
    ds_read_b128 v[144:147], v24 offset:30720
    ds_read_b128 v[148:151], v23 offset:30848
    ds_read_b128 v[152:155], v24 offset:30848
    ds_read_b128 v[156:159], v23 offset:30976
    ds_read_b128 v[160:163], v24 offset:30976
    s_add_u32 m0, s55, 12288
    s_waitcnt vmcnt(8)
    buffer_load_dwordx4 v11, s[24:27], s57 offen offset:0 nt lds
    s_waitcnt lgkmcnt(0)
    v_mfma_f32_16x16x32_bf16 v[244:247], v[140:143], v[68:71], 0
    v_mfma_f32_16x16x32_bf16 v[244:247], v[144:147], v[72:75], v[244:247]
    v_mfma_f32_16x16x32_bf16 v[244:247], v[148:151], v[76:79], v[244:247]
    v_mfma_f32_16x16x32_bf16 v[244:247], v[152:155], v[80:83], v[244:247]
    v_mfma_f32_16x16x32_bf16 v[244:247], v[156:159], v[84:87], v[244:247]
    v_mfma_f32_16x16x32_bf16 v[244:247], v[160:163], v[88:91], v[244:247]
    s_waitcnt vmcnt(8)
    buffer_load_dwordx4 v12, s[24:27], s57 offen offset:1024 nt lds
    s_waitcnt vmcnt(8)
    buffer_load_dwordx4 v13, s[24:27], s57 offen offset:2048 nt lds
    s_add_u32 m0, s55, 6144
    s_waitcnt vmcnt(8)
    buffer_load_dwordx4 v17, s[32:35], s75 offen offset:3072 lds
    s_add_u32 m0, s55, 15360
    s_add_u32 s0, s57, 3072
    s_waitcnt vmcnt(8)
    buffer_load_dwordx4 v11, s[24:27], s0 offen offset:0 nt lds
    s_waitcnt vmcnt(8)
    buffer_load_dwordx4 v12, s[24:27], s0 offen offset:1024 nt lds
    s_add_u32 m0, s55, 10240
    s_waitcnt vmcnt(8)
    buffer_load_dwordx4 v18, s[32:35], s75 offen offset:0 lds
    s_add_u32 m0, s55, 15360
    s_waitcnt vmcnt(8)
    buffer_load_dwordx4 v13, s[24:27], s0 offen offset:2048 nt lds
    s_add_u32 s57, s57, 24576
    s_sub_u32 s0, s57, 393216
    s_min_u32 s57, s57, s0
    ds_read_b128 v[140:143], v23 offset:0
    ds_read_b128 v[144:147], v24 offset:0
    ds_read_b128 v[148:151], v23 offset:128
    ds_read_b128 v[152:155], v24 offset:128
    ds_read_b128 v[156:159], v23 offset:256
    ds_read_b128 v[160:163], v24 offset:256
    s_add_u32 m0, s55, 18432
    s_waitcnt vmcnt(8)
    buffer_load_dwordx4 v11, s[24:27], s57 offen offset:0 nt lds
    s_waitcnt lgkmcnt(0)
    v_mfma_f32_16x16x32_bf16 v[248:251], v[140:143], v[68:71], 0
    v_mfma_f32_16x16x32_bf16 v[248:251], v[144:147], v[72:75], v[248:251]
    v_mfma_f32_16x16x32_bf16 v[248:251], v[148:151], v[76:79], v[248:251]
    v_mfma_f32_16x16x32_bf16 v[248:251], v[152:155], v[80:83], v[248:251]
    v_mfma_f32_16x16x32_bf16 v[248:251], v[156:159], v[84:87], v[248:251]
    v_mfma_f32_16x16x32_bf16 v[248:251], v[160:163], v[88:91], v[248:251]
    s_mov_b32 s75, 122880
    s_add_u32 m0, s55, 30720
    s_waitcnt vmcnt(8)
    buffer_load_dwordx4 v14, s[32:35], s75 offen offset:0 lds
    v_max3_f32 v40, v188, v189, v190
    v_max3_f32 v41, v191, v192, v193
    v_max3_f32 v40, v40, v194, v195
    v_max3_f32 v41, v41, v196, v197
    v_max3_f32 v40, v40, v198, v199
    v_max3_f32 v41, v41, v200, v201
    v_max3_f32 v40, v40, v202, v203
    v_max3_f32 v41, v41, v204, v205
    v_max3_f32 v40, v40, v206, v207
    v_max3_f32 v41, v41, v208, v209
    v_max3_f32 v40, v40, v210, v211
    v_max3_f32 v41, v41, v212, v213
    v_max3_f32 v40, v40, v214, v215
    v_max3_f32 v41, v41, v216, v217
    v_max3_f32 v40, v40, v218, v219
    v_max3_f32 v41, v41, v220, v221
    v_max3_f32 v40, v40, v222, v223
    v_max3_f32 v41, v41, v224, v225
    v_max3_f32 v40, v40, v226, v227
    v_max3_f32 v41, v41, v228, v229
    v_max3_f32 v40, v40, v230, v231
    v_max3_f32 v41, v41, v232, v233
    v_max3_f32 v40, v40, v234, v235
    v_max3_f32 v41, v41, v236, v237
    v_max3_f32 v40, v40, v238, v239
    s_add_u32 m0, s55, 18432
    s_waitcnt vmcnt(8)
    buffer_load_dwordx4 v12, s[24:27], s57 offen offset:1024 nt lds
    v_max3_f32 v41, v41, v240, v241
    v_max3_f32 v40, v40, v242, v243
    v_max3_f32 v41, v41, v244, v245
    v_max3_f32 v40, v40, v246, v247
    v_max3_f32 v41, v41, v248, v249
    v_max3_f32 v40, v40, v250, v251
    v_max_f32 v40, v40, v41
    v_mul_f32 v41, s60, v40
    v_max_f32 v41, 0xff7fffff, v41
    v_fma_f32 v188, v188, s60, -v41
    v_fma_f32 v189, v189, s60, -v41
    v_fma_f32 v190, v190, s60, -v41
    v_fma_f32 v191, v191, s60, -v41
    v_fma_f32 v192, v192, s60, -v41
    v_fma_f32 v193, v193, s60, -v41
    v_fma_f32 v194, v194, s60, -v41
    v_fma_f32 v195, v195, s60, -v41
    v_fma_f32 v196, v196, s60, -v41
    v_fma_f32 v197, v197, s60, -v41
    v_fma_f32 v198, v198, s60, -v41
    v_fma_f32 v199, v199, s60, -v41
    v_fma_f32 v200, v200, s60, -v41
    v_fma_f32 v201, v201, s60, -v41
    v_fma_f32 v202, v202, s60, -v41
    v_fma_f32 v203, v203, s60, -v41
    s_waitcnt vmcnt(8)
    buffer_load_dwordx4 v13, s[24:27], s57 offen offset:2048 nt lds
    v_fma_f32 v204, v204, s60, -v41
    v_fma_f32 v205, v205, s60, -v41
    v_fma_f32 v206, v206, s60, -v41
    v_fma_f32 v207, v207, s60, -v41
    v_fma_f32 v208, v208, s60, -v41
    v_fma_f32 v209, v209, s60, -v41
    v_fma_f32 v210, v210, s60, -v41
    v_fma_f32 v211, v211, s60, -v41
    v_fma_f32 v212, v212, s60, -v41
    v_fma_f32 v213, v213, s60, -v41
    v_fma_f32 v214, v214, s60, -v41
    v_fma_f32 v215, v215, s60, -v41
    v_fma_f32 v216, v216, s60, -v41
    v_fma_f32 v217, v217, s60, -v41
    v_fma_f32 v218, v218, s60, -v41
    v_fma_f32 v219, v219, s60, -v41
    v_fma_f32 v220, v220, s60, -v41
    v_fma_f32 v221, v221, s60, -v41
    v_fma_f32 v222, v222, s60, -v41
    v_fma_f32 v223, v223, s60, -v41
    v_fma_f32 v224, v224, s60, -v41
    v_fma_f32 v225, v225, s60, -v41
    v_fma_f32 v226, v226, s60, -v41
    v_fma_f32 v227, v227, s60, -v41
    v_fma_f32 v228, v228, s60, -v41
    s_add_u32 m0, s55, 21504
    s_add_u32 s0, s57, 3072
    s_waitcnt vmcnt(8)
    buffer_load_dwordx4 v11, s[24:27], s0 offen offset:0 nt lds
    v_fma_f32 v229, v229, s60, -v41
    v_fma_f32 v230, v230, s60, -v41
    v_fma_f32 v231, v231, s60, -v41
    v_fma_f32 v232, v232, s60, -v41
    v_fma_f32 v233, v233, s60, -v41
    v_fma_f32 v234, v234, s60, -v41
    v_fma_f32 v235, v235, s60, -v41
    v_fma_f32 v236, v236, s60, -v41
    v_fma_f32 v237, v237, s60, -v41
    v_fma_f32 v238, v238, s60, -v41
    v_fma_f32 v239, v239, s60, -v41
    v_fma_f32 v240, v240, s60, -v41
    v_fma_f32 v241, v241, s60, -v41
    v_fma_f32 v242, v242, s60, -v41
    v_fma_f32 v243, v243, s60, -v41
    v_fma_f32 v244, v244, s60, -v41
    v_fma_f32 v245, v245, s60, -v41
    v_fma_f32 v246, v246, s60, -v41
    v_fma_f32 v247, v247, s60, -v41
    v_fma_f32 v248, v248, s60, -v41
    v_fma_f32 v249, v249, s60, -v41
    v_fma_f32 v250, v250, s60, -v41
    v_fma_f32 v251, v251, s60, -v41
    v_exp_f32 v188, v188
    v_exp_f32 v189, v189
    s_add_u32 m0, s55, 30720
    s_waitcnt vmcnt(8)
    buffer_load_dwordx4 v15, s[32:35], s75 offen offset:1024 lds
    v_exp_f32 v190, v190
    v_exp_f32 v191, v191
    v_exp_f32 v192, v192
    v_exp_f32 v193, v193
    v_exp_f32 v194, v194
    v_exp_f32 v195, v195
    v_exp_f32 v196, v196
    v_exp_f32 v197, v197
    v_exp_f32 v198, v198
    v_exp_f32 v199, v199
    v_exp_f32 v200, v200
    v_exp_f32 v201, v201
    v_exp_f32 v202, v202
    v_exp_f32 v203, v203
    v_exp_f32 v204, v204
    v_exp_f32 v205, v205
    v_exp_f32 v206, v206
    v_exp_f32 v207, v207
    v_exp_f32 v208, v208
    v_exp_f32 v209, v209
    v_exp_f32 v210, v210
    v_exp_f32 v211, v211
    v_exp_f32 v212, v212
    v_exp_f32 v213, v213
    v_exp_f32 v214, v214
    s_add_u32 m0, s55, 21504
    s_waitcnt vmcnt(8)
    buffer_load_dwordx4 v12, s[24:27], s0 offen offset:1024 nt lds
    v_exp_f32 v215, v215
    v_exp_f32 v216, v216
    v_exp_f32 v217, v217
    v_exp_f32 v218, v218
    v_exp_f32 v219, v219
    v_exp_f32 v220, v220
    v_exp_f32 v221, v221
    v_exp_f32 v222, v222
    v_exp_f32 v223, v223
    v_exp_f32 v224, v224
    v_exp_f32 v225, v225
    v_exp_f32 v226, v226
    v_exp_f32 v227, v227
    v_exp_f32 v228, v228
    v_exp_f32 v229, v229
    v_exp_f32 v230, v230
    v_exp_f32 v231, v231
    v_exp_f32 v232, v232
    v_exp_f32 v233, v233
    v_exp_f32 v234, v234
    v_exp_f32 v235, v235
    v_exp_f32 v236, v236
    v_exp_f32 v237, v237
    v_exp_f32 v238, v238
    v_exp_f32 v239, v239
    s_waitcnt vmcnt(8)
    buffer_load_dwordx4 v13, s[24:27], s0 offen offset:2048 nt lds
    s_add_u32 s57, s57, 24576
    s_sub_u32 s0, s57, 393216
    s_min_u32 s57, s57, s0
    v_exp_f32 v240, v240
    v_exp_f32 v241, v241
    v_exp_f32 v242, v242
    v_exp_f32 v243, v243
    v_exp_f32 v244, v244
    v_exp_f32 v245, v245
    v_exp_f32 v246, v246
    v_exp_f32 v247, v247
    v_exp_f32 v248, v248
    v_exp_f32 v249, v249
    v_exp_f32 v250, v250
    v_exp_f32 v251, v251
    v_add_f32 v42, v188, v189
    v_add_f32 v43, v190, v191
    v_add_f32 v42, v42, v192
    v_add_f32 v43, v43, v193
    v_add_f32 v42, v42, v194
    v_add_f32 v43, v43, v195
    v_add_f32 v42, v42, v196
    v_add_f32 v43, v43, v197
    v_add_f32 v42, v42, v198
    v_add_f32 v43, v43, v199
    v_add_f32 v42, v42, v200
    v_add_f32 v43, v43, v201
    v_add_f32 v42, v42, v202
    s_add_u32 m0, s55, 30720
    s_waitcnt vmcnt(8)
    buffer_load_dwordx4 v16, s[32:35], s75 offen offset:2048 lds
    v_add_f32 v43, v43, v203
    v_add_f32 v42, v42, v204
    v_add_f32 v43, v43, v205
    v_add_f32 v42, v42, v206
    v_add_f32 v43, v43, v207
    v_add_f32 v42, v42, v208
    v_add_f32 v43, v43, v209
    v_add_f32 v42, v42, v210
    v_add_f32 v43, v43, v211
    v_add_f32 v42, v42, v212
    v_add_f32 v43, v43, v213
    v_add_f32 v42, v42, v214
    v_add_f32 v43, v43, v215
    v_add_f32 v42, v42, v216
    v_add_f32 v43, v43, v217
    v_add_f32 v42, v42, v218
    v_add_f32 v43, v43, v219
    v_add_f32 v42, v42, v220
    v_add_f32 v43, v43, v221
    v_add_f32 v42, v42, v222
    v_add_f32 v43, v43, v223
    v_add_f32 v42, v42, v224
    v_add_f32 v43, v43, v225
    v_add_f32 v42, v42, v226
    v_add_f32 v43, v43, v227
    s_add_u32 m0, s55, 24576
    s_waitcnt vmcnt(8)
    buffer_load_dwordx4 v11, s[24:27], s57 offen offset:0 nt lds
    v_add_f32 v42, v42, v228
    v_add_f32 v43, v43, v229
    v_add_f32 v42, v42, v230
    v_add_f32 v43, v43, v231
    v_add_f32 v42, v42, v232
    v_add_f32 v43, v43, v233
    v_add_f32 v42, v42, v234
    v_add_f32 v43, v43, v235
    v_add_f32 v42, v42, v236
    v_add_f32 v43, v43, v237
    v_add_f32 v42, v42, v238
    v_add_f32 v43, v43, v239
    v_add_f32 v42, v42, v240
    v_add_f32 v43, v43, v241
    v_add_f32 v42, v42, v242
    v_add_f32 v43, v43, v243
    v_add_f32 v42, v42, v244
    v_add_f32 v43, v43, v245
    v_add_f32 v42, v42, v246
    v_add_f32 v43, v43, v247
    v_add_f32 v42, v42, v248
    v_add_f32 v43, v43, v249
    v_add_f32 v42, v42, v250
    v_add_f32 v43, v43, v251
    v_mov_b32 v44, v41
    s_waitcnt vmcnt(8)
    buffer_load_dwordx4 v12, s[24:27], s57 offen offset:1024 nt lds
    v_add_f32 v45, v42, v43
    s_mov_b64 exec, s[62:63]
    ds_write_b64 v30, v[44:45]
    s_mov_b64 exec, -1
    v_add_u32 v39, 1, v39
    v_and_b32 v2, 0xfff, v39
    v_bfe_u32 v3, v39, 12, 12
    v_lshrrev_b32 v4, 20, v39
    v_lshrrev_b32 v46, 1, v1
    v_and_b32 v46, 8, v46
    v_add_u32 v46, 12, v46
    v_bfe_u32 v0, v39, v46, 12
    v_xor_b32 v3, v2, v3
    v_xor_b32 v4, v2, v4
    v_xor_b32 v0, v2, v0
    buffer_load_dwordx4 v13, s[24:27], s57 offen offset:2048 nt lds
    s_add_u32 m0, s55, 30720
    s_nop 0
    buffer_load_dwordx4 v17, s[32:35], s75 offen offset:3072 lds
    s_add_u32 m0, s55, 27648
    s_add_u32 s0, s57, 3072
    buffer_load_dwordx4 v11, s[24:27], s0 offen offset:0 nt lds
    s_waitcnt lgkmcnt(0)
    s_barrier
    ds_read_b128 v[92:95], v31 offset:0
    ds_read_b128 v[96:99], v31 offset:16
    ds_read_b128 v[100:103], v31 offset:32
    ds_read_b128 v[104:107], v31 offset:48
    ds_read_b128 v[108:111], v31 offset:64
    ds_read_b128 v[112:115], v31 offset:80
    ds_read_b128 v[116:119], v31 offset:96
    ds_read_b128 v[120:123], v31 offset:112
    s_waitcnt lgkmcnt(0)
    v_max3_f32 v40, v92, v94, v96
    v_max3_f32 v40, v40, v98, v100
    v_max3_f32 v40, v40, v102, v104
    v_max3_f32 v40, v40, v106, v108
    v_max3_f32 v40, v40, v110, v112
    v_max3_f32 v40, v40, v114, v116
    v_max3_f32 v40, v40, v118, v120
    v_max_f32 v40, v40, v122
    v_sub_f32 v92, v92, v40
    v_sub_f32 v94, v94, v40
    v_sub_f32 v96, v96, v40
    v_sub_f32 v98, v98, v40
    v_sub_f32 v100, v100, v40
    v_sub_f32 v102, v102, v40
    v_sub_f32 v104, v104, v40
    v_sub_f32 v106, v106, v40
    v_sub_f32 v108, v108, v40
    v_sub_f32 v110, v110, v40
    v_sub_f32 v112, v112, v40
    v_sub_f32 v114, v114, v40
    v_sub_f32 v116, v116, v40
    v_sub_f32 v118, v118, v40
    v_sub_f32 v120, v120, v40
    v_sub_f32 v122, v122, v40
    v_sub_f32 v41, v41, v40
    s_waitcnt vmcnt(8)
    buffer_load_dwordx4 v12, s[24:27], s0 offen offset:1024 nt lds
    v_exp_f32 v92, v92
    v_exp_f32 v94, v94
    v_exp_f32 v96, v96
    v_exp_f32 v98, v98
    v_exp_f32 v100, v100
    v_exp_f32 v102, v102
    v_exp_f32 v104, v104
    v_exp_f32 v106, v106
    v_exp_f32 v108, v108
    v_exp_f32 v110, v110
    v_exp_f32 v112, v112
    v_exp_f32 v114, v114
    v_exp_f32 v116, v116
    v_exp_f32 v118, v118
    v_exp_f32 v120, v120
    v_exp_f32 v122, v122
    v_exp_f32 v41, v41
    v_mul_f32 v42, v92, v93
    v_fmac_f32 v42, v94, v95
    v_fmac_f32 v42, v96, v97
    v_fmac_f32 v42, v98, v99
    v_fmac_f32 v42, v100, v101
    v_fmac_f32 v42, v102, v103
    v_fmac_f32 v42, v104, v105
    v_fmac_f32 v42, v106, v107
    s_add_u32 m0, s55, 34816
    s_waitcnt vmcnt(8)
    buffer_load_dwordx4 v18, s[32:35], s75 offen offset:0 lds
    v_fmac_f32 v42, v108, v109
    v_fmac_f32 v42, v110, v111
    v_fmac_f32 v42, v112, v113
    v_fmac_f32 v42, v114, v115
    v_fmac_f32 v42, v116, v117
    v_fmac_f32 v42, v118, v119
    v_fmac_f32 v42, v120, v121
    v_fmac_f32 v42, v122, v123
    v_rcp_f32 v42, v42
    s_nop 0
    v_mul_f32 v41, v41, v42
    v_mul_f32 v188, v41, v188
    v_mul_f32 v189, v41, v189
    v_mul_f32 v190, v41, v190
    v_mul_f32 v191, v41, v191
    v_mul_f32 v192, v41, v192
    v_mul_f32 v193, v41, v193
    v_mul_f32 v194, v41, v194
    v_mul_f32 v195, v41, v195
    v_mul_f32 v196, v41, v196
    v_mul_f32 v197, v41, v197
    v_mul_f32 v198, v41, v198
    v_mul_f32 v199, v41, v199
    v_mul_f32 v200, v41, v200
    v_mul_f32 v201, v41, v201
    v_mul_f32 v202, v41, v202
    s_add_u32 m0, s55, 27648
    s_waitcnt vmcnt(8)
    buffer_load_dwordx4 v13, s[24:27], s0 offen offset:2048 nt lds
    s_add_u32 s57, s57, 24576
    s_sub_u32 s0, s57, 393216
    s_min_u32 s57, s57, s0
    v_mul_f32 v203, v41, v203
    v_mul_f32 v204, v41, v204
    v_mul_f32 v205, v41, v205
    v_mul_f32 v206, v41, v206
    v_mul_f32 v207, v41, v207
    v_mul_f32 v208, v41, v208
    v_mul_f32 v209, v41, v209
    v_mul_f32 v210, v41, v210
    v_mul_f32 v211, v41, v211
    v_mul_f32 v212, v41, v212
    v_mul_f32 v213, v41, v213
    v_mul_f32 v214, v41, v214
    v_mul_f32 v215, v41, v215
    v_mul_f32 v216, v41, v216
    v_mul_f32 v217, v41, v217
    v_mul_f32 v218, v41, v218
    v_mul_f32 v219, v41, v219
    v_mul_f32 v220, v41, v220
    v_mul_f32 v221, v41, v221
    v_mul_f32 v222, v41, v222
    v_mul_f32 v223, v41, v223
    v_mul_f32 v224, v41, v224
    v_mul_f32 v225, v41, v225
    v_mul_f32 v226, v41, v226
    v_mul_f32 v227, v41, v227
    s_add_u32 m0, s55, 0
    s_waitcnt vmcnt(8)
    buffer_load_dwordx4 v11, s[24:27], s57 offen offset:0 nt lds
    v_mul_f32 v228, v41, v228
    v_mul_f32 v229, v41, v229
    v_mul_f32 v230, v41, v230
    v_mul_f32 v231, v41, v231
    v_mul_f32 v232, v41, v232
    v_mul_f32 v233, v41, v233
    v_mul_f32 v234, v41, v234
    v_mul_f32 v235, v41, v235
    v_mul_f32 v236, v41, v236
    v_mul_f32 v237, v41, v237
    v_mul_f32 v238, v41, v238
    v_mul_f32 v239, v41, v239
    v_mul_f32 v240, v41, v240
    v_mul_f32 v241, v41, v241
    v_mul_f32 v242, v41, v242
    v_mul_f32 v243, v41, v243
    v_mul_f32 v244, v41, v244
    v_mul_f32 v245, v41, v245
    v_mul_f32 v246, v41, v246
    v_mul_f32 v247, v41, v247
    v_mul_f32 v248, v41, v248
    v_mul_f32 v249, v41, v249
    v_mul_f32 v250, v41, v250
    v_mul_f32 v251, v41, v251
    v_cvt_pk_bf16_f32 v188, v188, v189
    s_waitcnt vmcnt(8)
    buffer_load_dwordx4 v12, s[24:27], s57 offen offset:1024 nt lds
    v_cvt_pk_bf16_f32 v189, v190, v191
    v_cvt_pk_bf16_f32 v190, v192, v193
    v_cvt_pk_bf16_f32 v191, v194, v195
    v_cvt_pk_bf16_f32 v192, v196, v197
    v_cvt_pk_bf16_f32 v193, v198, v199
    v_cvt_pk_bf16_f32 v194, v200, v201
    v_cvt_pk_bf16_f32 v195, v202, v203
    v_cvt_pk_bf16_f32 v196, v204, v205
    v_cvt_pk_bf16_f32 v197, v206, v207
    v_cvt_pk_bf16_f32 v198, v208, v209
    v_cvt_pk_bf16_f32 v199, v210, v211
    v_cvt_pk_bf16_f32 v200, v212, v213
    v_cvt_pk_bf16_f32 v201, v214, v215
    v_cvt_pk_bf16_f32 v202, v216, v217
    v_cvt_pk_bf16_f32 v203, v218, v219
    v_cvt_pk_bf16_f32 v204, v220, v221
    v_cvt_pk_bf16_f32 v205, v222, v223
    v_cvt_pk_bf16_f32 v206, v224, v225
    v_cvt_pk_bf16_f32 v207, v226, v227
    v_cvt_pk_bf16_f32 v208, v228, v229
    v_cvt_pk_bf16_f32 v209, v230, v231
    v_cvt_pk_bf16_f32 v210, v232, v233
    v_cvt_pk_bf16_f32 v211, v234, v235
    v_cvt_pk_bf16_f32 v212, v236, v237
    v_cvt_pk_bf16_f32 v213, v238, v239
    s_waitcnt vmcnt(8)
    buffer_load_dwordx4 v13, s[24:27], s57 offen offset:2048 nt lds
    v_cvt_pk_bf16_f32 v214, v240, v241
    v_cvt_pk_bf16_f32 v215, v242, v243
    v_cvt_pk_bf16_f32 v216, v244, v245
    v_cvt_pk_bf16_f32 v217, v246, v247
    v_cvt_pk_bf16_f32 v218, v248, v249
    v_cvt_pk_bf16_f32 v219, v250, v251
    ds_read_b64_tr_b16 a[82:83], v25 offset:6144
    ds_read_b64_tr_b16 a[86:87], v25 offset:6176
    ds_read_b64_tr_b16 a[90:91], v25 offset:6208
    ds_read_b64_tr_b16 a[94:95], v25 offset:6240
    ds_read_b64_tr_b16 a[98:99], v25 offset:6272
    ds_read_b64_tr_b16 a[102:103], v25 offset:6304
    ds_read_b64_tr_b16 a[106:107], v25 offset:6336
    ds_read_b64_tr_b16 a[110:111], v25 offset:6368
    ds_read_b64_tr_b16 a[114:115], v25 offset:6400
    ds_read_b64_tr_b16 a[118:119], v25 offset:6432
    ds_read_b64_tr_b16 v[140:141], v19 offset:12288
    ds_read_b64_tr_b16 v[144:145], v20 offset:12288
    ds_read_b64_tr_b16 v[148:149], v21 offset:12288
    ds_read_b64_tr_b16 v[152:153], v22 offset:12288
    ds_read_b64_tr_b16 v[156:157], v19 offset:12416
    ds_read_b64_tr_b16 v[160:161], v20 offset:12416
    ds_read_b64_tr_b16 v[164:165], v21 offset:12416
    ds_read_b64_tr_b16 v[168:169], v22 offset:12416
    ds_read_b64_tr_b16 v[172:173], v19 offset:12544
    ds_read_b64_tr_b16 v[176:177], v20 offset:12544
    ds_read_b64_tr_b16 v[180:181], v21 offset:12544
    ds_read_b64_tr_b16 v[184:185], v22 offset:12544
    ds_read_b64_tr_b16 v[142:143], v19 offset:18432
    ds_read_b64_tr_b16 v[146:147], v20 offset:18432
    ds_read_b64_tr_b16 v[150:151], v21 offset:18432
    ds_read_b64_tr_b16 v[154:155], v22 offset:18432
    ds_read_b64_tr_b16 v[158:159], v19 offset:18560
    ds_read_b64_tr_b16 v[162:163], v20 offset:18560
    ds_read_b64_tr_b16 v[166:167], v21 offset:18560
    ds_read_b64_tr_b16 v[170:171], v22 offset:18560
    ds_read_b64_tr_b16 v[174:175], v19 offset:18688
    ds_read_b64_tr_b16 v[178:179], v20 offset:18688
    ds_read_b64_tr_b16 v[182:183], v21 offset:18688
    ds_read_b64_tr_b16 v[186:187], v22 offset:18688
    s_add_u32 m0, s55, 3072
    s_add_u32 s0, s57, 3072
    s_waitcnt vmcnt(8)
    buffer_load_dwordx4 v11, s[24:27], s0 offen offset:0 nt lds
    s_waitcnt lgkmcnt(0)
    v_mfma_f32_16x16x32_bf16 v[92:95], v[140:143], v[188:191], 0
    v_mfma_f32_16x16x32_bf16 v[96:99], v[144:147], v[188:191], 0
    v_mfma_f32_16x16x32_bf16 v[100:103], v[148:151], v[188:191], 0
    v_mfma_f32_16x16x32_bf16 v[104:107], v[152:155], v[188:191], 0
    v_mfma_f32_16x16x32_bf16 v[108:111], v[156:159], v[188:191], 0
    v_mfma_f32_16x16x32_bf16 v[112:115], v[160:163], v[188:191], 0
    s_mov_b32 s75, 143360
    s_add_u32 m0, s55, 6144
    s_waitcnt vmcnt(8)
    buffer_load_dwordx4 v14, s[32:35], s75 offen offset:0 lds
    v_mfma_f32_16x16x32_bf16 v[116:119], v[164:167], v[188:191], 0
    v_mfma_f32_16x16x32_bf16 v[120:123], v[168:171], v[188:191], 0
    v_mfma_f32_16x16x32_bf16 v[124:127], v[172:175], v[188:191], 0
    v_mfma_f32_16x16x32_bf16 v[128:131], v[176:179], v[188:191], 0
    v_mfma_f32_16x16x32_bf16 v[132:135], v[180:183], v[188:191], 0
    v_mfma_f32_16x16x32_bf16 v[136:139], v[184:187], v[188:191], 0
    s_waitcnt vmcnt(8)
    buffer_load_dwordx4 v15, s[32:35], s75 offen offset:1024 lds
    s_add_u32 m0, s55, 3072
    s_waitcnt vmcnt(8)
    buffer_load_dwordx4 v12, s[24:27], s0 offen offset:1024 nt lds
    s_waitcnt vmcnt(8)
    buffer_load_dwordx4 v13, s[24:27], s0 offen offset:2048 nt lds
    s_add_u32 s57, s57, 24576
    s_sub_u32 s0, s57, 393216
    s_min_u32 s57, s57, s0
    ds_read_b64_tr_b16 a[120:121], v25 offset:30720
    ds_read_b64_tr_b16 a[124:125], v25 offset:30752
    ds_read_b64_tr_b16 a[128:129], v25 offset:30784
    ds_read_b64_tr_b16 a[132:133], v25 offset:30816
    ds_read_b64_tr_b16 a[136:137], v25 offset:30848
    ds_read_b64_tr_b16 a[140:141], v25 offset:30880
    ds_read_b64_tr_b16 a[144:145], v25 offset:30912
    ds_read_b64_tr_b16 a[148:149], v25 offset:30944
    ds_read_b64_tr_b16 a[152:153], v25 offset:30976
    ds_read_b64_tr_b16 a[156:157], v25 offset:31008
    s_add_u32 m0, s55, 6144
    s_waitcnt vmcnt(8)
    buffer_load_dwordx4 v16, s[32:35], s75 offen offset:2048 lds
    ds_read_b64_tr_b16 v[140:141], v19 offset:24576
    ds_read_b64_tr_b16 v[144:145], v20 offset:24576
    ds_read_b64_tr_b16 v[148:149], v21 offset:24576
    ds_read_b64_tr_b16 v[152:153], v22 offset:24576
    ds_read_b64_tr_b16 v[156:157], v19 offset:24704
    ds_read_b64_tr_b16 v[160:161], v20 offset:24704
    ds_read_b64_tr_b16 v[164:165], v21 offset:24704
    ds_read_b64_tr_b16 v[168:169], v22 offset:24704
    ds_read_b64_tr_b16 v[172:173], v19 offset:24832
    ds_read_b64_tr_b16 v[176:177], v20 offset:24832
    ds_read_b64_tr_b16 v[180:181], v21 offset:24832
    ds_read_b64_tr_b16 v[184:185], v22 offset:24832
    s_add_u32 m0, s55, 18432
    s_waitcnt vmcnt(8)
    buffer_load_dwordx4 v11, s[24:27], s57 offen offset:0 nt lds
    s_waitcnt vmcnt(8)
    buffer_load_dwordx4 v12, s[24:27], s57 offen offset:1024 nt lds
    s_waitcnt vmcnt(8)
    buffer_load_dwordx4 v13, s[24:27], s57 offen offset:2048 nt lds
    s_add_u32 m0, s55, 6144
    s_waitcnt vmcnt(8)
    buffer_load_dwordx4 v17, s[32:35], s75 offen offset:3072 lds
    s_add_u32 m0, s55, 21504
    s_add_u32 s0, s57, 3072
    s_waitcnt vmcnt(8)
    buffer_load_dwordx4 v11, s[24:27], s0 offen offset:0 nt lds
    s_waitcnt vmcnt(8)
    buffer_load_dwordx4 v12, s[24:27], s0 offen offset:1024 nt lds
    s_add_u32 m0, s55, 10240
    s_waitcnt vmcnt(8)
    buffer_load_dwordx4 v18, s[32:35], s75 offen offset:0 lds
    s_add_u32 m0, s55, 21504
    s_waitcnt vmcnt(8)
    buffer_load_dwordx4 v13, s[24:27], s0 offen offset:2048 nt lds
    s_add_u32 s57, s57, 24576
    s_sub_u32 s0, s57, 393216
    s_min_u32 s57, s57, s0
    ds_read_b64_tr_b16 v[142:143], v19 offset:0
    ds_read_b64_tr_b16 v[146:147], v20 offset:0
    ds_read_b64_tr_b16 v[150:151], v21 offset:0
    ds_read_b64_tr_b16 v[154:155], v22 offset:0
    ds_read_b64_tr_b16 v[158:159], v19 offset:128
    ds_read_b64_tr_b16 v[162:163], v20 offset:128
    ds_read_b64_tr_b16 v[166:167], v21 offset:128
    ds_read_b64_tr_b16 v[170:171], v22 offset:128
    ds_read_b64_tr_b16 v[174:175], v19 offset:256
    ds_read_b64_tr_b16 v[178:179], v20 offset:256
    ds_read_b64_tr_b16 v[182:183], v21 offset:256
    ds_read_b64_tr_b16 v[186:187], v22 offset:256
    s_add_u32 m0, s55, 12288
    s_waitcnt vmcnt(8)
    buffer_load_dwordx4 v11, s[24:27], s57 offen offset:0 nt lds
    s_waitcnt lgkmcnt(0)
    v_mfma_f32_16x16x32_bf16 v[92:95], v[140:143], v[192:195], v[92:95]
    v_mfma_f32_16x16x32_bf16 v[96:99], v[144:147], v[192:195], v[96:99]
    v_mfma_f32_16x16x32_bf16 v[100:103], v[148:151], v[192:195], v[100:103]
    v_mfma_f32_16x16x32_bf16 v[104:107], v[152:155], v[192:195], v[104:107]
    v_mfma_f32_16x16x32_bf16 v[108:111], v[156:159], v[192:195], v[108:111]
    v_mfma_f32_16x16x32_bf16 v[112:115], v[160:163], v[192:195], v[112:115]
    s_mov_b32 s75, 163840
    s_add_u32 m0, s55, 24576
    s_waitcnt vmcnt(8)
    buffer_load_dwordx4 v14, s[32:35], s75 offen offset:0 lds
    v_mfma_f32_16x16x32_bf16 v[116:119], v[164:167], v[192:195], v[116:119]
    v_mfma_f32_16x16x32_bf16 v[120:123], v[168:171], v[192:195], v[120:123]
    v_mfma_f32_16x16x32_bf16 v[124:127], v[172:175], v[192:195], v[124:127]
    v_mfma_f32_16x16x32_bf16 v[128:131], v[176:179], v[192:195], v[128:131]
    v_mfma_f32_16x16x32_bf16 v[132:135], v[180:183], v[192:195], v[132:135]
    v_mfma_f32_16x16x32_bf16 v[136:139], v[184:187], v[192:195], v[136:139]
    s_add_u32 m0, s55, 12288
    s_waitcnt vmcnt(8)
    buffer_load_dwordx4 v12, s[24:27], s57 offen offset:1024 nt lds
    s_waitcnt vmcnt(8)
    buffer_load_dwordx4 v13, s[24:27], s57 offen offset:2048 nt lds
    s_add_u32 m0, s55, 15360
    s_add_u32 s0, s57, 3072
    s_waitcnt vmcnt(8)
    buffer_load_dwordx4 v11, s[24:27], s0 offen offset:0 nt lds
    s_add_u32 m0, s55, 24576
    s_waitcnt vmcnt(8)
    buffer_load_dwordx4 v15, s[32:35], s75 offen offset:1024 lds
    s_add_u32 m0, s55, 15360
    s_waitcnt vmcnt(8)
    buffer_load_dwordx4 v12, s[24:27], s0 offen offset:1024 nt lds
    s_waitcnt vmcnt(8)
    buffer_load_dwordx4 v13, s[24:27], s0 offen offset:2048 nt lds
    s_add_u32 s57, s57, 24576
    s_sub_u32 s0, s57, 393216
    s_min_u32 s57, s57, s0
    ds_read_b64_tr_b16 a[122:123], v25 offset:6144
    ds_read_b64_tr_b16 a[126:127], v25 offset:6176
    ds_read_b64_tr_b16 a[130:131], v25 offset:6208
    ds_read_b64_tr_b16 a[134:135], v25 offset:6240
    ds_read_b64_tr_b16 a[138:139], v25 offset:6272
    ds_read_b64_tr_b16 a[142:143], v25 offset:6304
    ds_read_b64_tr_b16 a[146:147], v25 offset:6336
    ds_read_b64_tr_b16 a[150:151], v25 offset:6368
    ds_read_b64_tr_b16 a[154:155], v25 offset:6400
    ds_read_b64_tr_b16 a[158:159], v25 offset:6432
    s_add_u32 m0, s55, 24576
    s_waitcnt vmcnt(8)
    buffer_load_dwordx4 v16, s[32:35], s75 offen offset:2048 lds
    ds_read_b64_tr_b16 v[140:141], v19 offset:18432
    ds_read_b64_tr_b16 v[144:145], v20 offset:18432
    ds_read_b64_tr_b16 v[148:149], v21 offset:18432
    ds_read_b64_tr_b16 v[152:153], v22 offset:18432
    ds_read_b64_tr_b16 v[156:157], v19 offset:18560
    ds_read_b64_tr_b16 v[160:161], v20 offset:18560
    ds_read_b64_tr_b16 v[164:165], v21 offset:18560
    ds_read_b64_tr_b16 v[168:169], v22 offset:18560
    ds_read_b64_tr_b16 v[172:173], v19 offset:18688
    ds_read_b64_tr_b16 v[176:177], v20 offset:18688
    ds_read_b64_tr_b16 v[180:181], v21 offset:18688
    ds_read_b64_tr_b16 v[184:185], v22 offset:18688
    s_add_u32 m0, s55, 30720
    s_waitcnt vmcnt(8)
    buffer_load_dwordx4 v11, s[24:27], s57 offen offset:0 nt lds
    s_waitcnt vmcnt(8)
    buffer_load_dwordx4 v12, s[24:27], s57 offen offset:1024 nt lds
    s_waitcnt vmcnt(8)
    buffer_load_dwordx4 v13, s[24:27], s57 offen offset:2048 nt lds
    s_add_u32 m0, s55, 24576
    s_waitcnt vmcnt(8)
    buffer_load_dwordx4 v17, s[32:35], s75 offen offset:3072 lds
    s_add_u32 m0, s55, 33792
    s_add_u32 s0, s57, 3072
    s_waitcnt vmcnt(8)
    buffer_load_dwordx4 v11, s[24:27], s0 offen offset:0 nt lds
    s_waitcnt vmcnt(8)
    buffer_load_dwordx4 v12, s[24:27], s0 offen offset:1024 nt lds
    s_add_u32 m0, s55, 28672
    s_waitcnt vmcnt(8)
    buffer_load_dwordx4 v18, s[32:35], s75 offen offset:0 lds
    s_add_u32 m0, s55, 33792
    s_waitcnt vmcnt(8)
    buffer_load_dwordx4 v13, s[24:27], s0 offen offset:2048 nt lds
    s_add_u32 s57, s57, 24576
    s_sub_u32 s0, s57, 393216
    s_min_u32 s57, s57, s0
    ds_read_b64_tr_b16 v[142:143], v19 offset:12288
    ds_read_b64_tr_b16 v[146:147], v20 offset:12288
    ds_read_b64_tr_b16 v[150:151], v21 offset:12288
    ds_read_b64_tr_b16 v[154:155], v22 offset:12288
    ds_read_b64_tr_b16 v[158:159], v19 offset:12416
    ds_read_b64_tr_b16 v[162:163], v20 offset:12416
    ds_read_b64_tr_b16 v[166:167], v21 offset:12416
    ds_read_b64_tr_b16 v[170:171], v22 offset:12416
    ds_read_b64_tr_b16 v[174:175], v19 offset:12544
    ds_read_b64_tr_b16 v[178:179], v20 offset:12544
    ds_read_b64_tr_b16 v[182:183], v21 offset:12544
    ds_read_b64_tr_b16 v[186:187], v22 offset:12544
    s_add_u32 m0, s55, 0
    s_waitcnt vmcnt(8)
    buffer_load_dwordx4 v11, s[24:27], s57 offen offset:0 nt lds
    s_waitcnt lgkmcnt(0)
    v_mfma_f32_16x16x32_bf16 v[92:95], v[140:143], v[196:199], v[92:95]
    v_mfma_f32_16x16x32_bf16 v[96:99], v[144:147], v[196:199], v[96:99]
    v_mfma_f32_16x16x32_bf16 v[100:103], v[148:151], v[196:199], v[100:103]
    v_mfma_f32_16x16x32_bf16 v[104:107], v[152:155], v[196:199], v[104:107]
    v_mfma_f32_16x16x32_bf16 v[108:111], v[156:159], v[196:199], v[108:111]
    v_mfma_f32_16x16x32_bf16 v[112:115], v[160:163], v[196:199], v[112:115]
    s_mov_b32 s75, 184320
    s_add_u32 m0, s55, 12288
    s_waitcnt vmcnt(8)
    buffer_load_dwordx4 v14, s[32:35], s75 offen offset:0 lds
    v_mfma_f32_16x16x32_bf16 v[116:119], v[164:167], v[196:199], v[116:119]
    v_mfma_f32_16x16x32_bf16 v[120:123], v[168:171], v[196:199], v[120:123]
    v_mfma_f32_16x16x32_bf16 v[124:127], v[172:175], v[196:199], v[124:127]
    v_mfma_f32_16x16x32_bf16 v[128:131], v[176:179], v[196:199], v[128:131]
    v_mfma_f32_16x16x32_bf16 v[132:135], v[180:183], v[196:199], v[132:135]
    v_mfma_f32_16x16x32_bf16 v[136:139], v[184:187], v[196:199], v[136:139]
    s_add_u32 m0, s55, 0
    s_waitcnt vmcnt(8)
    buffer_load_dwordx4 v12, s[24:27], s57 offen offset:1024 nt lds
    s_waitcnt vmcnt(8)
    buffer_load_dwordx4 v13, s[24:27], s57 offen offset:2048 nt lds
    s_add_u32 m0, s55, 3072
    s_add_u32 s0, s57, 3072
    s_waitcnt vmcnt(8)
    buffer_load_dwordx4 v11, s[24:27], s0 offen offset:0 nt lds
    s_add_u32 m0, s55, 12288
    s_waitcnt vmcnt(8)
    buffer_load_dwordx4 v15, s[32:35], s75 offen offset:1024 lds
    s_add_u32 m0, s55, 3072
    s_waitcnt vmcnt(8)
    buffer_load_dwordx4 v12, s[24:27], s0 offen offset:1024 nt lds
    s_waitcnt vmcnt(8)
    buffer_load_dwordx4 v13, s[24:27], s0 offen offset:2048 nt lds
    s_add_u32 s57, s57, 24576
    s_sub_u32 s0, s57, 393216
    s_min_u32 s57, s57, s0
    ds_read_b64_tr_b16 a[160:161], v25 offset:24576
    ds_read_b64_tr_b16 a[164:165], v25 offset:24608
    ds_read_b64_tr_b16 a[168:169], v25 offset:24640
    ds_read_b64_tr_b16 a[172:173], v25 offset:24672
    ds_read_b64_tr_b16 a[176:177], v25 offset:24704
    ds_read_b64_tr_b16 a[180:181], v25 offset:24736
    ds_read_b64_tr_b16 a[184:185], v25 offset:24768
    ds_read_b64_tr_b16 a[188:189], v25 offset:24800
    ds_read_b64_tr_b16 a[192:193], v25 offset:24832
    ds_read_b64_tr_b16 a[196:197], v25 offset:24864
    s_add_u32 m0, s55, 12288
    s_waitcnt vmcnt(8)
    buffer_load_dwordx4 v16, s[32:35], s75 offen offset:2048 lds
    ds_read_b64_tr_b16 v[140:141], v19 offset:30720
    ds_read_b64_tr_b16 v[144:145], v20 offset:30720
    ds_read_b64_tr_b16 v[148:149], v21 offset:30720
    ds_read_b64_tr_b16 v[152:153], v22 offset:30720
    ds_read_b64_tr_b16 v[156:157], v19 offset:30848
    ds_read_b64_tr_b16 v[160:161], v20 offset:30848
    ds_read_b64_tr_b16 v[164:165], v21 offset:30848
    ds_read_b64_tr_b16 v[168:169], v22 offset:30848
    ds_read_b64_tr_b16 v[172:173], v19 offset:30976
    ds_read_b64_tr_b16 v[176:177], v20 offset:30976
    ds_read_b64_tr_b16 v[180:181], v21 offset:30976
    ds_read_b64_tr_b16 v[184:185], v22 offset:30976
    s_add_u32 m0, s55, 18432
    s_waitcnt vmcnt(8)
    buffer_load_dwordx4 v11, s[24:27], s57 offen offset:0 nt lds
    s_waitcnt vmcnt(8)
    buffer_load_dwordx4 v12, s[24:27], s57 offen offset:1024 nt lds
    s_waitcnt vmcnt(8)
    buffer_load_dwordx4 v13, s[24:27], s57 offen offset:2048 nt lds
    s_add_u32 m0, s55, 12288
    s_waitcnt vmcnt(8)
    buffer_load_dwordx4 v17, s[32:35], s75 offen offset:3072 lds
    s_add_u32 m0, s55, 21504
    s_add_u32 s0, s57, 3072
    s_waitcnt vmcnt(8)
    buffer_load_dwordx4 v11, s[24:27], s0 offen offset:0 nt lds
    s_waitcnt vmcnt(8)
    buffer_load_dwordx4 v12, s[24:27], s0 offen offset:1024 nt lds
    s_add_u32 m0, s55, 16384
    s_waitcnt vmcnt(8)
    buffer_load_dwordx4 v18, s[32:35], s75 offen offset:0 lds
    s_add_u32 m0, s55, 21504
    s_waitcnt vmcnt(8)
    buffer_load_dwordx4 v13, s[24:27], s0 offen offset:2048 nt lds
    s_add_u32 s57, s57, 24576
    s_sub_u32 s0, s57, 393216
    s_min_u32 s57, s57, s0
    ds_read_b64_tr_b16 v[142:143], v19 offset:0
    ds_read_b64_tr_b16 v[146:147], v20 offset:0
    ds_read_b64_tr_b16 v[150:151], v21 offset:0
    ds_read_b64_tr_b16 v[154:155], v22 offset:0
    ds_read_b64_tr_b16 v[158:159], v19 offset:128
    ds_read_b64_tr_b16 v[162:163], v20 offset:128
    ds_read_b64_tr_b16 v[166:167], v21 offset:128
    ds_read_b64_tr_b16 v[170:171], v22 offset:128
    ds_read_b64_tr_b16 v[174:175], v19 offset:256
    ds_read_b64_tr_b16 v[178:179], v20 offset:256
    ds_read_b64_tr_b16 v[182:183], v21 offset:256
    ds_read_b64_tr_b16 v[186:187], v22 offset:256
    s_add_u32 m0, s55, 6144
    s_waitcnt vmcnt(8)
    buffer_load_dwordx4 v11, s[24:27], s57 offen offset:0 nt lds
    s_waitcnt lgkmcnt(0)
    v_mfma_f32_16x16x32_bf16 v[92:95], v[140:143], v[200:203], v[92:95]
    v_mfma_f32_16x16x32_bf16 v[96:99], v[144:147], v[200:203], v[96:99]
    v_mfma_f32_16x16x32_bf16 v[100:103], v[148:151], v[200:203], v[100:103]
    v_mfma_f32_16x16x32_bf16 v[104:107], v[152:155], v[200:203], v[104:107]
    v_mfma_f32_16x16x32_bf16 v[108:111], v[156:159], v[200:203], v[108:111]
    v_mfma_f32_16x16x32_bf16 v[112:115], v[160:163], v[200:203], v[112:115]
    s_mov_b32 s75, 204800
    s_add_u32 m0, s55, 24576
    s_waitcnt vmcnt(8)
    buffer_load_dwordx4 v14, s[32:35], s75 offen offset:0 lds
    v_mfma_f32_16x16x32_bf16 v[116:119], v[164:167], v[200:203], v[116:119]
    v_mfma_f32_16x16x32_bf16 v[120:123], v[168:171], v[200:203], v[120:123]
    v_mfma_f32_16x16x32_bf16 v[124:127], v[172:175], v[200:203], v[124:127]
    v_mfma_f32_16x16x32_bf16 v[128:131], v[176:179], v[200:203], v[128:131]
    v_mfma_f32_16x16x32_bf16 v[132:135], v[180:183], v[200:203], v[132:135]
    v_mfma_f32_16x16x32_bf16 v[136:139], v[184:187], v[200:203], v[136:139]
    s_add_u32 m0, s55, 6144
    s_waitcnt vmcnt(8)
    buffer_load_dwordx4 v12, s[24:27], s57 offen offset:1024 nt lds
    s_waitcnt vmcnt(8)
    buffer_load_dwordx4 v13, s[24:27], s57 offen offset:2048 nt lds
    s_add_u32 m0, s55, 9216
    s_add_u32 s0, s57, 3072
    s_waitcnt vmcnt(8)
    buffer_load_dwordx4 v11, s[24:27], s0 offen offset:0 nt lds
    s_add_u32 m0, s55, 24576
    s_waitcnt vmcnt(8)
    buffer_load_dwordx4 v15, s[32:35], s75 offen offset:1024 lds
    s_add_u32 m0, s55, 9216
    s_waitcnt vmcnt(8)
    buffer_load_dwordx4 v12, s[24:27], s0 offen offset:1024 nt lds
    s_waitcnt vmcnt(8)
    buffer_load_dwordx4 v13, s[24:27], s0 offen offset:2048 nt lds
    s_add_u32 s57, s57, 24576
    s_sub_u32 s0, s57, 393216
    s_min_u32 s57, s57, s0
    ds_read_b64_tr_b16 a[162:163], v25 offset:12288
    ds_read_b64_tr_b16 a[166:167], v25 offset:12320
    ds_read_b64_tr_b16 a[170:171], v25 offset:12352
    ds_read_b64_tr_b16 a[174:175], v25 offset:12384
    ds_read_b64_tr_b16 a[178:179], v25 offset:12416
    ds_read_b64_tr_b16 a[182:183], v25 offset:12448
    ds_read_b64_tr_b16 a[186:187], v25 offset:12480
    ds_read_b64_tr_b16 a[190:191], v25 offset:12512
    ds_read_b64_tr_b16 a[194:195], v25 offset:12544
    ds_read_b64_tr_b16 a[198:199], v25 offset:12576
    s_add_u32 m0, s55, 24576
    s_waitcnt vmcnt(8)
    buffer_load_dwordx4 v16, s[32:35], s75 offen offset:2048 lds
    ds_read_b64_tr_b16 v[140:141], v19 offset:18432
    ds_read_b64_tr_b16 v[144:145], v20 offset:18432
    ds_read_b64_tr_b16 v[148:149], v21 offset:18432
    ds_read_b64_tr_b16 v[152:153], v22 offset:18432
    ds_read_b64_tr_b16 v[156:157], v19 offset:18560
    ds_read_b64_tr_b16 v[160:161], v20 offset:18560
    ds_read_b64_tr_b16 v[164:165], v21 offset:18560
    ds_read_b64_tr_b16 v[168:169], v22 offset:18560
    ds_read_b64_tr_b16 v[172:173], v19 offset:18688
    ds_read_b64_tr_b16 v[176:177], v20 offset:18688
    ds_read_b64_tr_b16 v[180:181], v21 offset:18688
    ds_read_b64_tr_b16 v[184:185], v22 offset:18688
    s_add_u32 m0, s55, 30720
    s_waitcnt vmcnt(8)
    buffer_load_dwordx4 v11, s[24:27], s57 offen offset:0 nt lds
    s_waitcnt vmcnt(8)
    buffer_load_dwordx4 v12, s[24:27], s57 offen offset:1024 nt lds
    s_waitcnt vmcnt(8)
    buffer_load_dwordx4 v13, s[24:27], s57 offen offset:2048 nt lds
    s_add_u32 m0, s55, 24576
    s_waitcnt vmcnt(8)
    buffer_load_dwordx4 v17, s[32:35], s75 offen offset:3072 lds
    s_add_u32 m0, s55, 33792
    s_add_u32 s0, s57, 3072
    s_waitcnt vmcnt(8)
    buffer_load_dwordx4 v11, s[24:27], s0 offen offset:0 nt lds
    s_waitcnt vmcnt(8)
    buffer_load_dwordx4 v12, s[24:27], s0 offen offset:1024 nt lds
    s_add_u32 m0, s55, 28672
    s_waitcnt vmcnt(8)
    buffer_load_dwordx4 v18, s[32:35], s75 offen offset:0 lds
    s_add_u32 m0, s55, 33792
    s_waitcnt vmcnt(8)
    buffer_load_dwordx4 v13, s[24:27], s0 offen offset:2048 nt lds
    s_add_u32 s57, s57, 24576
    s_sub_u32 s0, s57, 393216
    s_min_u32 s57, s57, s0
    ds_read_b64_tr_b16 v[142:143], v19 offset:6144
    ds_read_b64_tr_b16 v[146:147], v20 offset:6144
    ds_read_b64_tr_b16 v[150:151], v21 offset:6144
    ds_read_b64_tr_b16 v[154:155], v22 offset:6144
    ds_read_b64_tr_b16 v[158:159], v19 offset:6272
    ds_read_b64_tr_b16 v[162:163], v20 offset:6272
    ds_read_b64_tr_b16 v[166:167], v21 offset:6272
    ds_read_b64_tr_b16 v[170:171], v22 offset:6272
    ds_read_b64_tr_b16 v[174:175], v19 offset:6400
    ds_read_b64_tr_b16 v[178:179], v20 offset:6400
    ds_read_b64_tr_b16 v[182:183], v21 offset:6400
    ds_read_b64_tr_b16 v[186:187], v22 offset:6400
    s_add_u32 m0, s55, 0
    s_waitcnt vmcnt(8)
    buffer_load_dwordx4 v11, s[24:27], s57 offen offset:0 nt lds
    s_waitcnt lgkmcnt(0)
    v_mfma_f32_16x16x32_bf16 v[92:95], v[140:143], v[204:207], v[92:95]
    v_mfma_f32_16x16x32_bf16 v[96:99], v[144:147], v[204:207], v[96:99]
    v_mfma_f32_16x16x32_bf16 v[100:103], v[148:151], v[204:207], v[100:103]
    v_mfma_f32_16x16x32_bf16 v[104:107], v[152:155], v[204:207], v[104:107]
    v_mfma_f32_16x16x32_bf16 v[108:111], v[156:159], v[204:207], v[108:111]
    v_mfma_f32_16x16x32_bf16 v[112:115], v[160:163], v[204:207], v[112:115]
    s_mov_b32 s75, 225280
    s_add_u32 m0, s55, 6144
    s_waitcnt vmcnt(8)
    buffer_load_dwordx4 v14, s[32:35], s75 offen offset:0 lds
    v_mfma_f32_16x16x32_bf16 v[116:119], v[164:167], v[204:207], v[116:119]
    v_mfma_f32_16x16x32_bf16 v[120:123], v[168:171], v[204:207], v[120:123]
    v_mfma_f32_16x16x32_bf16 v[124:127], v[172:175], v[204:207], v[124:127]
    v_mfma_f32_16x16x32_bf16 v[128:131], v[176:179], v[204:207], v[128:131]
    v_mfma_f32_16x16x32_bf16 v[132:135], v[180:183], v[204:207], v[132:135]
    v_mfma_f32_16x16x32_bf16 v[136:139], v[184:187], v[204:207], v[136:139]
    s_add_u32 m0, s55, 0
    s_waitcnt vmcnt(8)
    buffer_load_dwordx4 v12, s[24:27], s57 offen offset:1024 nt lds
    s_waitcnt vmcnt(8)
    buffer_load_dwordx4 v13, s[24:27], s57 offen offset:2048 nt lds
    s_add_u32 m0, s55, 3072
    s_add_u32 s0, s57, 3072
    s_waitcnt vmcnt(8)
    buffer_load_dwordx4 v11, s[24:27], s0 offen offset:0 nt lds
    s_add_u32 m0, s55, 6144
    s_waitcnt vmcnt(8)
    buffer_load_dwordx4 v15, s[32:35], s75 offen offset:1024 lds
    s_add_u32 m0, s55, 3072
    s_waitcnt vmcnt(8)
    buffer_load_dwordx4 v12, s[24:27], s0 offen offset:1024 nt lds
    s_waitcnt vmcnt(8)
    buffer_load_dwordx4 v13, s[24:27], s0 offen offset:2048 nt lds
    s_add_u32 s57, s57, 24576
    s_sub_u32 s0, s57, 393216
    s_min_u32 s57, s57, s0
    ds_read_b64_tr_b16 a[200:201], v25 offset:24576
    ds_read_b64_tr_b16 a[204:205], v25 offset:24608
    ds_read_b64_tr_b16 a[208:209], v25 offset:24640
    ds_read_b64_tr_b16 a[212:213], v25 offset:24672
    ds_read_b64_tr_b16 a[216:217], v25 offset:24704
    ds_read_b64_tr_b16 a[220:221], v25 offset:24736
    ds_read_b64_tr_b16 a[224:225], v25 offset:24768
    ds_read_b64_tr_b16 a[228:229], v25 offset:24800
    ds_read_b64_tr_b16 a[232:233], v25 offset:24832
    ds_read_b64_tr_b16 a[236:237], v25 offset:24864
    s_add_u32 m0, s55, 6144
    s_waitcnt vmcnt(8)
    buffer_load_dwordx4 v16, s[32:35], s75 offen offset:2048 lds
    ds_read_b64_tr_b16 v[140:141], v19 offset:30720
    ds_read_b64_tr_b16 v[144:145], v20 offset:30720
    ds_read_b64_tr_b16 v[148:149], v21 offset:30720
    ds_read_b64_tr_b16 v[152:153], v22 offset:30720
    ds_read_b64_tr_b16 v[156:157], v19 offset:30848
    ds_read_b64_tr_b16 v[160:161], v20 offset:30848
    ds_read_b64_tr_b16 v[164:165], v21 offset:30848
    ds_read_b64_tr_b16 v[168:169], v22 offset:30848
    ds_read_b64_tr_b16 v[172:173], v19 offset:30976
    ds_read_b64_tr_b16 v[176:177], v20 offset:30976
    ds_read_b64_tr_b16 v[180:181], v21 offset:30976
    ds_read_b64_tr_b16 v[184:185], v22 offset:30976
    s_mov_b32 s8, s57
    s_add_u32 s9, s8, 24576
    s_sub_u32 s0, s9, 393216
    s_min_u32 s9, s9, s0
    s_add_u32 s10, s9, 24576
    s_sub_u32 s0, s10, 393216
    s_min_u32 s10, s10, s0
    s_add_u32 s11, s10, 24576
    s_sub_u32 s0, s11, 393216
    s_min_u32 s11, s11, s0
    s_add_u32 m0, s55, 12288
    s_waitcnt vmcnt(8)
    buffer_load_dwordx4 v27, s[24:27], s8 offen offset:0 nt lds
    s_waitcnt vmcnt(8)
    buffer_load_dwordx4 v27, s[24:27], s8 offen offset:3072 nt lds
    s_add_u32 m0, s55, 18432
    s_waitcnt vmcnt(8)
    buffer_load_dwordx4 v27, s[24:27], s9 offen offset:0 nt lds
    s_add_u32 m0, s55, 6144
    s_waitcnt vmcnt(8)
    buffer_load_dwordx4 v17, s[32:35], s75 offen offset:3072 lds
    s_add_u32 m0, s55, 18432
    s_waitcnt vmcnt(8)
    buffer_load_dwordx4 v27, s[24:27], s9 offen offset:3072 nt lds
    s_waitcnt lgkmcnt(0)
    s_add_u32 m0, s55, 24576
    s_waitcnt vmcnt(8)
    buffer_load_dwordx4 v27, s[24:27], s10 offen offset:0 nt lds
    s_add_u32 m0, s55, 10240
    s_waitcnt vmcnt(8)
    buffer_load_dwordx4 v18, s[32:35], s75 offen offset:0 lds
    s_add_u32 m0, s55, 24576
    s_waitcnt vmcnt(8)
    buffer_load_dwordx4 v27, s[24:27], s10 offen offset:3072 nt lds
    ds_read_b64_tr_b16 v[142:143], v19 offset:0
    ds_read_b64_tr_b16 v[146:147], v20 offset:0
    ds_read_b64_tr_b16 v[150:151], v21 offset:0
    ds_read_b64_tr_b16 v[154:155], v22 offset:0
    ds_read_b64_tr_b16 v[158:159], v19 offset:128
    ds_read_b64_tr_b16 v[162:163], v20 offset:128
    ds_read_b64_tr_b16 v[166:167], v21 offset:128
    ds_read_b64_tr_b16 v[170:171], v22 offset:128
    ds_read_b64_tr_b16 v[174:175], v19 offset:256
    ds_read_b64_tr_b16 v[178:179], v20 offset:256
    ds_read_b64_tr_b16 v[182:183], v21 offset:256
    ds_read_b64_tr_b16 v[186:187], v22 offset:256
    s_add_u32 m0, s55, 30720
    s_waitcnt vmcnt(8)
    buffer_load_dwordx4 v27, s[24:27], s11 offen offset:0 nt lds
    s_waitcnt lgkmcnt(0)
    v_mfma_f32_16x16x32_bf16 v[92:95], v[140:143], v[208:211], v[92:95]
    v_mfma_f32_16x16x32_bf16 v[96:99], v[144:147], v[208:211], v[96:99]
    v_mfma_f32_16x16x32_bf16 v[100:103], v[148:151], v[208:211], v[100:103]
    v_mfma_f32_16x16x32_bf16 v[104:107], v[152:155], v[208:211], v[104:107]
    v_mfma_f32_16x16x32_bf16 v[108:111], v[156:159], v[208:211], v[108:111]
    v_mfma_f32_16x16x32_bf16 v[112:115], v[160:163], v[208:211], v[112:115]
    s_waitcnt vmcnt(8)
    buffer_load_dwordx4 v27, s[24:27], s11 offen offset:3072 nt lds
    v_mfma_f32_16x16x32_bf16 v[116:119], v[164:167], v[208:211], v[116:119]
    v_mfma_f32_16x16x32_bf16 v[120:123], v[168:171], v[208:211], v[120:123]
    v_mfma_f32_16x16x32_bf16 v[124:127], v[172:175], v[208:211], v[124:127]
    v_mfma_f32_16x16x32_bf16 v[128:131], v[176:179], v[208:211], v[128:131]
    v_mfma_f32_16x16x32_bf16 v[132:135], v[180:183], v[208:211], v[132:135]
    v_mfma_f32_16x16x32_bf16 v[136:139], v[184:187], v[208:211], v[136:139]
    s_add_u32 m0, s55, 13184
    s_waitcnt vmcnt(8)
    buffer_load_dwordx4 v27, s[24:27], s8 offen offset:128 nt lds
    s_waitcnt vmcnt(8)
    buffer_load_dwordx4 v27, s[24:27], s8 offen offset:3200 nt lds
    s_add_u32 m0, s55, 19328
    s_waitcnt vmcnt(8)
    buffer_load_dwordx4 v27, s[24:27], s9 offen offset:128 nt lds
    s_waitcnt vmcnt(8)
    buffer_load_dwordx4 v27, s[24:27], s9 offen offset:3200 nt lds
    s_add_u32 m0, s55, 25472
    s_waitcnt vmcnt(8)
    buffer_load_dwordx4 v27, s[24:27], s10 offen offset:128 nt lds
    s_waitcnt vmcnt(8)
    buffer_load_dwordx4 v27, s[24:27], s10 offen offset:3200 nt lds
    ds_read_b64_tr_b16 a[202:203], v25 offset:6144
    ds_read_b64_tr_b16 a[206:207], v25 offset:6176
    ds_read_b64_tr_b16 a[210:211], v25 offset:6208
    ds_read_b64_tr_b16 a[214:215], v25 offset:6240
    ds_read_b64_tr_b16 a[218:219], v25 offset:6272
    ds_read_b64_tr_b16 a[222:223], v25 offset:6304
    ds_read_b64_tr_b16 a[226:227], v25 offset:6336
    ds_read_b64_tr_b16 a[230:231], v25 offset:6368
    ds_read_b64_tr_b16 a[234:235], v25 offset:6400
    ds_read_b64_tr_b16 a[238:239], v25 offset:6432
    s_add_u32 m0, s55, 31616
    s_nop 0
    buffer_load_dwordx4 v27, s[24:27], s11 offen offset:128 nt lds
    s_waitcnt vmcnt(9)
    buffer_load_dwordx4 v27, s[24:27], s11 offen offset:3200 nt lds
    s_add_u32 m0, s55, 14080
    s_waitcnt vmcnt(9)
    buffer_load_dwordx4 v27, s[24:27], s8 offen offset:256 nt lds
    s_waitcnt vmcnt(9)
    buffer_load_dwordx4 v27, s[24:27], s8 offen offset:3328 nt lds
    s_add_u32 m0, s55, 20224
    s_waitcnt vmcnt(9)
    buffer_load_dwordx4 v27, s[24:27], s9 offen offset:256 nt lds
    s_waitcnt vmcnt(9)
    buffer_load_dwordx4 v27, s[24:27], s9 offen offset:3328 nt lds
    s_branch L_tail
L_G1:
    s_add_u32 m0, s55, 6144
    s_nop 0
    buffer_load_dwordx4 v5, s[20:23], s57 offen offset:0 nt lds
    buffer_load_dwordx4 v6, s[20:23], s57 offen offset:1024 nt lds
    buffer_load_dwordx4 v7, s[20:23], s57 offen offset:2048 nt lds
    s_add_u32 m0, s55, 9216
    s_add_u32 s0, s57, 3072
    buffer_load_dwordx4 v8, s[20:23], s0 offen offset:0 nt lds
    v_lshrrev_b32 v46, 4, v1
    v_and_b32 v41, 3, v1
    v_mul_u32_u24 v40, 320, v41
    v_lshl_add_u32 v40, v46, 3, v40
    v_add_u32 v26, s3, v40
    v_lshl_add_u32 v41, v41, 3, s55
    v_bfe_u32 v40, v1, 2, 3
    v_lshl_add_u32 v41, v40, 7, v41
    v_lshrrev_b32 v40, 5, v1
    v_mul_u32_u24 v40, 3072, v40
    v_add_u32 v41, v40, v41
    v_bfe_u32 v42, v1, 3, 2
    v_xor_b32 v43, 0, v42
    v_lshl_add_u32 v252, v43, 5, v41
    v_xor_b32 v43, 1, v42
    v_lshl_add_u32 v253, v43, 5, v41
    v_xor_b32 v43, 2, v42
    v_lshl_add_u32 v254, v43, 5, v41
    v_xor_b32 v43, 3, v42
    v_lshl_add_u32 v255, v43, 5, v41
    s_waitcnt vmcnt(11)
    buffer_load_dwordx4 v9, s[20:23], s0 offen offset:1024 nt lds
    s_waitcnt vmcnt(11)
    buffer_load_dwordx4 v10, s[20:23], s0 offen offset:2048 nt lds
    s_add_u32 s57, s57, 24576
    s_sub_u32 s0, s57, 393216
    s_min_u32 s57, s57, s0
    s_add_u32 m0, s55, 12288
    s_waitcnt vmcnt(11)
    buffer_load_dwordx4 v5, s[20:23], s57 offen offset:0 nt lds
    s_waitcnt vmcnt(11)
    buffer_load_dwordx4 v6, s[20:23], s57 offen offset:1024 nt lds
    s_waitcnt vmcnt(11)
    buffer_load_dwordx4 v7, s[20:23], s57 offen offset:2048 nt lds
    s_add_u32 m0, s55, 15360
    s_add_u32 s0, s57, 3072
    s_waitcnt vmcnt(11)
    buffer_load_dwordx4 v8, s[20:23], s0 offen offset:0 nt lds
    s_waitcnt vmcnt(11)
    buffer_load_dwordx4 v9, s[20:23], s0 offen offset:1024 nt lds
    s_waitcnt vmcnt(11)
    buffer_load_dwordx4 v10, s[20:23], s0 offen offset:2048 nt lds
    s_add_u32 s57, s57, 24576
    s_sub_u32 s0, s57, 393216
    s_min_u32 s57, s57, s0
    s_add_u32 m0, s55, 18432
    s_waitcnt vmcnt(11)
    buffer_load_dwordx4 v2, s[28:31], s74 offen offset:0 lds
    s_waitcnt vmcnt(11)
    buffer_load_dwordx4 v3, s[28:31], s74 offen offset:1024 lds
    s_waitcnt vmcnt(11)
    buffer_load_dwordx4 v4, s[28:31], s74 offen offset:2048 lds
    s_add_u32 m0, s55, 21504
    s_add_u32 s75, s74, 98304
    s_waitcnt vmcnt(11)
    buffer_load_dwordx4 v2, s[28:31], s75 offen offset:0 lds
    s_waitcnt vmcnt(11)
    buffer_load_dwordx4 v3, s[28:31], s75 offen offset:1024 lds
    s_waitcnt vmcnt(11)
    buffer_load_dwordx4 v4, s[28:31], s75 offen offset:2048 lds
    s_add_u32 s74, s74, 196608
    s_cmp_eq_u32 s74, 7864320
    s_cselect_b32 s74, 0, s74
    s_add_u32 m0, s55, 24576
    s_waitcnt vmcnt(11)
    buffer_load_dwordx4 v2, s[28:31], s74 offen offset:0 lds
    s_waitcnt vmcnt(11)
    buffer_load_dwordx4 v3, s[28:31], s74 offen offset:1024 lds
    s_waitcnt vmcnt(11)
    buffer_load_dwordx4 v4, s[28:31], s74 offen offset:2048 lds
    s_add_u32 m0, s55, 27648
    s_add_u32 s75, s74, 98304
    s_waitcnt vmcnt(11)
    buffer_load_dwordx4 v2, s[28:31], s75 offen offset:0 lds
    s_waitcnt vmcnt(11)
    buffer_load_dwordx4 v3, s[28:31], s75 offen offset:1024 lds
    s_waitcnt vmcnt(11)
    buffer_load_dwordx4 v4, s[28:31], s75 offen offset:2048 lds
    s_add_u32 s74, s74, 196608
    s_cmp_eq_u32 s74, 7864320
    s_cselect_b32 s74, 0, s74
    s_add_u32 m0, s55, 30720
    s_waitcnt vmcnt(11)
    buffer_load_dwordx4 v2, s[28:31], s74 offen offset:0 lds
    s_waitcnt vmcnt(11)
    buffer_load_dwordx4 v3, s[28:31], s74 offen offset:1024 lds
    s_waitcnt vmcnt(11)
    buffer_load_dwordx4 v4, s[28:31], s74 offen offset:2048 lds
    s_add_u32 m0, s55, 33792
    s_add_u32 s75, s74, 98304
    s_waitcnt vmcnt(11)
    buffer_load_dwordx4 v2, s[28:31], s75 offen offset:0 lds
    s_waitcnt vmcnt(11)
    buffer_load_dwordx4 v3, s[28:31], s75 offen offset:1024 lds
    s_waitcnt vmcnt(11)
    buffer_load_dwordx4 v4, s[28:31], s75 offen offset:2048 lds
    s_add_u32 s74, s74, 196608
    s_cmp_eq_u32 s74, 7864320
    s_cselect_b32 s74, 0, s74
    ds_read_b64_tr_b16 v[140:141], v252 offset:18432
    ds_read_b64_tr_b16 v[144:145], v253 offset:18432
    ds_read_b64_tr_b16 v[148:149], v254 offset:18432
    ds_read_b64_tr_b16 v[152:153], v255 offset:18432
    ds_read_b64_tr_b16 v[156:157], v252 offset:19456
    ds_read_b64_tr_b16 v[160:161], v253 offset:19456
    ds_read_b64_tr_b16 v[164:165], v254 offset:19456
    ds_read_b64_tr_b16 v[168:169], v255 offset:19456
    ds_read_b64_tr_b16 v[172:173], v252 offset:20480
    ds_read_b64_tr_b16 v[176:177], v253 offset:20480
    ds_read_b64_tr_b16 v[180:181], v254 offset:20480
    ds_read_b64_tr_b16 v[184:185], v255 offset:20480
    s_waitcnt lgkmcnt(0)
    s_add_u32 m0, s55, 18432
    s_waitcnt vmcnt(11)
    buffer_load_dwordx4 v2, s[28:31], s74 offen offset:0 lds
    s_waitcnt vmcnt(11)
    buffer_load_dwordx4 v3, s[28:31], s74 offen offset:1024 lds
    s_waitcnt vmcnt(11)
    buffer_load_dwordx4 v4, s[28:31], s74 offen offset:2048 lds
    s_add_u32 m0, s55, 21504
    s_add_u32 s75, s74, 98304
    s_waitcnt vmcnt(11)
    buffer_load_dwordx4 v2, s[28:31], s75 offen offset:0 lds
    s_waitcnt vmcnt(11)
    buffer_load_dwordx4 v3, s[28:31], s75 offen offset:1024 lds
    s_waitcnt vmcnt(11)
    buffer_load_dwordx4 v4, s[28:31], s75 offen offset:2048 lds
    s_add_u32 s74, s74, 196608
    s_cmp_eq_u32 s74, 7864320
    s_cselect_b32 s74, 0, s74
    ds_read_b64 v[48:49], v26 offset:0
    ds_read_b64 v[50:51], v26 offset:32
    ds_read_b64 v[52:53], v26 offset:64
    ds_read_b64 v[54:55], v26 offset:96
    ds_read_b64 v[56:57], v26 offset:128
    ds_read_b64 v[58:59], v26 offset:160
    ds_read_b64 v[60:61], v26 offset:192
    ds_read_b64 v[62:63], v26 offset:224
    ds_read_b64 v[64:65], v26 offset:256
    ds_read_b64 v[66:67], v26 offset:288
    ds_read_b64_tr_b16 v[142:143], v252 offset:24576
    ds_read_b64_tr_b16 v[146:147], v253 offset:24576
    ds_read_b64_tr_b16 v[150:151], v254 offset:24576
    ds_read_b64_tr_b16 v[154:155], v255 offset:24576
    ds_read_b64_tr_b16 v[158:159], v252 offset:25600
    ds_read_b64_tr_b16 v[162:163], v253 offset:25600
    ds_read_b64_tr_b16 v[166:167], v254 offset:25600
    ds_read_b64_tr_b16 v[170:171], v255 offset:25600
    ds_read_b64_tr_b16 v[174:175], v252 offset:26624
    ds_read_b64_tr_b16 v[178:179], v253 offset:26624
    ds_read_b64_tr_b16 v[182:183], v254 offset:26624
    ds_read_b64_tr_b16 v[186:187], v255 offset:26624
    s_waitcnt lgkmcnt(0)
    v_mfma_f32_16x16x32_bf16 v[92:95], v[140:143], v[48:51], 0
    v_mfma_f32_16x16x32_bf16 v[96:99], v[144:147], v[48:51], 0
    s_add_u32 m0, s55, 24576
    s_waitcnt vmcnt(11)
    buffer_load_dwordx4 v2, s[28:31], s74 offen offset:0 lds
    v_mfma_f32_16x16x32_bf16 v[100:103], v[148:151], v[48:51], 0
    v_mfma_f32_16x16x32_bf16 v[104:107], v[152:155], v[48:51], 0
    s_waitcnt vmcnt(11)
    buffer_load_dwordx4 v3, s[28:31], s74 offen offset:1024 lds
    v_mfma_f32_16x16x32_bf16 v[108:111], v[156:159], v[48:51], 0
    v_mfma_f32_16x16x32_bf16 v[112:115], v[160:163], v[48:51], 0
    s_waitcnt vmcnt(11)
    buffer_load_dwordx4 v4, s[28:31], s74 offen offset:2048 lds
    v_mfma_f32_16x16x32_bf16 v[116:119], v[164:167], v[48:51], 0
    v_mfma_f32_16x16x32_bf16 v[120:123], v[168:171], v[48:51], 0
    s_add_u32 m0, s55, 27648
    s_add_u32 s75, s74, 98304
    s_waitcnt vmcnt(11)
    buffer_load_dwordx4 v2, s[28:31], s75 offen offset:0 lds
    v_mfma_f32_16x16x32_bf16 v[124:127], v[172:175], v[48:51], 0
    v_mfma_f32_16x16x32_bf16 v[128:131], v[176:179], v[48:51], 0
    s_waitcnt vmcnt(11)
    buffer_load_dwordx4 v3, s[28:31], s75 offen offset:1024 lds
    v_mfma_f32_16x16x32_bf16 v[132:135], v[180:183], v[48:51], 0
    v_mfma_f32_16x16x32_bf16 v[136:139], v[184:187], v[48:51], 0
    s_waitcnt vmcnt(11)
    buffer_load_dwordx4 v4, s[28:31], s75 offen offset:2048 lds
    s_add_u32 s74, s74, 196608
    s_cmp_eq_u32 s74, 7864320
    s_cselect_b32 s74, 0, s74
    ds_read_b64_tr_b16 v[140:141], v252 offset:30720
    ds_read_b64_tr_b16 v[144:145], v253 offset:30720
    ds_read_b64_tr_b16 v[148:149], v254 offset:30720
    ds_read_b64_tr_b16 v[152:153], v255 offset:30720
    ds_read_b64_tr_b16 v[156:157], v252 offset:31744
    ds_read_b64_tr_b16 v[160:161], v253 offset:31744
    ds_read_b64_tr_b16 v[164:165], v254 offset:31744
    ds_read_b64_tr_b16 v[168:169], v255 offset:31744
    ds_read_b64_tr_b16 v[172:173], v252 offset:32768
    ds_read_b64_tr_b16 v[176:177], v253 offset:32768
    ds_read_b64_tr_b16 v[180:181], v254 offset:32768
    ds_read_b64_tr_b16 v[184:185], v255 offset:32768
    s_waitcnt lgkmcnt(0)
    s_add_u32 m0, s55, 30720
    s_waitcnt vmcnt(11)
    buffer_load_dwordx4 v2, s[28:31], s74 offen offset:0 lds
    s_waitcnt vmcnt(11)
    buffer_load_dwordx4 v3, s[28:31], s74 offen offset:1024 lds
    s_waitcnt vmcnt(11)
    buffer_load_dwordx4 v4, s[28:31], s74 offen offset:2048 lds
    s_add_u32 m0, s55, 33792
    s_add_u32 s75, s74, 98304
    s_waitcnt vmcnt(11)
    buffer_load_dwordx4 v2, s[28:31], s75 offen offset:0 lds
    s_waitcnt vmcnt(11)
    buffer_load_dwordx4 v3, s[28:31], s75 offen offset:1024 lds
    s_waitcnt vmcnt(11)
    buffer_load_dwordx4 v4, s[28:31], s75 offen offset:2048 lds
    s_add_u32 s74, s74, 196608
    s_cmp_eq_u32 s74, 7864320
    s_cselect_b32 s74, 0, s74
    ds_read_b64_tr_b16 v[142:143], v252 offset:18432
    ds_read_b64_tr_b16 v[146:147], v253 offset:18432
    ds_read_b64_tr_b16 v[150:151], v254 offset:18432
    ds_read_b64_tr_b16 v[154:155], v255 offset:18432
    ds_read_b64_tr_b16 v[158:159], v252 offset:19456
    ds_read_b64_tr_b16 v[162:163], v253 offset:19456
    ds_read_b64_tr_b16 v[166:167], v254 offset:19456
    ds_read_b64_tr_b16 v[170:171], v255 offset:19456
    ds_read_b64_tr_b16 v[174:175], v252 offset:20480
    ds_read_b64_tr_b16 v[178:179], v253 offset:20480
    ds_read_b64_tr_b16 v[182:183], v254 offset:20480
    ds_read_b64_tr_b16 v[186:187], v255 offset:20480
    s_waitcnt lgkmcnt(0)
    v_mfma_f32_16x16x32_bf16 v[92:95], v[140:143], v[52:55], v[92:95]
    v_mfma_f32_16x16x32_bf16 v[96:99], v[144:147], v[52:55], v[96:99]
    s_add_u32 m0, s55, 18432
    s_waitcnt vmcnt(11)
    buffer_load_dwordx4 v2, s[28:31], s74 offen offset:0 lds
    v_mfma_f32_16x16x32_bf16 v[100:103], v[148:151], v[52:55], v[100:103]
    v_mfma_f32_16x16x32_bf16 v[104:107], v[152:155], v[52:55], v[104:107]
    s_waitcnt vmcnt(11)
    buffer_load_dwordx4 v3, s[28:31], s74 offen offset:1024 lds
    v_mfma_f32_16x16x32_bf16 v[108:111], v[156:159], v[52:55], v[108:111]
    v_mfma_f32_16x16x32_bf16 v[112:115], v[160:163], v[52:55], v[112:115]
    s_waitcnt vmcnt(11)
    buffer_load_dwordx4 v4, s[28:31], s74 offen offset:2048 lds
    v_mfma_f32_16x16x32_bf16 v[116:119], v[164:167], v[52:55], v[116:119]
    v_mfma_f32_16x16x32_bf16 v[120:123], v[168:171], v[52:55], v[120:123]
    s_add_u32 m0, s55, 21504
    s_add_u32 s75, s74, 98304
    s_waitcnt vmcnt(11)
    buffer_load_dwordx4 v2, s[28:31], s75 offen offset:0 lds
    v_mfma_f32_16x16x32_bf16 v[124:127], v[172:175], v[52:55], v[124:127]
    v_mfma_f32_16x16x32_bf16 v[128:131], v[176:179], v[52:55], v[128:131]
    s_waitcnt vmcnt(11)
    buffer_load_dwordx4 v3, s[28:31], s75 offen offset:1024 lds
    v_mfma_f32_16x16x32_bf16 v[132:135], v[180:183], v[52:55], v[132:135]
    v_mfma_f32_16x16x32_bf16 v[136:139], v[184:187], v[52:55], v[136:139]
    s_waitcnt vmcnt(11)
    buffer_load_dwordx4 v4, s[28:31], s75 offen offset:2048 lds
    s_add_u32 s74, s74, 196608
    s_cmp_eq_u32 s74, 7864320
    s_cselect_b32 s74, 0, s74
    ds_read_b64_tr_b16 v[140:141], v252 offset:24576
    ds_read_b64_tr_b16 v[144:145], v253 offset:24576
    ds_read_b64_tr_b16 v[148:149], v254 offset:24576
    ds_read_b64_tr_b16 v[152:153], v255 offset:24576
    ds_read_b64_tr_b16 v[156:157], v252 offset:25600
    ds_read_b64_tr_b16 v[160:161], v253 offset:25600
    ds_read_b64_tr_b16 v[164:165], v254 offset:25600
    ds_read_b64_tr_b16 v[168:169], v255 offset:25600
    ds_read_b64_tr_b16 v[172:173], v252 offset:26624
    ds_read_b64_tr_b16 v[176:177], v253 offset:26624
    ds_read_b64_tr_b16 v[180:181], v254 offset:26624
    ds_read_b64_tr_b16 v[184:185], v255 offset:26624
    s_waitcnt lgkmcnt(0)
    s_add_u32 m0, s55, 24576
    s_waitcnt vmcnt(11)
    buffer_load_dwordx4 v2, s[28:31], s74 offen offset:0 lds
    s_waitcnt vmcnt(11)
    buffer_load_dwordx4 v3, s[28:31], s74 offen offset:1024 lds
    s_waitcnt vmcnt(11)
    buffer_load_dwordx4 v4, s[28:31], s74 offen offset:2048 lds
    s_add_u32 m0, s55, 27648
    s_add_u32 s75, s74, 98304
    s_waitcnt vmcnt(11)
    buffer_load_dwordx4 v2, s[28:31], s75 offen offset:0 lds
    s_waitcnt vmcnt(11)
    buffer_load_dwordx4 v3, s[28:31], s75 offen offset:1024 lds
    s_waitcnt vmcnt(11)
    buffer_load_dwordx4 v4, s[28:31], s75 offen offset:2048 lds
    s_add_u32 s74, s74, 196608
    s_cmp_eq_u32 s74, 7864320
    s_cselect_b32 s74, 0, s74
    ds_read_b64_tr_b16 v[142:143], v252 offset:30720
    ds_read_b64_tr_b16 v[146:147], v253 offset:30720
    ds_read_b64_tr_b16 v[150:151], v254 offset:30720
    ds_read_b64_tr_b16 v[154:155], v255 offset:30720
    ds_read_b64_tr_b16 v[158:159], v252 offset:31744
    ds_read_b64_tr_b16 v[162:163], v253 offset:31744
    ds_read_b64_tr_b16 v[166:167], v254 offset:31744
    ds_read_b64_tr_b16 v[170:171], v255 offset:31744
    ds_read_b64_tr_b16 v[174:175], v252 offset:32768
    ds_read_b64_tr_b16 v[178:179], v253 offset:32768
    ds_read_b64_tr_b16 v[182:183], v254 offset:32768
    ds_read_b64_tr_b16 v[186:187], v255 offset:32768
    s_waitcnt lgkmcnt(0)
    v_mfma_f32_16x16x32_bf16 v[92:95], v[140:143], v[56:59], v[92:95]
    v_mfma_f32_16x16x32_bf16 v[96:99], v[144:147], v[56:59], v[96:99]
    s_add_u32 m0, s55, 30720
    s_waitcnt vmcnt(11)
    buffer_load_dwordx4 v2, s[28:31], s74 offen offset:0 lds
    v_mfma_f32_16x16x32_bf16 v[100:103], v[148:151], v[56:59], v[100:103]
    v_mfma_f32_16x16x32_bf16 v[104:107], v[152:155], v[56:59], v[104:107]
    s_waitcnt vmcnt(11)
    buffer_load_dwordx4 v3, s[28:31], s74 offen offset:1024 lds
    v_mfma_f32_16x16x32_bf16 v[108:111], v[156:159], v[56:59], v[108:111]
    v_mfma_f32_16x16x32_bf16 v[112:115], v[160:163], v[56:59], v[112:115]
    s_waitcnt vmcnt(11)
    buffer_load_dwordx4 v4, s[28:31], s74 offen offset:2048 lds
    v_mfma_f32_16x16x32_bf16 v[116:119], v[164:167], v[56:59], v[116:119]
    v_mfma_f32_16x16x32_bf16 v[120:123], v[168:171], v[56:59], v[120:123]
    s_add_u32 m0, s55, 33792
    s_add_u32 s75, s74, 98304
    s_waitcnt vmcnt(11)
    buffer_load_dwordx4 v2, s[28:31], s75 offen offset:0 lds
    v_mfma_f32_16x16x32_bf16 v[124:127], v[172:175], v[56:59], v[124:127]
    v_mfma_f32_16x16x32_bf16 v[128:131], v[176:179], v[56:59], v[128:131]
    s_waitcnt vmcnt(11)
    buffer_load_dwordx4 v3, s[28:31], s75 offen offset:1024 lds
    v_mfma_f32_16x16x32_bf16 v[132:135], v[180:183], v[56:59], v[132:135]
    v_mfma_f32_16x16x32_bf16 v[136:139], v[184:187], v[56:59], v[136:139]
    s_waitcnt vmcnt(11)
    buffer_load_dwordx4 v4, s[28:31], s75 offen offset:2048 lds
    s_add_u32 s74, s74, 196608
    s_cmp_eq_u32 s74, 7864320
    s_cselect_b32 s74, 0, s74
    ds_read_b64_tr_b16 v[140:141], v252 offset:18432
    ds_read_b64_tr_b16 v[144:145], v253 offset:18432
    ds_read_b64_tr_b16 v[148:149], v254 offset:18432
    ds_read_b64_tr_b16 v[152:153], v255 offset:18432
    ds_read_b64_tr_b16 v[156:157], v252 offset:19456
    ds_read_b64_tr_b16 v[160:161], v253 offset:19456
    ds_read_b64_tr_b16 v[164:165], v254 offset:19456
    ds_read_b64_tr_b16 v[168:169], v255 offset:19456
    ds_read_b64_tr_b16 v[172:173], v252 offset:20480
    ds_read_b64_tr_b16 v[176:177], v253 offset:20480
    ds_read_b64_tr_b16 v[180:181], v254 offset:20480
    ds_read_b64_tr_b16 v[184:185], v255 offset:20480
    s_waitcnt lgkmcnt(0)
    s_add_u32 m0, s55, 18432
    s_waitcnt vmcnt(11)
    buffer_load_dwordx4 v2, s[28:31], s74 offen offset:0 lds
    s_waitcnt vmcnt(11)
    buffer_load_dwordx4 v3, s[28:31], s74 offen offset:1024 lds
    s_waitcnt vmcnt(11)
    buffer_load_dwordx4 v4, s[28:31], s74 offen offset:2048 lds
    s_add_u32 m0, s55, 21504
    s_add_u32 s75, s74, 98304
    s_waitcnt vmcnt(11)
    buffer_load_dwordx4 v2, s[28:31], s75 offen offset:0 lds
    s_waitcnt vmcnt(11)
    buffer_load_dwordx4 v3, s[28:31], s75 offen offset:1024 lds
    s_waitcnt vmcnt(11)
    buffer_load_dwordx4 v4, s[28:31], s75 offen offset:2048 lds
    s_add_u32 s74, s74, 196608
    s_cmp_eq_u32 s74, 7864320
    s_cselect_b32 s74, 0, s74
    ds_read_b64_tr_b16 v[142:143], v252 offset:24576
    ds_read_b64_tr_b16 v[146:147], v253 offset:24576
    ds_read_b64_tr_b16 v[150:151], v254 offset:24576
    ds_read_b64_tr_b16 v[154:155], v255 offset:24576
    ds_read_b64_tr_b16 v[158:159], v252 offset:25600
    ds_read_b64_tr_b16 v[162:163], v253 offset:25600
    ds_read_b64_tr_b16 v[166:167], v254 offset:25600
    ds_read_b64_tr_b16 v[170:171], v255 offset:25600
    ds_read_b64_tr_b16 v[174:175], v252 offset:26624
    ds_read_b64_tr_b16 v[178:179], v253 offset:26624
    ds_read_b64_tr_b16 v[182:183], v254 offset:26624
    ds_read_b64_tr_b16 v[186:187], v255 offset:26624
    s_waitcnt lgkmcnt(0)
    v_mfma_f32_16x16x32_bf16 v[92:95], v[140:143], v[60:63], v[92:95]
    v_mfma_f32_16x16x32_bf16 v[96:99], v[144:147], v[60:63], v[96:99]
    s_add_u32 m0, s55, 24576
    s_waitcnt vmcnt(11)
    buffer_load_dwordx4 v5, s[20:23], s57 offen offset:0 nt lds
    v_mfma_f32_16x16x32_bf16 v[100:103], v[148:151], v[60:63], v[100:103]
    v_mfma_f32_16x16x32_bf16 v[104:107], v[152:155], v[60:63], v[104:107]
    s_waitcnt vmcnt(11)
    buffer_load_dwordx4 v6, s[20:23], s57 offen offset:1024 nt lds
    v_mfma_f32_16x16x32_bf16 v[108:111], v[156:159], v[60:63], v[108:111]
    v_mfma_f32_16x16x32_bf16 v[112:115], v[160:163], v[60:63], v[112:115]
    s_waitcnt vmcnt(11)
    buffer_load_dwordx4 v7, s[20:23], s57 offen offset:2048 nt lds
    v_mfma_f32_16x16x32_bf16 v[116:119], v[164:167], v[60:63], v[116:119]
    v_mfma_f32_16x16x32_bf16 v[120:123], v[168:171], v[60:63], v[120:123]
    s_add_u32 m0, s55, 27648
    s_add_u32 s0, s57, 3072
    s_waitcnt vmcnt(11)
    buffer_load_dwordx4 v8, s[20:23], s0 offen offset:0 nt lds
    v_mfma_f32_16x16x32_bf16 v[124:127], v[172:175], v[60:63], v[124:127]
    v_mfma_f32_16x16x32_bf16 v[128:131], v[176:179], v[60:63], v[128:131]
    s_waitcnt vmcnt(11)
    buffer_load_dwordx4 v9, s[20:23], s0 offen offset:1024 nt lds
    v_mfma_f32_16x16x32_bf16 v[132:135], v[180:183], v[60:63], v[132:135]
    v_mfma_f32_16x16x32_bf16 v[136:139], v[184:187], v[60:63], v[136:139]
    s_waitcnt vmcnt(11)
    buffer_load_dwordx4 v10, s[20:23], s0 offen offset:2048 nt lds
    s_add_u32 s57, s57, 24576
    s_sub_u32 s0, s57, 393216
    s_min_u32 s57, s57, s0
    v_lshlrev_b32 v44, 4, v1
    v_xor_b32 v40, v44, v5
    v_lshlrev_b32 v40, 1, v40
    v_xor_b32 v11, v44, v40
    v_xor_b32 v40, v44, v6
    v_lshlrev_b32 v40, 1, v40
    v_xor_b32 v12, v44, v40
    v_xor_b32 v40, v44, v7
    v_lshlrev_b32 v40, 1, v40
    v_xor_b32 v13, v44, v40
    v_lshrrev_b32 v40, 3, v1
    v_and_b32 v41, 6, v40
    v_xor_b32 v41, v41, v1
    v_and_b32 v41, 7, v41
    v_mul_u32_u24 v40, 384, v40
    v_lshl_add_u32 v27, v41, 4, v40
    v_add_u32 v41, 0, v1
    v_mul_u32_u24 v40, 3277, v41
    v_lshrrev_b32 v40, 16, v40
    v_mul_u32_u24 v42, 20, v40
    v_sub_u32 v41, v41, v42
    v_mul_u32_u24 v40, 1280, v40
    v_lshl_add_u32 v14, v41, 4, v40
    v_add_u32 v41, 64, v1
    v_mul_u32_u24 v40, 3277, v41
    v_lshrrev_b32 v40, 16, v40
    v_mul_u32_u24 v42, 20, v40
    v_sub_u32 v41, v41, v42
    v_mul_u32_u24 v40, 1280, v40
    v_lshl_add_u32 v15, v41, 4, v40
    v_subrev_u32 v15, 1024, v15
    v_add_u32 v41, 128, v1
    v_mul_u32_u24 v40, 3277, v41
    v_lshrrev_b32 v40, 16, v40
    v_mul_u32_u24 v42, 20, v40
    v_sub_u32 v41, v41, v42
    v_mul_u32_u24 v40, 1280, v40
    v_lshl_add_u32 v16, v41, 4, v40
    v_subrev_u32 v16, 2048, v16
    v_add_u32 v41, 192, v1
    v_mul_u32_u24 v40, 3277, v41
    v_lshrrev_b32 v40, 16, v40
    v_mul_u32_u24 v42, 20, v40
    v_sub_u32 v41, v41, v42
    v_mul_u32_u24 v40, 1280, v40
    v_lshl_add_u32 v17, v41, 4, v40
    v_subrev_u32 v17, 3072, v17
    v_add_u32 v41, 256, v1
    v_mul_u32_u24 v40, 3277, v41
    v_lshrrev_b32 v40, 16, v40
    v_mul_u32_u24 v42, 20, v40
    v_sub_u32 v41, v41, v42
    v_mul_u32_u24 v40, 1280, v40
    v_lshl_add_u32 v18, v41, 4, v40
    v_lshrrev_b32 v40, 2, v1
    v_and_b32 v41, 3, v1
    v_lshlrev_b32 v41, 3, v41
    v_add_u32 v41, s55, v41
    v_mul_u32_u24 v42, 320, v40
    v_add_u32 v25, v42, v41
    v_mul_u32_u24 v42, 384, v40
    v_add_u32 v41, v42, v41
    v_bfe_u32 v42, v1, 3, 2
    v_xor_b32 v43, 0, v42
    v_lshl_add_u32 v19, v43, 5, v41
    v_xor_b32 v43, 1, v42
    v_lshl_add_u32 v20, v43, 5, v41
    v_xor_b32 v43, 2, v42
    v_lshl_add_u32 v21, v43, 5, v41
    v_xor_b32 v43, 3, v42
    v_lshl_add_u32 v22, v43, 5, v41
    v_and_b32 v45, 15, v1
    v_lshrrev_b32 v46, 4, v1
    v_mul_u32_u24 v40, 384, v45
    v_add_u32 v40, s55, v40
    v_lshrrev_b32 v41, 1, v45
    v_xor_b32 v41, v41, v46
    v_lshl_add_u32 v23, v41, 4, v40
    v_xor_b32 v41, 4, v41
    v_lshl_add_u32 v24, v41, 4, v40
    v_mul_u32_u24 v40, 784, v45
    v_add_u32 v40, 147456, v40
    v_lshl_add_u32 v29, v46, 5, v40
    s_mul_i32 s58, s52, 3136
    v_lshl_add_u32 v28, v46, 4, v40
    v_add_u32 v28, s58, v28
    v_and_b32 v40, 3, v1
    v_lshlrev_b32 v40, 7, v40
    v_add_u32 v31, 160000, v40
    s_lshl_b32 s58, s52, 5
    v_lshl_add_u32 v30, v46, 3, v31
    v_add_u32 v30, s58, v30
    v_add_u32 v33, 147456, v44
    s_lshl_b32 s58, s52, 6
    v_add_u32 v32, s58, v33
    v_lshrrev_b32 v40, 5, v1
    v_and_b32 v41, 31, v1
    v_lshlrev_b32 v41, 4, v41
    v_lshl_add_u32 v34, v40, 14, v41
    v_lshlrev_b32 v41, 4, v45
    v_lshl_add_u32 v35, v40, 8, v41
    v_bfe_u32 v40, v1, 4, 1
    v_lshl_add_u32 v35, v40, 3, v35
    v_lshrrev_b32 v40, 3, v1
    v_and_b32 v41, 7, v1
    v_lshlrev_b32 v42, 4, v41
    v_lshl_add_u32 v36, v40, 9, v42
    v_mul_u32_u24 v40, 1280, v46
    v_lshl_add_u32 v37, v41, 1, v40
    s_lshl_b32 s58, s54, 7
    s_add_u32 s58, s58, 2621440
    v_mov_b32 v38, s58
    v_add_u32 v26, s55, v44
    s_mov_b32 s1, 0xfffff000
    s_mov_b32 s60, 0x3dd53b95
    s_mov_b32 s62, 0xf000f
    s_mov_b32 s63, 0xf000f
    s_mov_b32 s66, 0x550055
    s_mov_b32 s67, 0x550055
    s_mov_b32 s68, 4096
    s_mov_b32 s69, 8192
    s_mov_b32 s70, 12288
    s_mov_b32 s71, 32768
    s_mov_b32 s4, 65536
    s_mul_i32 s58, s53, 245760
    s_mul_i32 s59, s52, 320
    s_add_u32 s58, s58, s59
    s_add_u32 s32, s12, s58
    s_addc_u32 s33, s13, 0
    s_sub_u32 s34, 7864320, s58
    s_mov_b32 s35, 0x20000
    s_mul_i32 s58, s54, 20
    s_mul_i32 s59, s52, 5
    s_add_u32 s59, s58, s59
    s_lshl_b32 s59, s59, 5
    s_add_u32 s59, s59, s53
    s_lshl_b32 s59, s59, 9
    s_add_u32 s40, s18, s59
    s_addc_u32 s41, s19, 0
    s_sub_u32 s42, 2621440, s59
    s_mov_b32 s43, 0x20000
    s_add_u32 s58, s58, s53
    s_lshl_b32 s58, s58, 14
    s_lshl_b32 s59, s52, 7
    s_add_u32 s58, s58, s59
    s_add_u32 s44, s18, s58
    s_addc_u32 s45, s19, 0
    s_mov_b32 s46, 16384
    s_mov_b32 s47, 0x20000
    s_mul_i32 s58, s54, 5120
    s_lshl_b32 s59, s53, 6
    s_add_u32 s58, s58, s59
    s_lshl_b32 s59, s52, 4
    s_add_u32 s58, s58, s59
    s_add_u32 s48, s14, s58
    s_addc_u32 s49, s15, 0
    s_sub_u32 s50, 40960, s58
    s_mov_b32 s51, 0x20000
    global_load_dword v39, v38, s[18:19] sc1
    ds_read_b64_tr_b16 v[140:141], v252 offset:30720
    ds_read_b64_tr_b16 v[144:145], v253 offset:30720
    ds_read_b64_tr_b16 v[148:149], v254 offset:30720
    ds_read_b64_tr_b16 v[152:153], v255 offset:30720
    ds_read_b64_tr_b16 v[156:157], v252 offset:31744
    ds_read_b64_tr_b16 v[160:161], v253 offset:31744
    ds_read_b64_tr_b16 v[164:165], v254 offset:31744
    ds_read_b64_tr_b16 v[168:169], v255 offset:31744
    ds_read_b64_tr_b16 v[172:173], v252 offset:32768
    ds_read_b64_tr_b16 v[176:177], v253 offset:32768
    ds_read_b64_tr_b16 v[180:181], v254 offset:32768
    ds_read_b64_tr_b16 v[184:185], v255 offset:32768
    s_waitcnt lgkmcnt(0)
    s_add_u32 m0, s55, 30720
    s_waitcnt vmcnt(11)
    buffer_load_dwordx4 v5, s[20:23], s57 offen offset:0 nt lds
    s_waitcnt vmcnt(11)
    buffer_load_dwordx4 v6, s[20:23], s57 offen offset:1024 nt lds
    s_waitcnt vmcnt(11)
    buffer_load_dwordx4 v7, s[20:23], s57 offen offset:2048 nt lds
    s_add_u32 m0, s55, 33792
    s_add_u32 s0, s57, 3072
    s_waitcnt vmcnt(11)
    buffer_load_dwordx4 v8, s[20:23], s0 offen offset:0 nt lds
    s_waitcnt vmcnt(11)
    buffer_load_dwordx4 v9, s[20:23], s0 offen offset:1024 nt lds
    ds_read_b64_tr_b16 v[142:143], v252 offset:18432
    ds_read_b64_tr_b16 v[146:147], v253 offset:18432
    ds_read_b64_tr_b16 v[150:151], v254 offset:18432
    ds_read_b64_tr_b16 v[154:155], v255 offset:18432
    ds_read_b64_tr_b16 v[158:159], v252 offset:19456
    ds_read_b64_tr_b16 v[162:163], v253 offset:19456
    ds_read_b64_tr_b16 v[166:167], v254 offset:19456
    ds_read_b64_tr_b16 v[170:171], v255 offset:19456
    ds_read_b64_tr_b16 v[174:175], v252 offset:20480
    ds_read_b64_tr_b16 v[178:179], v253 offset:20480
    ds_read_b64_tr_b16 v[182:183], v254 offset:20480
    ds_read_b64_tr_b16 v[186:187], v255 offset:20480
    s_waitcnt lgkmcnt(0)
    v_mfma_f32_16x16x32_bf16 v[92:95], v[140:143], v[64:67], v[92:95]
    v_mfma_f32_16x16x32_bf16 v[96:99], v[144:147], v[64:67], v[96:99]
    s_waitcnt vmcnt(11)
    buffer_load_dwordx4 v10, s[20:23], s0 offen offset:2048 nt lds
    s_add_u32 s57, s57, 24576
    s_sub_u32 s0, s57, 393216
    s_min_u32 s57, s57, s0
    v_mfma_f32_16x16x32_bf16 v[100:103], v[148:151], v[64:67], v[100:103]
    v_mfma_f32_16x16x32_bf16 v[104:107], v[152:155], v[64:67], v[104:107]
    s_add_u32 m0, s55, 18432
    s_waitcnt vmcnt(11)
    buffer_load_dwordx4 v5, s[20:23], s57 offen offset:0 nt lds
    v_mfma_f32_16x16x32_bf16 v[108:111], v[156:159], v[64:67], v[108:111]
    v_mfma_f32_16x16x32_bf16 v[112:115], v[160:163], v[64:67], v[112:115]
    s_waitcnt vmcnt(11)
    buffer_load_dwordx4 v6, s[20:23], s57 offen offset:1024 nt lds
    v_mfma_f32_16x16x32_bf16 v[116:119], v[164:167], v[64:67], v[116:119]
    v_mfma_f32_16x16x32_bf16 v[120:123], v[168:171], v[64:67], v[120:123]
    s_waitcnt vmcnt(11)
    buffer_load_dwordx4 v7, s[20:23], s57 offen offset:2048 nt lds
    v_mfma_f32_16x16x32_bf16 v[124:127], v[172:175], v[64:67], v[124:127]
    v_mfma_f32_16x16x32_bf16 v[128:131], v[176:179], v[64:67], v[128:131]
    s_add_u32 m0, s55, 21504
    s_add_u32 s0, s57, 3072
    s_waitcnt vmcnt(11)
    buffer_load_dwordx4 v8, s[20:23], s0 offen offset:0 nt lds
    v_mfma_f32_16x16x32_bf16 v[132:135], v[180:183], v[64:67], v[132:135]
    v_mfma_f32_16x16x32_bf16 v[136:139], v[184:187], v[64:67], v[136:139]
    s_waitcnt vmcnt(11)
    buffer_load_dwordx4 v9, s[20:23], s0 offen offset:1024 nt lds
    s_mov_b64 exec, s[62:63]
    ds_write_b128 v28, v[92:95] offset:0
    ds_write_b128 v28, v[96:99] offset:64
    ds_write_b128 v28, v[100:103] offset:128
    ds_write_b128 v28, v[104:107] offset:192
    ds_write_b128 v28, v[108:111] offset:256
    ds_write_b128 v28, v[112:115] offset:320
    ds_write_b128 v28, v[116:119] offset:384
    ds_write_b128 v28, v[120:123] offset:448
    ds_write_b128 v28, v[124:127] offset:512
    ds_write_b128 v28, v[128:131] offset:576
    ds_write_b128 v28, v[132:135] offset:640
    ds_write_b128 v28, v[136:139] offset:704
    s_mov_b64 exec, -1
    s_waitcnt lgkmcnt(0)
    s_barrier
    ds_read_b128 v[188:191], v29 offset:0
    ds_read_b128 v[192:195], v29 offset:16
    ds_read_b128 v[196:199], v29 offset:128
    ds_read_b128 v[200:203], v29 offset:144
    ds_read_b128 v[204:207], v29 offset:256
    ds_read_b128 v[208:211], v29 offset:272
    ds_read_b128 v[212:215], v29 offset:384
    ds_read_b128 v[216:219], v29 offset:400
    ds_read_b128 v[220:223], v29 offset:512
    ds_read_b128 v[224:227], v29 offset:528
    ds_read_b128 v[228:231], v29 offset:640
    ds_read_b128 v[232:235], v29 offset:656
    s_waitcnt lgkmcnt(0)
    v_add_f32_dpp v188, v188, v188 row_ror:4 row_mask:0xf bank_mask:0xf
    v_add_f32_dpp v189, v189, v189 row_ror:4 row_mask:0xf bank_mask:0xf
    v_add_f32_dpp v190, v190, v190 row_ror:4 row_mask:0xf bank_mask:0xf
    v_add_f32_dpp v191, v191, v191 row_ror:4 row_mask:0xf bank_mask:0xf
    v_add_f32_dpp v192, v192, v192 row_ror:4 row_mask:0xf bank_mask:0xf
    v_add_f32_dpp v193, v193, v193 row_ror:4 row_mask:0xf bank_mask:0xf
    v_add_f32_dpp v194, v194, v194 row_ror:4 row_mask:0xf bank_mask:0xf
    v_add_f32_dpp v195, v195, v195 row_ror:4 row_mask:0xf bank_mask:0xf
    v_add_f32_dpp v196, v196, v196 row_ror:4 row_mask:0xf bank_mask:0xf
    v_add_f32_dpp v197, v197, v197 row_ror:4 row_mask:0xf bank_mask:0xf
    v_add_f32_dpp v198, v198, v198 row_ror:4 row_mask:0xf bank_mask:0xf
    v_add_f32_dpp v199, v199, v199 row_ror:4 row_mask:0xf bank_mask:0xf
    v_add_f32_dpp v200, v200, v200 row_ror:4 row_mask:0xf bank_mask:0xf
    v_add_f32_dpp v201, v201, v201 row_ror:4 row_mask:0xf bank_mask:0xf
    v_add_f32_dpp v202, v202, v202 row_ror:4 row_mask:0xf bank_mask:0xf
    v_add_f32_dpp v203, v203, v203 row_ror:4 row_mask:0xf bank_mask:0xf
    v_add_f32_dpp v204, v204, v204 row_ror:4 row_mask:0xf bank_mask:0xf
    v_add_f32_dpp v205, v205, v205 row_ror:4 row_mask:0xf bank_mask:0xf
    v_add_f32_dpp v206, v206, v206 row_ror:4 row_mask:0xf bank_mask:0xf
    v_add_f32_dpp v207, v207, v207 row_ror:4 row_mask:0xf bank_mask:0xf
    v_add_f32_dpp v208, v208, v208 row_ror:4 row_mask:0xf bank_mask:0xf
    v_add_f32_dpp v209, v209, v209 row_ror:4 row_mask:0xf bank_mask:0xf
    v_add_f32_dpp v210, v210, v210 row_ror:4 row_mask:0xf bank_mask:0xf
    v_add_f32_dpp v211, v211, v211 row_ror:4 row_mask:0xf bank_mask:0xf
    s_waitcnt vmcnt(11)
    buffer_load_dwordx4 v10, s[20:23], s0 offen offset:2048 nt lds
    s_add_u32 s57, s57, 24576
    s_sub_u32 s0, s57, 393216
    s_min_u32 s57, s57, s0
    v_add_f32_dpp v212, v212, v212 row_ror:4 row_mask:0xf bank_mask:0xf
    v_add_f32_dpp v213, v213, v213 row_ror:4 row_mask:0xf bank_mask:0xf
    v_add_f32_dpp v214, v214, v214 row_ror:4 row_mask:0xf bank_mask:0xf
    v_add_f32_dpp v215, v215, v215 row_ror:4 row_mask:0xf bank_mask:0xf
    v_add_f32_dpp v216, v216, v216 row_ror:4 row_mask:0xf bank_mask:0xf
    v_add_f32_dpp v217, v217, v217 row_ror:4 row_mask:0xf bank_mask:0xf
    v_add_f32_dpp v218, v218, v218 row_ror:4 row_mask:0xf bank_mask:0xf
    v_add_f32_dpp v219, v219, v219 row_ror:4 row_mask:0xf bank_mask:0xf
    v_add_f32_dpp v220, v220, v220 row_ror:4 row_mask:0xf bank_mask:0xf
    v_add_f32_dpp v221, v221, v221 row_ror:4 row_mask:0xf bank_mask:0xf
    v_add_f32_dpp v222, v222, v222 row_ror:4 row_mask:0xf bank_mask:0xf
    v_add_f32_dpp v223, v223, v223 row_ror:4 row_mask:0xf bank_mask:0xf
    v_add_f32_dpp v224, v224, v224 row_ror:4 row_mask:0xf bank_mask:0xf
    v_add_f32_dpp v225, v225, v225 row_ror:4 row_mask:0xf bank_mask:0xf
    v_add_f32_dpp v226, v226, v226 row_ror:4 row_mask:0xf bank_mask:0xf
    v_add_f32_dpp v227, v227, v227 row_ror:4 row_mask:0xf bank_mask:0xf
    v_add_f32_dpp v228, v228, v228 row_ror:4 row_mask:0xf bank_mask:0xf
    v_add_f32_dpp v229, v229, v229 row_ror:4 row_mask:0xf bank_mask:0xf
    v_add_f32_dpp v230, v230, v230 row_ror:4 row_mask:0xf bank_mask:0xf
    v_add_f32_dpp v231, v231, v231 row_ror:4 row_mask:0xf bank_mask:0xf
    v_add_f32_dpp v232, v232, v232 row_ror:4 row_mask:0xf bank_mask:0xf
    v_add_f32_dpp v233, v233, v233 row_ror:4 row_mask:0xf bank_mask:0xf
    v_add_f32_dpp v234, v234, v234 row_ror:4 row_mask:0xf bank_mask:0xf
    v_add_f32_dpp v235, v235, v235 row_ror:4 row_mask:0xf bank_mask:0xf
    v_add_f32_dpp v188, v188, v188 row_ror:8 row_mask:0xf bank_mask:0xf
    v_add_f32_dpp v189, v189, v189 row_ror:8 row_mask:0xf bank_mask:0xf
    v_add_f32_dpp v190, v190, v190 row_ror:8 row_mask:0xf bank_mask:0xf
    v_add_f32_dpp v191, v191, v191 row_ror:8 row_mask:0xf bank_mask:0xf
    v_add_f32_dpp v192, v192, v192 row_ror:8 row_mask:0xf bank_mask:0xf
    v_add_f32_dpp v193, v193, v193 row_ror:8 row_mask:0xf bank_mask:0xf
    v_add_f32_dpp v194, v194, v194 row_ror:8 row_mask:0xf bank_mask:0xf
    v_add_f32_dpp v195, v195, v195 row_ror:8 row_mask:0xf bank_mask:0xf
    v_add_f32_dpp v196, v196, v196 row_ror:8 row_mask:0xf bank_mask:0xf
    v_add_f32_dpp v197, v197, v197 row_ror:8 row_mask:0xf bank_mask:0xf
    v_add_f32_dpp v198, v198, v198 row_ror:8 row_mask:0xf bank_mask:0xf
    v_add_f32_dpp v199, v199, v199 row_ror:8 row_mask:0xf bank_mask:0xf
    v_add_f32_dpp v200, v200, v200 row_ror:8 row_mask:0xf bank_mask:0xf
    v_add_f32_dpp v201, v201, v201 row_ror:8 row_mask:0xf bank_mask:0xf
    v_add_f32_dpp v202, v202, v202 row_ror:8 row_mask:0xf bank_mask:0xf
    v_add_f32_dpp v203, v203, v203 row_ror:8 row_mask:0xf bank_mask:0xf
    v_add_f32_dpp v204, v204, v204 row_ror:8 row_mask:0xf bank_mask:0xf
    v_add_f32_dpp v205, v205, v205 row_ror:8 row_mask:0xf bank_mask:0xf
    v_add_f32_dpp v206, v206, v206 row_ror:8 row_mask:0xf bank_mask:0xf
    v_add_f32_dpp v207, v207, v207 row_ror:8 row_mask:0xf bank_mask:0xf
    v_add_f32_dpp v208, v208, v208 row_ror:8 row_mask:0xf bank_mask:0xf
    v_add_f32_dpp v209, v209, v209 row_ror:8 row_mask:0xf bank_mask:0xf
    v_add_f32_dpp v210, v210, v210 row_ror:8 row_mask:0xf bank_mask:0xf
    v_add_f32_dpp v211, v211, v211 row_ror:8 row_mask:0xf bank_mask:0xf
    v_add_f32_dpp v212, v212, v212 row_ror:8 row_mask:0xf bank_mask:0xf
    v_add_f32_dpp v213, v213, v213 row_ror:8 row_mask:0xf bank_mask:0xf
    v_add_f32_dpp v214, v214, v214 row_ror:8 row_mask:0xf bank_mask:0xf
    v_add_f32_dpp v215, v215, v215 row_ror:8 row_mask:0xf bank_mask:0xf
    v_add_f32_dpp v216, v216, v216 row_ror:8 row_mask:0xf bank_mask:0xf
    v_add_f32_dpp v217, v217, v217 row_ror:8 row_mask:0xf bank_mask:0xf
    v_add_f32_dpp v218, v218, v218 row_ror:8 row_mask:0xf bank_mask:0xf
    v_add_f32_dpp v219, v219, v219 row_ror:8 row_mask:0xf bank_mask:0xf
    v_add_f32_dpp v220, v220, v220 row_ror:8 row_mask:0xf bank_mask:0xf
    v_add_f32_dpp v221, v221, v221 row_ror:8 row_mask:0xf bank_mask:0xf
    v_add_f32_dpp v222, v222, v222 row_ror:8 row_mask:0xf bank_mask:0xf
    v_add_f32_dpp v223, v223, v223 row_ror:8 row_mask:0xf bank_mask:0xf
    v_add_f32_dpp v224, v224, v224 row_ror:8 row_mask:0xf bank_mask:0xf
    v_add_f32_dpp v225, v225, v225 row_ror:8 row_mask:0xf bank_mask:0xf
    v_add_f32_dpp v226, v226, v226 row_ror:8 row_mask:0xf bank_mask:0xf
    v_add_f32_dpp v227, v227, v227 row_ror:8 row_mask:0xf bank_mask:0xf
    v_add_f32_dpp v228, v228, v228 row_ror:8 row_mask:0xf bank_mask:0xf
    v_add_f32_dpp v229, v229, v229 row_ror:8 row_mask:0xf bank_mask:0xf
    v_add_f32_dpp v230, v230, v230 row_ror:8 row_mask:0xf bank_mask:0xf
    v_add_f32_dpp v231, v231, v231 row_ror:8 row_mask:0xf bank_mask:0xf
    v_add_f32_dpp v232, v232, v232 row_ror:8 row_mask:0xf bank_mask:0xf
    v_add_f32_dpp v233, v233, v233 row_ror:8 row_mask:0xf bank_mask:0xf
    v_add_f32_dpp v234, v234, v234 row_ror:8 row_mask:0xf bank_mask:0xf
    v_add_f32_dpp v235, v235, v235 row_ror:8 row_mask:0xf bank_mask:0xf
    v_cvt_pk_bf16_f32 v68, v188, v189
    v_cvt_pk_bf16_f32 v69, v190, v191
    v_cvt_pk_bf16_f32 v70, v192, v193
    v_cvt_pk_bf16_f32 v71, v194, v195
    v_cvt_pk_bf16_f32 v72, v196, v197
    v_cvt_pk_bf16_f32 v73, v198, v199
    v_cvt_pk_bf16_f32 v74, v200, v201
    v_cvt_pk_bf16_f32 v75, v202, v203
    v_cvt_pk_bf16_f32 v76, v204, v205
    v_cvt_pk_bf16_f32 v77, v206, v207
    v_cvt_pk_bf16_f32 v78, v208, v209
    v_cvt_pk_bf16_f32 v79, v210, v211
    v_cvt_pk_bf16_f32 v80, v212, v213
    v_cvt_pk_bf16_f32 v81, v214, v215
    v_cvt_pk_bf16_f32 v82, v216, v217
    v_cvt_pk_bf16_f32 v83, v218, v219
    v_cvt_pk_bf16_f32 v84, v220, v221
    v_cvt_pk_bf16_f32 v85, v222, v223
    v_cvt_pk_bf16_f32 v86, v224, v225
    v_cvt_pk_bf16_f32 v87, v226, v227
    v_cvt_pk_bf16_f32 v88, v228, v229
    v_cvt_pk_bf16_f32 v89, v230, v231
    v_cvt_pk_bf16_f32 v90, v232, v233
    v_cvt_pk_bf16_f32 v91, v234, v235
    ds_read_b128 v[140:143], v23 offset:0
    ds_read_b128 v[144:147], v24 offset:0
    ds_read_b128 v[148:151], v23 offset:128
    ds_read_b128 v[152:155], v24 offset:128
    ds_read_b128 v[156:159], v23 offset:256
    ds_read_b128 v[160:163], v24 offset:256
    s_waitcnt lgkmcnt(0)
    v_mfma_f32_16x16x32_bf16 v[188:191], v[140:143], v[68:71], 0
    v_mfma_f32_16x16x32_bf16 v[188:191], v[144:147], v[72:75], v[188:191]
    s_add_u32 m0, s55, 0
    s_waitcnt vmcnt(11)
    buffer_load_dwordx4 v5, s[20:23], s57 offen offset:0 nt lds
    v_mfma_f32_16x16x32_bf16 v[188:191], v[148:151], v[76:79], v[188:191]
    v_mfma_f32_16x16x32_bf16 v[188:191], v[152:155], v[80:83], v[188:191]
    s_waitcnt vmcnt(11)
    buffer_load_dwordx4 v6, s[20:23], s57 offen offset:1024 nt lds
    v_mfma_f32_16x16x32_bf16 v[188:191], v[156:159], v[84:87], v[188:191]
    v_mfma_f32_16x16x32_bf16 v[188:191], v[160:163], v[88:91], v[188:191]
    s_waitcnt vmcnt(11)
    buffer_load_dwordx4 v7, s[20:23], s57 offen offset:2048 nt lds
    ds_read_b128 v[140:143], v23 offset:6144
    ds_read_b128 v[144:147], v24 offset:6144
    ds_read_b128 v[148:151], v23 offset:6272
    ds_read_b128 v[152:155], v24 offset:6272
    ds_read_b128 v[156:159], v23 offset:6400
    ds_read_b128 v[160:163], v24 offset:6400
    s_add_u32 m0, s55, 3072
    s_add_u32 s0, s57, 3072
    s_waitcnt vmcnt(11)
    buffer_load_dwordx4 v8, s[20:23], s0 offen offset:0 nt lds
    s_waitcnt lgkmcnt(0)
    v_mfma_f32_16x16x32_bf16 v[192:195], v[140:143], v[68:71], 0
    v_mfma_f32_16x16x32_bf16 v[192:195], v[144:147], v[72:75], v[192:195]
    s_waitcnt vmcnt(11)
    buffer_load_dwordx4 v9, s[20:23], s0 offen offset:1024 nt lds
    v_mfma_f32_16x16x32_bf16 v[192:195], v[148:151], v[76:79], v[192:195]
    v_mfma_f32_16x16x32_bf16 v[192:195], v[152:155], v[80:83], v[192:195]
    s_waitcnt vmcnt(11)
    buffer_load_dwordx4 v10, s[20:23], s0 offen offset:2048 nt lds
    s_add_u32 s57, s57, 24576
    s_sub_u32 s0, s57, 393216
    s_min_u32 s57, s57, s0
    v_mfma_f32_16x16x32_bf16 v[192:195], v[156:159], v[84:87], v[192:195]
    v_mfma_f32_16x16x32_bf16 v[192:195], v[160:163], v[88:91], v[192:195]
    s_add_u32 m0, s55, 6144
    s_waitcnt vmcnt(8)
    buffer_load_dwordx4 v5, s[20:23], s57 offen offset:0 nt lds
    ds_read_b128 v[140:143], v23 offset:12288
    ds_read_b128 v[144:147], v24 offset:12288
    ds_read_b128 v[148:151], v23 offset:12416
    ds_read_b128 v[152:155], v24 offset:12416
    ds_read_b128 v[156:159], v23 offset:12544
    ds_read_b128 v[160:163], v24 offset:12544
    s_waitcnt vmcnt(8)
    buffer_load_dwordx4 v6, s[20:23], s57 offen offset:1024 nt lds
    s_waitcnt lgkmcnt(0)
    v_mfma_f32_16x16x32_bf16 v[196:199], v[140:143], v[68:71], 0
    v_mfma_f32_16x16x32_bf16 v[196:199], v[144:147], v[72:75], v[196:199]
    s_mov_b32 s75, 0
    s_add_u32 m0, s55, 12288
    s_waitcnt vmcnt(8)
    buffer_load_dwordx4 v14, s[32:35], s75 offen offset:0 lds
    v_mfma_f32_16x16x32_bf16 v[196:199], v[148:151], v[76:79], v[196:199]
    v_mfma_f32_16x16x32_bf16 v[196:199], v[152:155], v[80:83], v[196:199]
    s_add_u32 m0, s55, 6144
    s_waitcnt vmcnt(8)
    buffer_load_dwordx4 v7, s[20:23], s57 offen offset:2048 nt lds
    v_mfma_f32_16x16x32_bf16 v[196:199], v[156:159], v[84:87], v[196:199]
    v_mfma_f32_16x16x32_bf16 v[196:199], v[160:163], v[88:91], v[196:199]
    s_add_u32 m0, s55, 9216
    s_add_u32 s0, s57, 3072
    s_waitcnt vmcnt(8)
    buffer_load_dwordx4 v8, s[20:23], s0 offen offset:0 nt lds
    ds_read_b128 v[140:143], v23 offset:24576
    ds_read_b128 v[144:147], v24 offset:24576
    ds_read_b128 v[148:151], v23 offset:24704
    ds_read_b128 v[152:155], v24 offset:24704
    ds_read_b128 v[156:159], v23 offset:24832
    ds_read_b128 v[160:163], v24 offset:24832
    s_add_u32 m0, s55, 12288
    s_waitcnt vmcnt(8)
    buffer_load_dwordx4 v15, s[32:35], s75 offen offset:1024 lds
    s_waitcnt lgkmcnt(0)
    v_mfma_f32_16x16x32_bf16 v[200:203], v[140:143], v[68:71], 0
    v_mfma_f32_16x16x32_bf16 v[200:203], v[144:147], v[72:75], v[200:203]
    v_mfma_f32_16x16x32_bf16 v[200:203], v[148:151], v[76:79], v[200:203]
    v_mfma_f32_16x16x32_bf16 v[200:203], v[152:155], v[80:83], v[200:203]
    v_mfma_f32_16x16x32_bf16 v[200:203], v[156:159], v[84:87], v[200:203]
    v_mfma_f32_16x16x32_bf16 v[200:203], v[160:163], v[88:91], v[200:203]
    s_add_u32 m0, s55, 9216
    s_waitcnt vmcnt(8)
    buffer_load_dwordx4 v9, s[20:23], s0 offen offset:1024 nt lds
    ds_read_b128 v[140:143], v23 offset:30720
    ds_read_b128 v[144:147], v24 offset:30720
    ds_read_b128 v[148:151], v23 offset:30848
    ds_read_b128 v[152:155], v24 offset:30848
    ds_read_b128 v[156:159], v23 offset:30976
    ds_read_b128 v[160:163], v24 offset:30976
    s_waitcnt vmcnt(8)
    buffer_load_dwordx4 v10, s[20:23], s0 offen offset:2048 nt lds
    s_add_u32 s57, s57, 24576
    s_sub_u32 s0, s57, 393216
    s_min_u32 s57, s57, s0
    s_waitcnt lgkmcnt(0)
    v_mfma_f32_16x16x32_bf16 v[204:207], v[140:143], v[68:71], 0
    v_mfma_f32_16x16x32_bf16 v[204:207], v[144:147], v[72:75], v[204:207]
    v_mfma_f32_16x16x32_bf16 v[204:207], v[148:151], v[76:79], v[204:207]
    v_mfma_f32_16x16x32_bf16 v[204:207], v[152:155], v[80:83], v[204:207]
    v_mfma_f32_16x16x32_bf16 v[204:207], v[156:159], v[84:87], v[204:207]
    v_mfma_f32_16x16x32_bf16 v[204:207], v[160:163], v[88:91], v[204:207]
    s_add_u32 m0, s55, 12288
    s_waitcnt vmcnt(8)
    buffer_load_dwordx4 v16, s[32:35], s75 offen offset:2048 lds
    ds_read_b128 v[140:143], v23 offset:18432
    ds_read_b128 v[144:147], v24 offset:18432
    ds_read_b128 v[148:151], v23 offset:18560
    ds_read_b128 v[152:155], v24 offset:18560
    ds_read_b128 v[156:159], v23 offset:18688
    ds_read_b128 v[160:163], v24 offset:18688
    s_add_u32 m0, s55, 24576
    s_waitcnt vmcnt(8)
    buffer_load_dwordx4 v5, s[20:23], s57 offen offset:0 nt lds
    s_waitcnt lgkmcnt(0)
    v_mfma_f32_16x16x32_bf16 v[208:211], v[140:143], v[68:71], 0
    v_mfma_f32_16x16x32_bf16 v[208:211], v[144:147], v[72:75], v[208:211]
    v_mfma_f32_16x16x32_bf16 v[208:211], v[148:151], v[76:79], v[208:211]
    v_mfma_f32_16x16x32_bf16 v[208:211], v[152:155], v[80:83], v[208:211]
    v_mfma_f32_16x16x32_bf16 v[208:211], v[156:159], v[84:87], v[208:211]
    v_mfma_f32_16x16x32_bf16 v[208:211], v[160:163], v[88:91], v[208:211]
    s_waitcnt vmcnt(8)
    buffer_load_dwordx4 v6, s[20:23], s57 offen offset:1024 nt lds
    ds_read_b128 v[140:143], v23 offset:0
    ds_read_b128 v[144:147], v24 offset:0
    ds_read_b128 v[148:151], v23 offset:128
    ds_read_b128 v[152:155], v24 offset:128
    ds_read_b128 v[156:159], v23 offset:256
    ds_read_b128 v[160:163], v24 offset:256
    s_add_u32 m0, s55, 12288
    s_waitcnt vmcnt(8)
    buffer_load_dwordx4 v17, s[32:35], s75 offen offset:3072 lds
    s_waitcnt lgkmcnt(0)
    v_mfma_f32_16x16x32_bf16 v[212:215], v[140:143], v[68:71], 0
    v_mfma_f32_16x16x32_bf16 v[212:215], v[144:147], v[72:75], v[212:215]
    v_mfma_f32_16x16x32_bf16 v[212:215], v[148:151], v[76:79], v[212:215]
    v_mfma_f32_16x16x32_bf16 v[212:215], v[152:155], v[80:83], v[212:215]
    v_mfma_f32_16x16x32_bf16 v[212:215], v[156:159], v[84:87], v[212:215]
    v_mfma_f32_16x16x32_bf16 v[212:215], v[160:163], v[88:91], v[212:215]
    s_add_u32 m0, s55, 24576
    s_waitcnt vmcnt(8)
    buffer_load_dwordx4 v7, s[20:23], s57 offen offset:2048 nt lds
    s_add_u32 m0, s55, 27648
    s_add_u32 s0, s57, 3072
    s_waitcnt vmcnt(8)
    buffer_load_dwordx4 v8, s[20:23], s0 offen offset:0 nt lds
    s_add_u32 m0, s55, 16384
    s_waitcnt vmcnt(8)
    buffer_load_dwordx4 v18, s[32:35], s75 offen offset:0 lds
    s_add_u32 m0, s55, 27648
    s_waitcnt vmcnt(8)
    buffer_load_dwordx4 v9, s[20:23], s0 offen offset:1024 nt lds
    s_waitcnt vmcnt(8)
    buffer_load_dwordx4 v10, s[20:23], s0 offen offset:2048 nt lds
    s_add_u32 s57, s57, 24576
    s_sub_u32 s0, s57, 393216
    s_min_u32 s57, s57, s0
    ds_read_b128 v[140:143], v23 offset:6144
    ds_read_b128 v[144:147], v24 offset:6144
    ds_read_b128 v[148:151], v23 offset:6272
    ds_read_b128 v[152:155], v24 offset:6272
    ds_read_b128 v[156:159], v23 offset:6400
    ds_read_b128 v[160:163], v24 offset:6400
    s_mov_b32 s75, 20480
    s_add_u32 m0, s55, 30720
    s_waitcnt vmcnt(8)
    buffer_load_dwordx4 v14, s[32:35], s75 offen offset:0 lds
    s_waitcnt lgkmcnt(0)
    v_mfma_f32_16x16x32_bf16 v[216:219], v[140:143], v[68:71], 0
    v_mfma_f32_16x16x32_bf16 v[216:219], v[144:147], v[72:75], v[216:219]
    v_mfma_f32_16x16x32_bf16 v[216:219], v[148:151], v[76:79], v[216:219]
    v_mfma_f32_16x16x32_bf16 v[216:219], v[152:155], v[80:83], v[216:219]
    v_mfma_f32_16x16x32_bf16 v[216:219], v[156:159], v[84:87], v[216:219]
    v_mfma_f32_16x16x32_bf16 v[216:219], v[160:163], v[88:91], v[216:219]
    s_add_u32 m0, s55, 18432
    s_waitcnt vmcnt(8)
    buffer_load_dwordx4 v5, s[20:23], s57 offen offset:0 nt lds
    s_waitcnt vmcnt(8)
    buffer_load_dwordx4 v6, s[20:23], s57 offen offset:1024 nt lds
    s_waitcnt vmcnt(8)
    buffer_load_dwordx4 v7, s[20:23], s57 offen offset:2048 nt lds
    s_add_u32 m0, s55, 30720
    s_waitcnt vmcnt(8)
    buffer_load_dwordx4 v15, s[32:35], s75 offen offset:1024 lds
    s_add_u32 m0, s55, 21504
    s_add_u32 s0, s57, 3072
    s_waitcnt vmcnt(8)
    buffer_load_dwordx4 v8, s[20:23], s0 offen offset:0 nt lds
    s_waitcnt vmcnt(8)
    buffer_load_dwordx4 v9, s[20:23], s0 offen offset:1024 nt lds
    ds_read_b64_tr_b16 a[0:1], v25 offset:12288
    ds_read_b64_tr_b16 a[4:5], v25 offset:12320
    ds_read_b64_tr_b16 a[8:9], v25 offset:12352
    ds_read_b64_tr_b16 a[12:13], v25 offset:12384
    ds_read_b64_tr_b16 a[16:17], v25 offset:12416
    ds_read_b64_tr_b16 a[20:21], v25 offset:12448
    ds_read_b64_tr_b16 a[24:25], v25 offset:12480
    ds_read_b64_tr_b16 a[28:29], v25 offset:12512
    ds_read_b64_tr_b16 a[32:33], v25 offset:12544
    ds_read_b64_tr_b16 a[36:37], v25 offset:12576
    s_add_u32 m0, s55, 30720
    s_waitcnt vmcnt(8)
    buffer_load_dwordx4 v16, s[32:35], s75 offen offset:2048 lds
    s_add_u32 m0, s55, 21504
    s_waitcnt vmcnt(8)
    buffer_load_dwordx4 v10, s[20:23], s0 offen offset:2048 nt lds
    s_add_u32 s57, s57, 24576
    s_sub_u32 s0, s57, 393216
    s_min_u32 s57, s57, s0
    ds_read_b128 v[140:143], v23 offset:24576
    ds_read_b128 v[144:147], v24 offset:24576
    ds_read_b128 v[148:151], v23 offset:24704
    ds_read_b128 v[152:155], v24 offset:24704
    ds_read_b128 v[156:159], v23 offset:24832
    ds_read_b128 v[160:163], v24 offset:24832
    s_add_u32 m0, s55, 0
    s_waitcnt vmcnt(8)
    buffer_load_dwordx4 v5, s[20:23], s57 offen offset:0 nt lds
    s_waitcnt lgkmcnt(0)
    v_mfma_f32_16x16x32_bf16 v[220:223], v[140:143], v[68:71], 0
    v_mfma_f32_16x16x32_bf16 v[220:223], v[144:147], v[72:75], v[220:223]
    v_mfma_f32_16x16x32_bf16 v[220:223], v[148:151], v[76:79], v[220:223]
    v_mfma_f32_16x16x32_bf16 v[220:223], v[152:155], v[80:83], v[220:223]
    v_mfma_f32_16x16x32_bf16 v[220:223], v[156:159], v[84:87], v[220:223]
    v_mfma_f32_16x16x32_bf16 v[220:223], v[160:163], v[88:91], v[220:223]
    s_add_u32 m0, s55, 30720
    s_waitcnt vmcnt(8)
    buffer_load_dwordx4 v17, s[32:35], s75 offen offset:3072 lds
    s_add_u32 m0, s55, 0
    s_waitcnt vmcnt(8)
    buffer_load_dwordx4 v6, s[20:23], s57 offen offset:1024 nt lds
    s_waitcnt vmcnt(8)
    buffer_load_dwordx4 v7, s[20:23], s57 offen offset:2048 nt lds
    s_add_u32 m0, s55, 34816
    s_waitcnt vmcnt(8)
    buffer_load_dwordx4 v18, s[32:35], s75 offen offset:0 lds
    s_add_u32 m0, s55, 3072
    s_add_u32 s0, s57, 3072
    s_waitcnt vmcnt(8)
    buffer_load_dwordx4 v8, s[20:23], s0 offen offset:0 nt lds
    s_waitcnt vmcnt(8)
    buffer_load_dwordx4 v9, s[20:23], s0 offen offset:1024 nt lds
    s_mov_b32 s75, 40960
    s_add_u32 m0, s55, 6144
    s_waitcnt vmcnt(8)
    buffer_load_dwordx4 v14, s[32:35], s75 offen offset:0 lds
    s_add_u32 m0, s55, 3072
    s_waitcnt vmcnt(8)
    buffer_load_dwordx4 v10, s[20:23], s0 offen offset:2048 nt lds
    s_add_u32 s57, s57, 24576
    s_sub_u32 s0, s57, 393216
    s_min_u32 s57, s57, s0
    ds_read_b128 v[140:143], v23 offset:18432
    ds_read_b128 v[144:147], v24 offset:18432
    ds_read_b128 v[148:151], v23 offset:18560
    ds_read_b128 v[152:155], v24 offset:18560
    ds_read_b128 v[156:159], v23 offset:18688
    ds_read_b128 v[160:163], v24 offset:18688
    s_add_u32 m0, s55, 12288
    s_waitcnt vmcnt(8)
    buffer_load_dwordx4 v5, s[20:23], s57 offen offset:0 nt lds
    s_waitcnt lgkmcnt(0)
    v_mfma_f32_16x16x32_bf16 v[224:227], v[140:143], v[68:71], 0
    v_mfma_f32_16x16x32_bf16 v[224:227], v[144:147], v[72:75], v[224:227]
    v_mfma_f32_16x16x32_bf16 v[224:227], v[148:151], v[76:79], v[224:227]
    v_mfma_f32_16x16x32_bf16 v[224:227], v[152:155], v[80:83], v[224:227]
    v_mfma_f32_16x16x32_bf16 v[224:227], v[156:159], v[84:87], v[224:227]
    v_mfma_f32_16x16x32_bf16 v[224:227], v[160:163], v[88:91], v[224:227]
    s_waitcnt vmcnt(8)
    buffer_load_dwordx4 v6, s[20:23], s57 offen offset:1024 nt lds
    s_add_u32 m0, s55, 6144
    s_waitcnt vmcnt(8)
    buffer_load_dwordx4 v15, s[32:35], s75 offen offset:1024 lds
    s_add_u32 m0, s55, 12288
    s_waitcnt vmcnt(8)
    buffer_load_dwordx4 v7, s[20:23], s57 offen offset:2048 nt lds
    s_add_u32 m0, s55, 15360
    s_add_u32 s0, s57, 3072
    s_waitcnt vmcnt(8)
    buffer_load_dwordx4 v8, s[20:23], s0 offen offset:0 nt lds
    ds_read_b64_tr_b16 a[2:3], v25 offset:30720
    ds_read_b64_tr_b16 a[6:7], v25 offset:30752
    ds_read_b64_tr_b16 a[10:11], v25 offset:30784
    ds_read_b64_tr_b16 a[14:15], v25 offset:30816
    ds_read_b64_tr_b16 a[18:19], v25 offset:30848
    ds_read_b64_tr_b16 a[22:23], v25 offset:30880
    ds_read_b64_tr_b16 a[26:27], v25 offset:30912
    ds_read_b64_tr_b16 a[30:31], v25 offset:30944
    ds_read_b64_tr_b16 a[34:35], v25 offset:30976
    ds_read_b64_tr_b16 a[38:39], v25 offset:31008
    s_add_u32 m0, s55, 6144
    s_waitcnt vmcnt(8)
    buffer_load_dwordx4 v16, s[32:35], s75 offen offset:2048 lds
    s_add_u32 m0, s55, 15360
    s_waitcnt vmcnt(8)
    buffer_load_dwordx4 v9, s[20:23], s0 offen offset:1024 nt lds
    s_waitcnt vmcnt(8)
    buffer_load_dwordx4 v10, s[20:23], s0 offen offset:2048 nt lds
    s_add_u32 s57, s57, 24576
    s_sub_u32 s0, s57, 393216
    s_min_u32 s57, s57, s0
    s_add_u32 m0, s55, 6144
    s_waitcnt vmcnt(8)
    buffer_load_dwordx4 v17, s[32:35], s75 offen offset:3072 lds
    ds_read_b128 v[140:143], v23 offset:0
    ds_read_b128 v[144:147], v24 offset:0
    ds_read_b128 v[148:151], v23 offset:128
    ds_read_b128 v[152:155], v24 offset:128
    ds_read_b128 v[156:159], v23 offset:256
    ds_read_b128 v[160:163], v24 offset:256
    s_add_u32 m0, s55, 24576
    s_waitcnt vmcnt(8)
    buffer_load_dwordx4 v5, s[20:23], s57 offen offset:0 nt lds
    s_waitcnt lgkmcnt(0)
    v_mfma_f32_16x16x32_bf16 v[228:231], v[140:143], v[68:71], 0
    v_mfma_f32_16x16x32_bf16 v[228:231], v[144:147], v[72:75], v[228:231]
    v_mfma_f32_16x16x32_bf16 v[228:231], v[148:151], v[76:79], v[228:231]
    v_mfma_f32_16x16x32_bf16 v[228:231], v[152:155], v[80:83], v[228:231]
    v_mfma_f32_16x16x32_bf16 v[228:231], v[156:159], v[84:87], v[228:231]
    v_mfma_f32_16x16x32_bf16 v[228:231], v[160:163], v[88:91], v[228:231]
    s_waitcnt vmcnt(8)
    buffer_load_dwordx4 v6, s[20:23], s57 offen offset:1024 nt lds
    s_add_u32 m0, s55, 10240
    s_waitcnt vmcnt(8)
    buffer_load_dwordx4 v18, s[32:35], s75 offen offset:0 lds
    s_add_u32 m0, s55, 24576
    s_waitcnt vmcnt(8)
    buffer_load_dwordx4 v7, s[20:23], s57 offen offset:2048 nt lds
    s_add_u32 m0, s55, 27648
    s_add_u32 s0, s57, 3072
    s_waitcnt vmcnt(8)
    buffer_load_dwordx4 v8, s[20:23], s0 offen offset:0 nt lds
    s_mov_b32 s75, 61440
    s_add_u32 m0, s55, 18432
    s_waitcnt vmcnt(8)
    buffer_load_dwordx4 v14, s[32:35], s75 offen offset:0 lds
    s_add_u32 m0, s55, 27648
    s_waitcnt vmcnt(8)
    buffer_load_dwordx4 v9, s[20:23], s0 offen offset:1024 nt lds
    s_waitcnt vmcnt(8)
    buffer_load_dwordx4 v10, s[20:23], s0 offen offset:2048 nt lds
    s_add_u32 s57, s57, 24576
    s_sub_u32 s0, s57, 393216
    s_min_u32 s57, s57, s0
    ds_read_b128 v[140:143], v23 offset:12288
    ds_read_b128 v[144:147], v24 offset:12288
    ds_read_b128 v[148:151], v23 offset:12416
    ds_read_b128 v[152:155], v24 offset:12416
    ds_read_b128 v[156:159], v23 offset:12544
    ds_read_b128 v[160:163], v24 offset:12544
    s_add_u32 m0, s55, 30720
    s_waitcnt vmcnt(8)
    buffer_load_dwordx4 v5, s[20:23], s57 offen offset:0 nt lds
    s_waitcnt lgkmcnt(0)
    v_mfma_f32_16x16x32_bf16 v[232:235], v[140:143], v[68:71], 0
    v_mfma_f32_16x16x32_bf16 v[232:235], v[144:147], v[72:75], v[232:235]
    v_mfma_f32_16x16x32_bf16 v[232:235], v[148:151], v[76:79], v[232:235]
    v_mfma_f32_16x16x32_bf16 v[232:235], v[152:155], v[80:83], v[232:235]
    v_mfma_f32_16x16x32_bf16 v[232:235], v[156:159], v[84:87], v[232:235]
    v_mfma_f32_16x16x32_bf16 v[232:235], v[160:163], v[88:91], v[232:235]
    s_add_u32 m0, s55, 18432
    s_waitcnt vmcnt(8)
    buffer_load_dwordx4 v15, s[32:35], s75 offen offset:1024 lds
    s_add_u32 m0, s55, 30720
    s_waitcnt vmcnt(8)
    buffer_load_dwordx4 v6, s[20:23], s57 offen offset:1024 nt lds
    s_waitcnt vmcnt(8)
    buffer_load_dwordx4 v7, s[20:23], s57 offen offset:2048 nt lds
    ds_read_b64_tr_b16 a[40:41], v25 offset:6144
    ds_read_b64_tr_b16 a[44:45], v25 offset:6176
    ds_read_b64_tr_b16 a[48:49], v25 offset:6208
    ds_read_b64_tr_b16 a[52:53], v25 offset:6240
    ds_read_b64_tr_b16 a[56:57], v25 offset:6272
    ds_read_b64_tr_b16 a[60:61], v25 offset:6304
    ds_read_b64_tr_b16 a[64:65], v25 offset:6336
    ds_read_b64_tr_b16 a[68:69], v25 offset:6368
    ds_read_b64_tr_b16 a[72:73], v25 offset:6400
    ds_read_b64_tr_b16 a[76:77], v25 offset:6432
    s_add_u32 m0, s55, 18432
    s_waitcnt vmcnt(8)
    buffer_load_dwordx4 v16, s[32:35], s75 offen offset:2048 lds
    s_add_u32 m0, s55, 33792
    s_add_u32 s0, s57, 3072
    s_waitcnt vmcnt(8)
    buffer_load_dwordx4 v8, s[20:23], s0 offen offset:0 nt lds
    s_waitcnt vmcnt(8)
    buffer_load_dwordx4 v9, s[20:23], s0 offen offset:1024 nt lds
    s_add_u32 m0, s55, 18432
    s_waitcnt vmcnt(8)
    buffer_load_dwordx4 v17, s[32:35], s75 offen offset:3072 lds
    s_add_u32 m0, s55, 33792
    s_waitcnt vmcnt(8)
    buffer_load_dwordx4 v10, s[20:23], s0 offen offset:2048 nt lds
    s_add_u32 s57, s57, 24576
    s_sub_u32 s0, s57, 393216
    s_min_u32 s57, s57, s0
    ds_read_b128 v[140:143], v23 offset:24576
    ds_read_b128 v[144:147], v24 offset:24576
    ds_read_b128 v[148:151], v23 offset:24704
    ds_read_b128 v[152:155], v24 offset:24704
    ds_read_b128 v[156:159], v23 offset:24832
    ds_read_b128 v[160:163], v24 offset:24832
    s_add_u32 m0, s55, 0
    s_waitcnt vmcnt(8)
    buffer_load_dwordx4 v5, s[20:23], s57 offen offset:0 nt lds
    s_waitcnt lgkmcnt(0)
    v_mfma_f32_16x16x32_bf16 v[236:239], v[140:143], v[68:71], 0
    v_mfma_f32_16x16x32_bf16 v[236:239], v[144:147], v[72:75], v[236:239]
    v_mfma_f32_16x16x32_bf16 v[236:239], v[148:151], v[76:79], v[236:239]
    v_mfma_f32_16x16x32_bf16 v[236:239], v[152:155], v[80:83], v[236:239]
    v_mfma_f32_16x16x32_bf16 v[236:239], v[156:159], v[84:87], v[236:239]
    v_mfma_f32_16x16x32_bf16 v[236:239], v[160:163], v[88:91], v[236:239]
    s_add_u32 m0, s55, 22528
    s_waitcnt vmcnt(8)
    buffer_load_dwordx4 v18, s[32:35], s75 offen offset:0 lds
    s_add_u32 m0, s55, 0
    s_waitcnt vmcnt(8)
    buffer_load_dwordx4 v6, s[20:23], s57 offen offset:1024 nt lds
    s_waitcnt vmcnt(8)
    buffer_load_dwordx4 v7, s[20:23], s57 offen offset:2048 nt lds
    s_mov_b32 s75, 81920
    s_add_u32 m0, s55, 12288
    s_waitcnt vmcnt(8)
    buffer_load_dwordx4 v14, s[32:35], s75 offen offset:0 lds
    s_add_u32 m0, s55, 3072
    s_add_u32 s0, s57, 3072
    s_waitcnt vmcnt(8)
    buffer_load_dwordx4 v8, s[20:23], s0 offen offset:0 nt lds
    s_waitcnt vmcnt(8)
    buffer_load_dwordx4 v9, s[20:23], s0 offen offset:1024 nt lds
    s_waitcnt vmcnt(8)
    buffer_load_dwordx4 v10, s[20:23], s0 offen offset:2048 nt lds
    s_add_u32 s57, s57, 24576
    s_sub_u32 s0, s57, 393216
    s_min_u32 s57, s57, s0
    s_add_u32 m0, s55, 12288
    s_waitcnt vmcnt(8)
    buffer_load_dwordx4 v15, s[32:35], s75 offen offset:1024 lds
    ds_read_b128 v[140:143], v23 offset:30720
    ds_read_b128 v[144:147], v24 offset:30720
    ds_read_b128 v[148:151], v23 offset:30848
    ds_read_b128 v[152:155], v24 offset:30848
    ds_read_b128 v[156:159], v23 offset:30976
    ds_read_b128 v[160:163], v24 offset:30976
    s_add_u32 m0, s55, 6144
    s_waitcnt vmcnt(8)
    buffer_load_dwordx4 v5, s[20:23], s57 offen offset:0 nt lds
    s_waitcnt lgkmcnt(0)
    v_mfma_f32_16x16x32_bf16 v[240:243], v[140:143], v[68:71], 0
    v_mfma_f32_16x16x32_bf16 v[240:243], v[144:147], v[72:75], v[240:243]
    v_mfma_f32_16x16x32_bf16 v[240:243], v[148:151], v[76:79], v[240:243]
    v_mfma_f32_16x16x32_bf16 v[240:243], v[152:155], v[80:83], v[240:243]
    v_mfma_f32_16x16x32_bf16 v[240:243], v[156:159], v[84:87], v[240:243]
    v_mfma_f32_16x16x32_bf16 v[240:243], v[160:163], v[88:91], v[240:243]
    s_waitcnt vmcnt(8)
    buffer_load_dwordx4 v6, s[20:23], s57 offen offset:1024 nt lds
    ds_read_b64_tr_b16 a[42:43], v25 offset:18432
    ds_read_b64_tr_b16 a[46:47], v25 offset:18464
    ds_read_b64_tr_b16 a[50:51], v25 offset:18496
    ds_read_b64_tr_b16 a[54:55], v25 offset:18528
    ds_read_b64_tr_b16 a[58:59], v25 offset:18560
    ds_read_b64_tr_b16 a[62:63], v25 offset:18592
    ds_read_b64_tr_b16 a[66:67], v25 offset:18624
    ds_read_b64_tr_b16 a[70:71], v25 offset:18656
    ds_read_b64_tr_b16 a[74:75], v25 offset:18688
    ds_read_b64_tr_b16 a[78:79], v25 offset:18720
    s_add_u32 m0, s55, 12288
    s_waitcnt vmcnt(8)
    buffer_load_dwordx4 v16, s[32:35], s75 offen offset:2048 lds
    s_add_u32 m0, s55, 6144
    s_waitcnt vmcnt(8)
    buffer_load_dwordx4 v7, s[20:23], s57 offen offset:2048 nt lds
    s_add_u32 m0, s55, 9216
    s_add_u32 s0, s57, 3072
    s_waitcnt vmcnt(8)
    buffer_load_dwordx4 v8, s[20:23], s0 offen offset:0 nt lds
    s_add_u32 m0, s55, 12288
    s_waitcnt vmcnt(8)
    buffer_load_dwordx4 v17, s[32:35], s75 offen offset:3072 lds
    s_add_u32 m0, s55, 9216
    s_waitcnt vmcnt(8)
    buffer_load_dwordx4 v9, s[20:23], s0 offen offset:1024 nt lds
    s_waitcnt vmcnt(8)
    buffer_load_dwordx4 v10, s[20:23], s0 offen offset:2048 nt lds
    s_add_u32 s57, s57, 24576
    s_sub_u32 s0, s57, 393216
    s_min_u32 s57, s57, s0
    ds_read_b128 v[140:143], v23 offset:0
    ds_read_b128 v[144:147], v24 offset:0
    ds_read_b128 v[148:151], v23 offset:128
    ds_read_b128 v[152:155], v24 offset:128
    ds_read_b128 v[156:159], v23 offset:256
    ds_read_b128 v[160:163], v24 offset:256
    s_add_u32 m0, s55, 16384
    s_waitcnt vmcnt(8)
    buffer_load_dwordx4 v18, s[32:35], s75 offen offset:0 lds
    s_waitcnt lgkmcnt(0)
    v_mfma_f32_16x16x32_bf16 v[244:247], v[140:143], v[68:71], 0
    v_mfma_f32_16x16x32_bf16 v[244:247], v[144:147], v[72:75], v[244:247]
    v_mfma_f32_16x16x32_bf16 v[244:247], v[148:151], v[76:79], v[244:247]
    v_mfma_f32_16x16x32_bf16 v[244:247], v[152:155], v[80:83], v[244:247]
    v_mfma_f32_16x16x32_bf16 v[244:247], v[156:159], v[84:87], v[244:247]
    v_mfma_f32_16x16x32_bf16 v[244:247], v[160:163], v[88:91], v[244:247]
    s_add_u32 m0, s55, 24576
    s_waitcnt vmcnt(8)
    buffer_load_dwordx4 v11, s[24:27], s57 offen offset:0 nt lds
    s_waitcnt vmcnt(8)
    buffer_load_dwordx4 v12, s[24:27], s57 offen offset:1024 nt lds
    s_mov_b32 s75, 102400
    s_add_u32 m0, s55, 30720
    s_waitcnt vmcnt(8)
    buffer_load_dwordx4 v14, s[32:35], s75 offen offset:0 lds
    s_add_u32 m0, s55, 24576
    s_waitcnt vmcnt(8)
    buffer_load_dwordx4 v13, s[24:27], s57 offen offset:2048 nt lds
    s_add_u32 m0, s55, 27648
    s_add_u32 s0, s57, 3072
    s_waitcnt vmcnt(8)
    buffer_load_dwordx4 v11, s[24:27], s0 offen offset:0 nt lds
    s_waitcnt vmcnt(8)
    buffer_load_dwordx4 v12, s[24:27], s0 offen offset:1024 nt lds
    s_add_u32 m0, s55, 30720
    s_waitcnt vmcnt(8)
    buffer_load_dwordx4 v15, s[32:35], s75 offen offset:1024 lds
    s_add_u32 m0, s55, 27648
    s_waitcnt vmcnt(8)
    buffer_load_dwordx4 v13, s[24:27], s0 offen offset:2048 nt lds
    s_add_u32 s57, s57, 24576
    s_sub_u32 s0, s57, 393216
    s_min_u32 s57, s57, s0
    ds_read_b128 v[140:143], v23 offset:6144
    ds_read_b128 v[144:147], v24 offset:6144
    ds_read_b128 v[148:151], v23 offset:6272
    ds_read_b128 v[152:155], v24 offset:6272
    ds_read_b128 v[156:159], v23 offset:6400
    ds_read_b128 v[160:163], v24 offset:6400
    s_add_u32 m0, s55, 18432
    s_waitcnt vmcnt(8)
    buffer_load_dwordx4 v11, s[24:27], s57 offen offset:0 nt lds
    s_waitcnt lgkmcnt(0)
    v_mfma_f32_16x16x32_bf16 v[248:251], v[140:143], v[68:71], 0
    v_mfma_f32_16x16x32_bf16 v[248:251], v[144:147], v[72:75], v[248:251]
    v_mfma_f32_16x16x32_bf16 v[248:251], v[148:151], v[76:79], v[248:251]
    v_mfma_f32_16x16x32_bf16 v[248:251], v[152:155], v[80:83], v[248:251]
    v_mfma_f32_16x16x32_bf16 v[248:251], v[156:159], v[84:87], v[248:251]
    v_mfma_f32_16x16x32_bf16 v[248:251], v[160:163], v[88:91], v[248:251]
    s_add_u32 m0, s55, 30720
    s_waitcnt vmcnt(8)
    buffer_load_dwordx4 v16, s[32:35], s75 offen offset:2048 lds
    v_max3_f32 v40, v188, v189, v190
    v_max3_f32 v41, v191, v192, v193
    v_max3_f32 v40, v40, v194, v195
    v_max3_f32 v41, v41, v196, v197
    v_max3_f32 v40, v40, v198, v199
    v_max3_f32 v41, v41, v200, v201
    v_max3_f32 v40, v40, v202, v203
    v_max3_f32 v41, v41, v204, v205
    v_max3_f32 v40, v40, v206, v207
    v_max3_f32 v41, v41, v208, v209
    v_max3_f32 v40, v40, v210, v211
    v_max3_f32 v41, v41, v212, v213
    v_max3_f32 v40, v40, v214, v215
    v_max3_f32 v41, v41, v216, v217
    v_max3_f32 v40, v40, v218, v219
    v_max3_f32 v41, v41, v220, v221
    v_max3_f32 v40, v40, v222, v223
    v_max3_f32 v41, v41, v224, v225
    v_max3_f32 v40, v40, v226, v227
    v_max3_f32 v41, v41, v228, v229
    v_max3_f32 v40, v40, v230, v231
    v_max3_f32 v41, v41, v232, v233
    v_max3_f32 v40, v40, v234, v235
    v_max3_f32 v41, v41, v236, v237
    v_max3_f32 v40, v40, v238, v239
    s_add_u32 m0, s55, 18432
    s_waitcnt vmcnt(8)
    buffer_load_dwordx4 v12, s[24:27], s57 offen offset:1024 nt lds
    v_max3_f32 v41, v41, v240, v241
    v_max3_f32 v40, v40, v242, v243
    v_max3_f32 v41, v41, v244, v245
    v_max3_f32 v40, v40, v246, v247
    v_max3_f32 v41, v41, v248, v249
    v_max3_f32 v40, v40, v250, v251
    v_max_f32 v40, v40, v41
    v_mul_f32 v41, s60, v40
    v_max_f32 v41, 0xff7fffff, v41
    v_fma_f32 v188, v188, s60, -v41
    v_fma_f32 v189, v189, s60, -v41
    v_fma_f32 v190, v190, s60, -v41
    v_fma_f32 v191, v191, s60, -v41
    v_fma_f32 v192, v192, s60, -v41
    v_fma_f32 v193, v193, s60, -v41
    v_fma_f32 v194, v194, s60, -v41
    v_fma_f32 v195, v195, s60, -v41
    v_fma_f32 v196, v196, s60, -v41
    v_fma_f32 v197, v197, s60, -v41
    v_fma_f32 v198, v198, s60, -v41
    v_fma_f32 v199, v199, s60, -v41
    v_fma_f32 v200, v200, s60, -v41
    v_fma_f32 v201, v201, s60, -v41
    v_fma_f32 v202, v202, s60, -v41
    v_fma_f32 v203, v203, s60, -v41
    s_waitcnt vmcnt(8)
    buffer_load_dwordx4 v13, s[24:27], s57 offen offset:2048 nt lds
    v_fma_f32 v204, v204, s60, -v41
    v_fma_f32 v205, v205, s60, -v41
    v_fma_f32 v206, v206, s60, -v41
    v_fma_f32 v207, v207, s60, -v41
    v_fma_f32 v208, v208, s60, -v41
    v_fma_f32 v209, v209, s60, -v41
    v_fma_f32 v210, v210, s60, -v41
    v_fma_f32 v211, v211, s60, -v41
    v_fma_f32 v212, v212, s60, -v41
    v_fma_f32 v213, v213, s60, -v41
    v_fma_f32 v214, v214, s60, -v41
    v_fma_f32 v215, v215, s60, -v41
    v_fma_f32 v216, v216, s60, -v41
    v_fma_f32 v217, v217, s60, -v41
    v_fma_f32 v218, v218, s60, -v41
    v_fma_f32 v219, v219, s60, -v41
    v_fma_f32 v220, v220, s60, -v41
    v_fma_f32 v221, v221, s60, -v41
    v_fma_f32 v222, v222, s60, -v41
    v_fma_f32 v223, v223, s60, -v41
    v_fma_f32 v224, v224, s60, -v41
    v_fma_f32 v225, v225, s60, -v41
    v_fma_f32 v226, v226, s60, -v41
    v_fma_f32 v227, v227, s60, -v41
    v_fma_f32 v228, v228, s60, -v41
    s_add_u32 m0, s55, 30720
    s_waitcnt vmcnt(8)
    buffer_load_dwordx4 v17, s[32:35], s75 offen offset:3072 lds
    v_fma_f32 v229, v229, s60, -v41
    v_fma_f32 v230, v230, s60, -v41
    v_fma_f32 v231, v231, s60, -v41
    v_fma_f32 v232, v232, s60, -v41
    v_fma_f32 v233, v233, s60, -v41
    v_fma_f32 v234, v234, s60, -v41
    v_fma_f32 v235, v235, s60, -v41
    v_fma_f32 v236, v236, s60, -v41
    v_fma_f32 v237, v237, s60, -v41
    v_fma_f32 v238, v238, s60, -v41
    v_fma_f32 v239, v239, s60, -v41
    v_fma_f32 v240, v240, s60, -v41
    v_fma_f32 v241, v241, s60, -v41
    v_fma_f32 v242, v242, s60, -v41
    v_fma_f32 v243, v243, s60, -v41
    v_fma_f32 v244, v244, s60, -v41
    v_fma_f32 v245, v245, s60, -v41
    v_fma_f32 v246, v246, s60, -v41
    v_fma_f32 v247, v247, s60, -v41
    v_fma_f32 v248, v248, s60, -v41
    v_fma_f32 v249, v249, s60, -v41
    v_fma_f32 v250, v250, s60, -v41
    v_fma_f32 v251, v251, s60, -v41
    v_exp_f32 v188, v188
    v_exp_f32 v189, v189
    s_add_u32 m0, s55, 21504
    s_add_u32 s0, s57, 3072
    s_waitcnt vmcnt(8)
    buffer_load_dwordx4 v11, s[24:27], s0 offen offset:0 nt lds
    v_exp_f32 v190, v190
    v_exp_f32 v191, v191
    v_exp_f32 v192, v192
    v_exp_f32 v193, v193
    v_exp_f32 v194, v194
    v_exp_f32 v195, v195
    v_exp_f32 v196, v196
    v_exp_f32 v197, v197
    v_exp_f32 v198, v198
    v_exp_f32 v199, v199
    v_exp_f32 v200, v200
    v_exp_f32 v201, v201
    v_exp_f32 v202, v202
    v_exp_f32 v203, v203
    v_exp_f32 v204, v204
    v_exp_f32 v205, v205
    v_exp_f32 v206, v206
    v_exp_f32 v207, v207
    v_exp_f32 v208, v208
    v_exp_f32 v209, v209
    v_exp_f32 v210, v210
    v_exp_f32 v211, v211
    v_exp_f32 v212, v212
    v_exp_f32 v213, v213
    v_exp_f32 v214, v214
    s_waitcnt vmcnt(8)
    buffer_load_dwordx4 v12, s[24:27], s0 offen offset:1024 nt lds
    v_exp_f32 v215, v215
    v_exp_f32 v216, v216
    v_exp_f32 v217, v217
    v_exp_f32 v218, v218
    v_exp_f32 v219, v219
    v_exp_f32 v220, v220
    v_exp_f32 v221, v221
    v_exp_f32 v222, v222
    v_exp_f32 v223, v223
    v_exp_f32 v224, v224
    v_exp_f32 v225, v225
    v_exp_f32 v226, v226
    v_exp_f32 v227, v227
    v_exp_f32 v228, v228
    v_exp_f32 v229, v229
    v_exp_f32 v230, v230
    v_exp_f32 v231, v231
    v_exp_f32 v232, v232
    v_exp_f32 v233, v233
    v_exp_f32 v234, v234
    v_exp_f32 v235, v235
    v_exp_f32 v236, v236
    v_exp_f32 v237, v237
    v_exp_f32 v238, v238
    v_exp_f32 v239, v239
    s_add_u32 m0, s55, 34816
    s_waitcnt vmcnt(8)
    buffer_load_dwordx4 v18, s[32:35], s75 offen offset:0 lds
    v_exp_f32 v240, v240
    v_exp_f32 v241, v241
    v_exp_f32 v242, v242
    v_exp_f32 v243, v243
    v_exp_f32 v244, v244
    v_exp_f32 v245, v245
    v_exp_f32 v246, v246
    v_exp_f32 v247, v247
    v_exp_f32 v248, v248
    v_exp_f32 v249, v249
    v_exp_f32 v250, v250
    v_exp_f32 v251, v251
    v_add_f32 v42, v188, v189
    v_add_f32 v43, v190, v191
    v_add_f32 v42, v42, v192
    v_add_f32 v43, v43, v193
    v_add_f32 v42, v42, v194
    v_add_f32 v43, v43, v195
    v_add_f32 v42, v42, v196
    v_add_f32 v43, v43, v197
    v_add_f32 v42, v42, v198
    v_add_f32 v43, v43, v199
    v_add_f32 v42, v42, v200
    v_add_f32 v43, v43, v201
    v_add_f32 v42, v42, v202
    s_add_u32 m0, s55, 21504
    s_waitcnt vmcnt(8)
    buffer_load_dwordx4 v13, s[24:27], s0 offen offset:2048 nt lds
    s_add_u32 s57, s57, 24576
    s_sub_u32 s0, s57, 393216
    s_min_u32 s57, s57, s0
    v_add_f32 v43, v43, v203
    v_add_f32 v42, v42, v204
    v_add_f32 v43, v43, v205
    v_add_f32 v42, v42, v206
    v_add_f32 v43, v43, v207
    v_add_f32 v42, v42, v208
    v_add_f32 v43, v43, v209
    v_add_f32 v42, v42, v210
    v_add_f32 v43, v43, v211
    v_add_f32 v42, v42, v212
    v_add_f32 v43, v43, v213
    v_add_f32 v42, v42, v214
    v_add_f32 v43, v43, v215
    v_add_f32 v42, v42, v216
    v_add_f32 v43, v43, v217
    v_add_f32 v42, v42, v218
    v_add_f32 v43, v43, v219
    v_add_f32 v42, v42, v220
    v_add_f32 v43, v43, v221
    v_add_f32 v42, v42, v222
    v_add_f32 v43, v43, v223
    v_add_f32 v42, v42, v224
    v_add_f32 v43, v43, v225
    v_add_f32 v42, v42, v226
    v_add_f32 v43, v43, v227
    s_add_u32 m0, s55, 0
    s_waitcnt vmcnt(8)
    buffer_load_dwordx4 v11, s[24:27], s57 offen offset:0 nt lds
    v_add_f32 v42, v42, v228
    v_add_f32 v43, v43, v229
    v_add_f32 v42, v42, v230
    v_add_f32 v43, v43, v231
    v_add_f32 v42, v42, v232
    v_add_f32 v43, v43, v233
    v_add_f32 v42, v42, v234
    v_add_f32 v43, v43, v235
    v_add_f32 v42, v42, v236
    v_add_f32 v43, v43, v237
    v_add_f32 v42, v42, v238
    v_add_f32 v43, v43, v239
    v_add_f32 v42, v42, v240
    v_add_f32 v43, v43, v241
    v_add_f32 v42, v42, v242
    v_add_f32 v43, v43, v243
    v_add_f32 v42, v42, v244
    v_add_f32 v43, v43, v245
    v_add_f32 v42, v42, v246
    v_add_f32 v43, v43, v247
    v_add_f32 v42, v42, v248
    v_add_f32 v43, v43, v249
    v_add_f32 v42, v42, v250
    v_add_f32 v43, v43, v251
    v_mov_b32 v44, v41
    s_mov_b32 s75, 122880
    s_add_u32 m0, s55, 6144
    s_waitcnt vmcnt(8)
    buffer_load_dwordx4 v14, s[32:35], s75 offen offset:0 lds
    v_add_f32 v45, v42, v43
    s_mov_b64 exec, s[62:63]
    ds_write_b64 v30, v[44:45]
    s_mov_b64 exec, -1
    v_add_u32 v39, 1, v39
    v_and_b32 v2, 0xfff, v39
    v_bfe_u32 v3, v39, 12, 12
    v_lshrrev_b32 v4, 20, v39
    v_lshrrev_b32 v46, 1, v1
    v_and_b32 v46, 8, v46
    v_add_u32 v46, 12, v46
    v_bfe_u32 v0, v39, v46, 12
    v_xor_b32 v3, v2, v3
    v_xor_b32 v4, v2, v4
    v_xor_b32 v0, v2, v0
    s_add_u32 m0, s55, 0
    s_nop 0
    buffer_load_dwordx4 v12, s[24:27], s57 offen offset:1024 nt lds
    buffer_load_dwordx4 v13, s[24:27], s57 offen offset:2048 nt lds
    s_add_u32 m0, s55, 3072
    s_add_u32 s0, s57, 3072
    buffer_load_dwordx4 v11, s[24:27], s0 offen offset:0 nt lds
    s_waitcnt lgkmcnt(0)
    s_barrier
    ds_read_b128 v[92:95], v31 offset:0
    ds_read_b128 v[96:99], v31 offset:16
    ds_read_b128 v[100:103], v31 offset:32
    ds_read_b128 v[104:107], v31 offset:48
    ds_read_b128 v[108:111], v31 offset:64
    ds_read_b128 v[112:115], v31 offset:80
    ds_read_b128 v[116:119], v31 offset:96
    ds_read_b128 v[120:123], v31 offset:112
    s_waitcnt lgkmcnt(0)
    v_max3_f32 v40, v92, v94, v96
    v_max3_f32 v40, v40, v98, v100
    v_max3_f32 v40, v40, v102, v104
    v_max3_f32 v40, v40, v106, v108
    v_max3_f32 v40, v40, v110, v112
    v_max3_f32 v40, v40, v114, v116
    v_max3_f32 v40, v40, v118, v120
    v_max_f32 v40, v40, v122
    v_sub_f32 v92, v92, v40
    v_sub_f32 v94, v94, v40
    v_sub_f32 v96, v96, v40
    v_sub_f32 v98, v98, v40
    v_sub_f32 v100, v100, v40
    v_sub_f32 v102, v102, v40
    v_sub_f32 v104, v104, v40
    v_sub_f32 v106, v106, v40
    v_sub_f32 v108, v108, v40
    v_sub_f32 v110, v110, v40
    v_sub_f32 v112, v112, v40
    v_sub_f32 v114, v114, v40
    v_sub_f32 v116, v116, v40
    v_sub_f32 v118, v118, v40
    v_sub_f32 v120, v120, v40
    v_sub_f32 v122, v122, v40
    v_sub_f32 v41, v41, v40
    s_add_u32 m0, s55, 6144
    s_waitcnt vmcnt(8)
    buffer_load_dwordx4 v15, s[32:35], s75 offen offset:1024 lds
    v_exp_f32 v92, v92
    v_exp_f32 v94, v94
    v_exp_f32 v96, v96
    v_exp_f32 v98, v98
    v_exp_f32 v100, v100
    v_exp_f32 v102, v102
    v_exp_f32 v104, v104
    v_exp_f32 v106, v106
    v_exp_f32 v108, v108
    v_exp_f32 v110, v110
    v_exp_f32 v112, v112
    v_exp_f32 v114, v114
    v_exp_f32 v116, v116
    v_exp_f32 v118, v118
    v_exp_f32 v120, v120
    v_exp_f32 v122, v122
    v_exp_f32 v41, v41
    v_mul_f32 v42, v92, v93
    v_fmac_f32 v42, v94, v95
    v_fmac_f32 v42, v96, v97
    v_fmac_f32 v42, v98, v99
    v_fmac_f32 v42, v100, v101
    v_fmac_f32 v42, v102, v103
    v_fmac_f32 v42, v104, v105
    v_fmac_f32 v42, v106, v107
    s_add_u32 m0, s55, 3072
    s_waitcnt vmcnt(8)
    buffer_load_dwordx4 v12, s[24:27], s0 offen offset:1024 nt lds
    v_fmac_f32 v42, v108, v109
    v_fmac_f32 v42, v110, v111
    v_fmac_f32 v42, v112, v113
    v_fmac_f32 v42, v114, v115
    v_fmac_f32 v42, v116, v117
    v_fmac_f32 v42, v118, v119
    v_fmac_f32 v42, v120, v121
    v_fmac_f32 v42, v122, v123
    v_rcp_f32 v42, v42
    s_nop 0
    v_mul_f32 v41, v41, v42
    v_mul_f32 v188, v41, v188
    v_mul_f32 v189, v41, v189
    v_mul_f32 v190, v41, v190
    v_mul_f32 v191, v41, v191
    v_mul_f32 v192, v41, v192
    v_mul_f32 v193, v41, v193
    v_mul_f32 v194, v41, v194
    v_mul_f32 v195, v41, v195
    v_mul_f32 v196, v41, v196
    v_mul_f32 v197, v41, v197
    v_mul_f32 v198, v41, v198
    v_mul_f32 v199, v41, v199
    v_mul_f32 v200, v41, v200
    v_mul_f32 v201, v41, v201
    v_mul_f32 v202, v41, v202
    s_waitcnt vmcnt(8)
    buffer_load_dwordx4 v13, s[24:27], s0 offen offset:2048 nt lds
    s_add_u32 s57, s57, 24576
    s_sub_u32 s0, s57, 393216
    s_min_u32 s57, s57, s0
    v_mul_f32 v203, v41, v203
    v_mul_f32 v204, v41, v204
    v_mul_f32 v205, v41, v205
    v_mul_f32 v206, v41, v206
    v_mul_f32 v207, v41, v207
    v_mul_f32 v208, v41, v208
    v_mul_f32 v209, v41, v209
    v_mul_f32 v210, v41, v210
    v_mul_f32 v211, v41, v211
    v_mul_f32 v212, v41, v212
    v_mul_f32 v213, v41, v213
    v_mul_f32 v214, v41, v214
    v_mul_f32 v215, v41, v215
    v_mul_f32 v216, v41, v216
    v_mul_f32 v217, v41, v217
    v_mul_f32 v218, v41, v218
    v_mul_f32 v219, v41, v219
    v_mul_f32 v220, v41, v220
    v_mul_f32 v221, v41, v221
    v_mul_f32 v222, v41, v222
    v_mul_f32 v223, v41, v223
    v_mul_f32 v224, v41, v224
    v_mul_f32 v225, v41, v225
    v_mul_f32 v226, v41, v226
    v_mul_f32 v227, v41, v227
    s_add_u32 m0, s55, 6144
    s_waitcnt vmcnt(8)
    buffer_load_dwordx4 v16, s[32:35], s75 offen offset:2048 lds
    v_mul_f32 v228, v41, v228
    v_mul_f32 v229, v41, v229
    v_mul_f32 v230, v41, v230
    v_mul_f32 v231, v41, v231
    v_mul_f32 v232, v41, v232
    v_mul_f32 v233, v41, v233
    v_mul_f32 v234, v41, v234
    v_mul_f32 v235, v41, v235
    v_mul_f32 v236, v41, v236
    v_mul_f32 v237, v41, v237
    v_mul_f32 v238, v41, v238
    v_mul_f32 v239, v41, v239
    v_mul_f32 v240, v41, v240
    v_mul_f32 v241, v41, v241
    v_mul_f32 v242, v41, v242
    v_mul_f32 v243, v41, v243
    v_mul_f32 v244, v41, v244
    v_mul_f32 v245, v41, v245
    v_mul_f32 v246, v41, v246
    v_mul_f32 v247, v41, v247
    v_mul_f32 v248, v41, v248
    v_mul_f32 v249, v41, v249
    v_mul_f32 v250, v41, v250
    v_mul_f32 v251, v41, v251
    v_cvt_pk_bf16_f32 v188, v188, v189
    v_cvt_pk_bf16_f32 v189, v190, v191
    v_cvt_pk_bf16_f32 v190, v192, v193
    v_cvt_pk_bf16_f32 v191, v194, v195
    v_cvt_pk_bf16_f32 v192, v196, v197
    v_cvt_pk_bf16_f32 v193, v198, v199
    v_cvt_pk_bf16_f32 v194, v200, v201
    v_cvt_pk_bf16_f32 v195, v202, v203
    v_cvt_pk_bf16_f32 v196, v204, v205
    v_cvt_pk_bf16_f32 v197, v206, v207
    v_cvt_pk_bf16_f32 v198, v208, v209
    v_cvt_pk_bf16_f32 v199, v210, v211
    v_cvt_pk_bf16_f32 v200, v212, v213
    v_cvt_pk_bf16_f32 v201, v214, v215
    v_cvt_pk_bf16_f32 v202, v216, v217
    v_cvt_pk_bf16_f32 v203, v218, v219
    v_cvt_pk_bf16_f32 v204, v220, v221
    v_cvt_pk_bf16_f32 v205, v222, v223
    v_cvt_pk_bf16_f32 v206, v224, v225
    v_cvt_pk_bf16_f32 v207, v226, v227
    v_cvt_pk_bf16_f32 v208, v228, v229
    v_cvt_pk_bf16_f32 v209, v230, v231
    v_cvt_pk_bf16_f32 v210, v232, v233
    v_cvt_pk_bf16_f32 v211, v234, v235
    v_cvt_pk_bf16_f32 v212, v236, v237
    v_cvt_pk_bf16_f32 v213, v238, v239
    v_cvt_pk_bf16_f32 v214, v240, v241
    v_cvt_pk_bf16_f32 v215, v242, v243
    v_cvt_pk_bf16_f32 v216, v244, v245
    v_cvt_pk_bf16_f32 v217, v246, v247
    v_cvt_pk_bf16_f32 v218, v248, v249
    v_cvt_pk_bf16_f32 v219, v250, v251
    ds_read_b64_tr_b16 a[80:81], v25 offset:12288
    ds_read_b64_tr_b16 a[84:85], v25 offset:12320
    ds_read_b64_tr_b16 a[88:89], v25 offset:12352
    ds_read_b64_tr_b16 a[92:93], v25 offset:12384
    ds_read_b64_tr_b16 a[96:97], v25 offset:12416
    ds_read_b64_tr_b16 a[100:101], v25 offset:12448
    ds_read_b64_tr_b16 a[104:105], v25 offset:12480
    ds_read_b64_tr_b16 a[108:109], v25 offset:12512
    ds_read_b64_tr_b16 a[112:113], v25 offset:12544
    ds_read_b64_tr_b16 a[116:117], v25 offset:12576
    ds_read_b64_tr_b16 v[140:141], v19 offset:24576
    ds_read_b64_tr_b16 v[144:145], v20 offset:24576
    ds_read_b64_tr_b16 v[148:149], v21 offset:24576
    ds_read_b64_tr_b16 v[152:153], v22 offset:24576
    ds_read_b64_tr_b16 v[156:157], v19 offset:24704
    ds_read_b64_tr_b16 v[160:161], v20 offset:24704
    ds_read_b64_tr_b16 v[164:165], v21 offset:24704
    ds_read_b64_tr_b16 v[168:169], v22 offset:24704
    ds_read_b64_tr_b16 v[172:173], v19 offset:24832
    ds_read_b64_tr_b16 v[176:177], v20 offset:24832
    ds_read_b64_tr_b16 v[180:181], v21 offset:24832
    ds_read_b64_tr_b16 v[184:185], v22 offset:24832
    ds_read_b64_tr_b16 a[82:83], v25 offset:30720
    ds_read_b64_tr_b16 a[86:87], v25 offset:30752
    ds_read_b64_tr_b16 a[90:91], v25 offset:30784
    ds_read_b64_tr_b16 a[94:95], v25 offset:30816
    ds_read_b64_tr_b16 a[98:99], v25 offset:30848
    ds_read_b64_tr_b16 a[102:103], v25 offset:30880
    ds_read_b64_tr_b16 a[106:107], v25 offset:30912
    ds_read_b64_tr_b16 a[110:111], v25 offset:30944
    ds_read_b64_tr_b16 a[114:115], v25 offset:30976
    ds_read_b64_tr_b16 a[118:119], v25 offset:31008
    ds_read_b64_tr_b16 v[142:143], v19 offset:18432
    ds_read_b64_tr_b16 v[146:147], v20 offset:18432
    ds_read_b64_tr_b16 v[150:151], v21 offset:18432
    ds_read_b64_tr_b16 v[154:155], v22 offset:18432
    ds_read_b64_tr_b16 v[158:159], v19 offset:18560
    ds_read_b64_tr_b16 v[162:163], v20 offset:18560
    ds_read_b64_tr_b16 v[166:167], v21 offset:18560
    ds_read_b64_tr_b16 v[170:171], v22 offset:18560
    ds_read_b64_tr_b16 v[174:175], v19 offset:18688
    ds_read_b64_tr_b16 v[178:179], v20 offset:18688
    ds_read_b64_tr_b16 v[182:183], v21 offset:18688
    ds_read_b64_tr_b16 v[186:187], v22 offset:18688
    s_waitcnt lgkmcnt(0)
    v_mfma_f32_16x16x32_bf16 v[92:95], v[140:143], v[188:191], 0
    v_mfma_f32_16x16x32_bf16 v[96:99], v[144:147], v[188:191], 0
    v_mfma_f32_16x16x32_bf16 v[100:103], v[148:151], v[188:191], 0
    v_mfma_f32_16x16x32_bf16 v[104:107], v[152:155], v[188:191], 0
    v_mfma_f32_16x16x32_bf16 v[108:111], v[156:159], v[188:191], 0
    v_mfma_f32_16x16x32_bf16 v[112:115], v[160:163], v[188:191], 0
    s_add_u32 m0, s55, 12288
    s_waitcnt vmcnt(8)
    buffer_load_dwordx4 v11, s[24:27], s57 offen offset:0 nt lds
    v_mfma_f32_16x16x32_bf16 v[116:119], v[164:167], v[188:191], 0
    v_mfma_f32_16x16x32_bf16 v[120:123], v[168:171], v[188:191], 0
    v_mfma_f32_16x16x32_bf16 v[124:127], v[172:175], v[188:191], 0
    v_mfma_f32_16x16x32_bf16 v[128:131], v[176:179], v[188:191], 0
    v_mfma_f32_16x16x32_bf16 v[132:135], v[180:183], v[188:191], 0
    v_mfma_f32_16x16x32_bf16 v[136:139], v[184:187], v[188:191], 0
    s_waitcnt vmcnt(8)
    buffer_load_dwordx4 v12, s[24:27], s57 offen offset:1024 nt lds
    s_add_u32 m0, s55, 6144
    s_waitcnt vmcnt(8)
    buffer_load_dwordx4 v17, s[32:35], s75 offen offset:3072 lds
    s_add_u32 m0, s55, 12288
    s_waitcnt vmcnt(8)
    buffer_load_dwordx4 v13, s[24:27], s57 offen offset:2048 nt lds
    s_add_u32 m0, s55, 15360
    s_add_u32 s0, s57, 3072
    s_waitcnt vmcnt(8)
    buffer_load_dwordx4 v11, s[24:27], s0 offen offset:0 nt lds
    s_add_u32 m0, s55, 10240
    s_waitcnt vmcnt(8)
    buffer_load_dwordx4 v18, s[32:35], s75 offen offset:0 lds
    s_add_u32 m0, s55, 15360
    s_waitcnt vmcnt(8)
    buffer_load_dwordx4 v12, s[24:27], s0 offen offset:1024 nt lds
    s_waitcnt vmcnt(8)
    buffer_load_dwordx4 v13, s[24:27], s0 offen offset:2048 nt lds
    s_add_u32 s57, s57, 24576
    s_sub_u32 s0, s57, 393216
    s_min_u32 s57, s57, s0
    ds_read_b64_tr_b16 v[140:141], v19 offset:0
    ds_read_b64_tr_b16 v[144:145], v20 offset:0
    ds_read_b64_tr_b16 v[148:149], v21 offset:0
    ds_read_b64_tr_b16 v[152:153], v22 offset:0
    ds_read_b64_tr_b16 v[156:157], v19 offset:128
    ds_read_b64_tr_b16 v[160:161], v20 offset:128
    ds_read_b64_tr_b16 v[164:165], v21 offset:128
    ds_read_b64_tr_b16 v[168:169], v22 offset:128
    ds_read_b64_tr_b16 v[172:173], v19 offset:256
    ds_read_b64_tr_b16 v[176:177], v20 offset:256
    ds_read_b64_tr_b16 v[180:181], v21 offset:256
    ds_read_b64_tr_b16 v[184:185], v22 offset:256
    s_mov_b32 s75, 143360
    s_add_u32 m0, s55, 30720
    s_waitcnt vmcnt(8)
    buffer_load_dwordx4 v14, s[32:35], s75 offen offset:0 lds
    s_add_u32 m0, s55, 24576
    s_waitcnt vmcnt(8)
    buffer_load_dwordx4 v11, s[24:27], s57 offen offset:0 nt lds
    s_waitcnt vmcnt(8)
    buffer_load_dwordx4 v12, s[24:27], s57 offen offset:1024 nt lds
    s_waitcnt vmcnt(8)
    buffer_load_dwordx4 v13, s[24:27], s57 offen offset:2048 nt lds
    s_add_u32 m0, s55, 30720
    s_waitcnt vmcnt(8)
    buffer_load_dwordx4 v15, s[32:35], s75 offen offset:1024 lds
    s_add_u32 m0, s55, 27648
    s_add_u32 s0, s57, 3072
    s_waitcnt vmcnt(8)
    buffer_load_dwordx4 v11, s[24:27], s0 offen offset:0 nt lds
    s_waitcnt vmcnt(8)
    buffer_load_dwordx4 v12, s[24:27], s0 offen offset:1024 nt lds
    ds_read_b64_tr_b16 a[120:121], v25 offset:6144
    ds_read_b64_tr_b16 a[124:125], v25 offset:6176
    ds_read_b64_tr_b16 a[128:129], v25 offset:6208
    ds_read_b64_tr_b16 a[132:133], v25 offset:6240
    ds_read_b64_tr_b16 a[136:137], v25 offset:6272
    ds_read_b64_tr_b16 a[140:141], v25 offset:6304
    ds_read_b64_tr_b16 a[144:145], v25 offset:6336
    ds_read_b64_tr_b16 a[148:149], v25 offset:6368
    ds_read_b64_tr_b16 a[152:153], v25 offset:6400
    ds_read_b64_tr_b16 a[156:157], v25 offset:6432
    s_add_u32 m0, s55, 30720
    s_waitcnt vmcnt(8)
    buffer_load_dwordx4 v16, s[32:35], s75 offen offset:2048 lds
    s_add_u32 m0, s55, 27648
    s_waitcnt vmcnt(8)
    buffer_load_dwordx4 v13, s[24:27], s0 offen offset:2048 nt lds
    s_add_u32 s57, s57, 24576
    s_sub_u32 s0, s57, 393216
    s_min_u32 s57, s57, s0
    ds_read_b64_tr_b16 v[142:143], v19 offset:12288
    ds_read_b64_tr_b16 v[146:147], v20 offset:12288
    ds_read_b64_tr_b16 v[150:151], v21 offset:12288
    ds_read_b64_tr_b16 v[154:155], v22 offset:12288
    ds_read_b64_tr_b16 v[158:159], v19 offset:12416
    ds_read_b64_tr_b16 v[162:163], v20 offset:12416
    ds_read_b64_tr_b16 v[166:167], v21 offset:12416
    ds_read_b64_tr_b16 v[170:171], v22 offset:12416
    ds_read_b64_tr_b16 v[174:175], v19 offset:12544
    ds_read_b64_tr_b16 v[178:179], v20 offset:12544
    ds_read_b64_tr_b16 v[182:183], v21 offset:12544
    ds_read_b64_tr_b16 v[186:187], v22 offset:12544
    s_add_u32 m0, s55, 18432
    s_waitcnt vmcnt(8)
    buffer_load_dwordx4 v11, s[24:27], s57 offen offset:0 nt lds
    s_waitcnt lgkmcnt(0)
    v_mfma_f32_16x16x32_bf16 v[92:95], v[140:143], v[192:195], v[92:95]
    v_mfma_f32_16x16x32_bf16 v[96:99], v[144:147], v[192:195], v[96:99]
    v_mfma_f32_16x16x32_bf16 v[100:103], v[148:151], v[192:195], v[100:103]
    v_mfma_f32_16x16x32_bf16 v[104:107], v[152:155], v[192:195], v[104:107]
    v_mfma_f32_16x16x32_bf16 v[108:111], v[156:159], v[192:195], v[108:111]
    v_mfma_f32_16x16x32_bf16 v[112:115], v[160:163], v[192:195], v[112:115]
    s_add_u32 m0, s55, 30720
    s_waitcnt vmcnt(8)
    buffer_load_dwordx4 v17, s[32:35], s75 offen offset:3072 lds
    v_mfma_f32_16x16x32_bf16 v[116:119], v[164:167], v[192:195], v[116:119]
    v_mfma_f32_16x16x32_bf16 v[120:123], v[168:171], v[192:195], v[120:123]
    v_mfma_f32_16x16x32_bf16 v[124:127], v[172:175], v[192:195], v[124:127]
    v_mfma_f32_16x16x32_bf16 v[128:131], v[176:179], v[192:195], v[128:131]
    v_mfma_f32_16x16x32_bf16 v[132:135], v[180:183], v[192:195], v[132:135]
    v_mfma_f32_16x16x32_bf16 v[136:139], v[184:187], v[192:195], v[136:139]
    s_add_u32 m0, s55, 18432
    s_waitcnt vmcnt(8)
    buffer_load_dwordx4 v12, s[24:27], s57 offen offset:1024 nt lds
    s_waitcnt vmcnt(8)
    buffer_load_dwordx4 v13, s[24:27], s57 offen offset:2048 nt lds
    s_add_u32 m0, s55, 34816
    s_waitcnt vmcnt(8)
    buffer_load_dwordx4 v18, s[32:35], s75 offen offset:0 lds
    s_add_u32 m0, s55, 21504
    s_add_u32 s0, s57, 3072
    s_waitcnt vmcnt(8)
    buffer_load_dwordx4 v11, s[24:27], s0 offen offset:0 nt lds
    s_waitcnt vmcnt(8)
    buffer_load_dwordx4 v12, s[24:27], s0 offen offset:1024 nt lds
    s_mov_b32 s75, 163840
    s_add_u32 m0, s55, 6144
    s_waitcnt vmcnt(8)
    buffer_load_dwordx4 v14, s[32:35], s75 offen offset:0 lds
    s_add_u32 m0, s55, 21504
    s_waitcnt vmcnt(8)
    buffer_load_dwordx4 v13, s[24:27], s0 offen offset:2048 nt lds
    s_add_u32 s57, s57, 24576
    s_sub_u32 s0, s57, 393216
    s_min_u32 s57, s57, s0
    ds_read_b64_tr_b16 v[140:141], v19 offset:24576
    ds_read_b64_tr_b16 v[144:145], v20 offset:24576
    ds_read_b64_tr_b16 v[148:149], v21 offset:24576
    ds_read_b64_tr_b16 v[152:153], v22 offset:24576
    ds_read_b64_tr_b16 v[156:157], v19 offset:24704
    ds_read_b64_tr_b16 v[160:161], v20 offset:24704
    ds_read_b64_tr_b16 v[164:165], v21 offset:24704
    ds_read_b64_tr_b16 v[168:169], v22 offset:24704
    ds_read_b64_tr_b16 v[172:173], v19 offset:24832
    ds_read_b64_tr_b16 v[176:177], v20 offset:24832
    ds_read_b64_tr_b16 v[180:181], v21 offset:24832
    ds_read_b64_tr_b16 v[184:185], v22 offset:24832
    s_add_u32 m0, s55, 0
    s_waitcnt vmcnt(8)
    buffer_load_dwordx4 v11, s[24:27], s57 offen offset:0 nt lds
    s_waitcnt vmcnt(8)
    buffer_load_dwordx4 v12, s[24:27], s57 offen offset:1024 nt lds
    s_add_u32 m0, s55, 6144
    s_waitcnt vmcnt(8)
    buffer_load_dwordx4 v15, s[32:35], s75 offen offset:1024 lds
    s_add_u32 m0, s55, 0
    s_waitcnt vmcnt(8)
    buffer_load_dwordx4 v13, s[24:27], s57 offen offset:2048 nt lds
    s_add_u32 m0, s55, 3072
    s_add_u32 s0, s57, 3072
    s_waitcnt vmcnt(8)
    buffer_load_dwordx4 v11, s[24:27], s0 offen offset:0 nt lds
    ds_read_b64_tr_b16 a[122:123], v25 offset:30720
    ds_read_b64_tr_b16 a[126:127], v25 offset:30752
    ds_read_b64_tr_b16 a[130:131], v25 offset:30784
    ds_read_b64_tr_b16 a[134:135], v25 offset:30816
    ds_read_b64_tr_b16 a[138:139], v25 offset:30848
    ds_read_b64_tr_b16 a[142:143], v25 offset:30880
    ds_read_b64_tr_b16 a[146:147], v25 offset:30912
    ds_read_b64_tr_b16 a[150:151], v25 offset:30944
    ds_read_b64_tr_b16 a[154:155], v25 offset:30976
    ds_read_b64_tr_b16 a[158:159], v25 offset:31008
    s_add_u32 m0, s55, 6144
    s_waitcnt vmcnt(8)
    buffer_load_dwordx4 v16, s[32:35], s75 offen offset:2048 lds
    s_add_u32 m0, s55, 3072
    s_waitcnt vmcnt(8)
    buffer_load_dwordx4 v12, s[24:27], s0 offen offset:1024 nt lds
    s_waitcnt vmcnt(8)
    buffer_load_dwordx4 v13, s[24:27], s0 offen offset:2048 nt lds
    s_add_u32 s57, s57, 24576
    s_sub_u32 s0, s57, 393216
    s_min_u32 s57, s57, s0
    s_add_u32 m0, s55, 6144
    s_waitcnt vmcnt(8)
    buffer_load_dwordx4 v17, s[32:35], s75 offen offset:3072 lds
    ds_read_b64_tr_b16 v[142:143], v19 offset:18432
    ds_read_b64_tr_b16 v[146:147], v20 offset:18432
    ds_read_b64_tr_b16 v[150:151], v21 offset:18432
    ds_read_b64_tr_b16 v[154:155], v22 offset:18432
    ds_read_b64_tr_b16 v[158:159], v19 offset:18560
    ds_read_b64_tr_b16 v[162:163], v20 offset:18560
    ds_read_b64_tr_b16 v[166:167], v21 offset:18560
    ds_read_b64_tr_b16 v[170:171], v22 offset:18560
    ds_read_b64_tr_b16 v[174:175], v19 offset:18688
    ds_read_b64_tr_b16 v[178:179], v20 offset:18688
    ds_read_b64_tr_b16 v[182:183], v21 offset:18688
    ds_read_b64_tr_b16 v[186:187], v22 offset:18688
    s_add_u32 m0, s55, 12288
    s_waitcnt vmcnt(8)
    buffer_load_dwordx4 v11, s[24:27], s57 offen offset:0 nt lds
    s_waitcnt lgkmcnt(0)
    v_mfma_f32_16x16x32_bf16 v[92:95], v[140:143], v[196:199], v[92:95]
    v_mfma_f32_16x16x32_bf16 v[96:99], v[144:147], v[196:199], v[96:99]
    v_mfma_f32_16x16x32_bf16 v[100:103], v[148:151], v[196:199], v[100:103]
    v_mfma_f32_16x16x32_bf16 v[104:107], v[152:155], v[196:199], v[104:107]
    v_mfma_f32_16x16x32_bf16 v[108:111], v[156:159], v[196:199], v[108:111]
    v_mfma_f32_16x16x32_bf16 v[112:115], v[160:163], v[196:199], v[112:115]
    s_waitcnt vmcnt(8)
    buffer_load_dwordx4 v12, s[24:27], s57 offen offset:1024 nt lds
    v_mfma_f32_16x16x32_bf16 v[116:119], v[164:167], v[196:199], v[116:119]
    v_mfma_f32_16x16x32_bf16 v[120:123], v[168:171], v[196:199], v[120:123]
    v_mfma_f32_16x16x32_bf16 v[124:127], v[172:175], v[196:199], v[124:127]
    v_mfma_f32_16x16x32_bf16 v[128:131], v[176:179], v[196:199], v[128:131]
    v_mfma_f32_16x16x32_bf16 v[132:135], v[180:183], v[196:199], v[132:135]
    v_mfma_f32_16x16x32_bf16 v[136:139], v[184:187], v[196:199], v[136:139]
    s_add_u32 m0, s55, 10240
    s_waitcnt vmcnt(8)
    buffer_load_dwordx4 v18, s[32:35], s75 offen offset:0 lds
    s_add_u32 m0, s55, 12288
    s_waitcnt vmcnt(8)
    buffer_load_dwordx4 v13, s[24:27], s57 offen offset:2048 nt lds
    s_add_u32 m0, s55, 15360
    s_add_u32 s0, s57, 3072
    s_waitcnt vmcnt(8)
    buffer_load_dwordx4 v11, s[24:27], s0 offen offset:0 nt lds
    s_mov_b32 s75, 184320
    s_add_u32 m0, s55, 30720
    s_waitcnt vmcnt(8)
    buffer_load_dwordx4 v14, s[32:35], s75 offen offset:0 lds
    s_add_u32 m0, s55, 15360
    s_waitcnt vmcnt(8)
    buffer_load_dwordx4 v12, s[24:27], s0 offen offset:1024 nt lds
    s_waitcnt vmcnt(8)
    buffer_load_dwordx4 v13, s[24:27], s0 offen offset:2048 nt lds
    s_add_u32 s57, s57, 24576
    s_sub_u32 s0, s57, 393216
    s_min_u32 s57, s57, s0
    ds_read_b64_tr_b16 v[140:141], v19 offset:0
    ds_read_b64_tr_b16 v[144:145], v20 offset:0
    ds_read_b64_tr_b16 v[148:149], v21 offset:0
    ds_read_b64_tr_b16 v[152:153], v22 offset:0
    ds_read_b64_tr_b16 v[156:157], v19 offset:128
    ds_read_b64_tr_b16 v[160:161], v20 offset:128
    ds_read_b64_tr_b16 v[164:165], v21 offset:128
    ds_read_b64_tr_b16 v[168:169], v22 offset:128
    ds_read_b64_tr_b16 v[172:173], v19 offset:256
    ds_read_b64_tr_b16 v[176:177], v20 offset:256
    ds_read_b64_tr_b16 v[180:181], v21 offset:256
    ds_read_b64_tr_b16 v[184:185], v22 offset:256
    s_add_u32 m0, s55, 18432
    s_waitcnt vmcnt(8)
    buffer_load_dwordx4 v11, s[24:27], s57 offen offset:0 nt lds
    s_add_u32 m0, s55, 30720
    s_waitcnt vmcnt(8)
    buffer_load_dwordx4 v15, s[32:35], s75 offen offset:1024 lds
    s_add_u32 m0, s55, 18432
    s_waitcnt vmcnt(8)
    buffer_load_dwordx4 v12, s[24:27], s57 offen offset:1024 nt lds
    s_waitcnt vmcnt(8)
    buffer_load_dwordx4 v13, s[24:27], s57 offen offset:2048 nt lds
    ds_read_b64_tr_b16 a[160:161], v25 offset:6144
    ds_read_b64_tr_b16 a[164:165], v25 offset:6176
    ds_read_b64_tr_b16 a[168:169], v25 offset:6208
    ds_read_b64_tr_b16 a[172:173], v25 offset:6240
    ds_read_b64_tr_b16 a[176:177], v25 offset:6272
    ds_read_b64_tr_b16 a[180:181], v25 offset:6304
    ds_read_b64_tr_b16 a[184:185], v25 offset:6336
    ds_read_b64_tr_b16 a[188:189], v25 offset:6368
    ds_read_b64_tr_b16 a[192:193], v25 offset:6400
    ds_read_b64_tr_b16 a[196:197], v25 offset:6432
    s_add_u32 m0, s55, 30720
    s_waitcnt vmcnt(8)
    buffer_load_dwordx4 v16, s[32:35], s75 offen offset:2048 lds
    s_add_u32 m0, s55, 21504
    s_add_u32 s0, s57, 3072
    s_waitcnt vmcnt(8)
    buffer_load_dwordx4 v11, s[24:27], s0 offen offset:0 nt lds
    s_waitcnt vmcnt(8)
    buffer_load_dwordx4 v12, s[24:27], s0 offen offset:1024 nt lds
    s_add_u32 m0, s55, 30720
    s_waitcnt vmcnt(8)
    buffer_load_dwordx4 v17, s[32:35], s75 offen offset:3072 lds
    s_add_u32 m0, s55, 21504
    s_waitcnt vmcnt(8)
    buffer_load_dwordx4 v13, s[24:27], s0 offen offset:2048 nt lds
    s_add_u32 s57, s57, 24576
    s_sub_u32 s0, s57, 393216
    s_min_u32 s57, s57, s0
    ds_read_b64_tr_b16 v[142:143], v19 offset:12288
    ds_read_b64_tr_b16 v[146:147], v20 offset:12288
    ds_read_b64_tr_b16 v[150:151], v21 offset:12288
    ds_read_b64_tr_b16 v[154:155], v22 offset:12288
    ds_read_b64_tr_b16 v[158:159], v19 offset:12416
    ds_read_b64_tr_b16 v[162:163], v20 offset:12416
    ds_read_b64_tr_b16 v[166:167], v21 offset:12416
    ds_read_b64_tr_b16 v[170:171], v22 offset:12416
    ds_read_b64_tr_b16 v[174:175], v19 offset:12544
    ds_read_b64_tr_b16 v[178:179], v20 offset:12544
    ds_read_b64_tr_b16 v[182:183], v21 offset:12544
    ds_read_b64_tr_b16 v[186:187], v22 offset:12544
    s_add_u32 m0, s55, 24576
    s_waitcnt vmcnt(8)
    buffer_load_dwordx4 v11, s[24:27], s57 offen offset:0 nt lds
    s_waitcnt lgkmcnt(0)
    v_mfma_f32_16x16x32_bf16 v[92:95], v[140:143], v[200:203], v[92:95]
    v_mfma_f32_16x16x32_bf16 v[96:99], v[144:147], v[200:203], v[96:99]
    v_mfma_f32_16x16x32_bf16 v[100:103], v[148:151], v[200:203], v[100:103]
    v_mfma_f32_16x16x32_bf16 v[104:107], v[152:155], v[200:203], v[104:107]
    v_mfma_f32_16x16x32_bf16 v[108:111], v[156:159], v[200:203], v[108:111]
    v_mfma_f32_16x16x32_bf16 v[112:115], v[160:163], v[200:203], v[112:115]
    s_add_u32 m0, s55, 34816
    s_waitcnt vmcnt(8)
    buffer_load_dwordx4 v18, s[32:35], s75 offen offset:0 lds
    v_mfma_f32_16x16x32_bf16 v[116:119], v[164:167], v[200:203], v[116:119]
    v_mfma_f32_16x16x32_bf16 v[120:123], v[168:171], v[200:203], v[120:123]
    v_mfma_f32_16x16x32_bf16 v[124:127], v[172:175], v[200:203], v[124:127]
    v_mfma_f32_16x16x32_bf16 v[128:131], v[176:179], v[200:203], v[128:131]
    v_mfma_f32_16x16x32_bf16 v[132:135], v[180:183], v[200:203], v[132:135]
    v_mfma_f32_16x16x32_bf16 v[136:139], v[184:187], v[200:203], v[136:139]
    s_add_u32 m0, s55, 24576
    s_waitcnt vmcnt(8)
    buffer_load_dwordx4 v12, s[24:27], s57 offen offset:1024 nt lds
    s_waitcnt vmcnt(8)
    buffer_load_dwordx4 v13, s[24:27], s57 offen offset:2048 nt lds
    s_mov_b32 s75, 204800
    s_add_u32 m0, s55, 0
    s_waitcnt vmcnt(8)
    buffer_load_dwordx4 v14, s[32:35], s75 offen offset:0 lds
    s_add_u32 m0, s55, 27648
    s_add_u32 s0, s57, 3072
    s_waitcnt vmcnt(8)
    buffer_load_dwordx4 v11, s[24:27], s0 offen offset:0 nt lds
    s_waitcnt vmcnt(8)
    buffer_load_dwordx4 v12, s[24:27], s0 offen offset:1024 nt lds
    s_waitcnt vmcnt(8)
    buffer_load_dwordx4 v13, s[24:27], s0 offen offset:2048 nt lds
    s_add_u32 s57, s57, 24576
    s_sub_u32 s0, s57, 393216
    s_min_u32 s57, s57, s0
    s_add_u32 m0, s55, 0
    s_waitcnt vmcnt(8)
    buffer_load_dwordx4 v15, s[32:35], s75 offen offset:1024 lds
    ds_read_b64_tr_b16 v[140:141], v19 offset:18432
    ds_read_b64_tr_b16 v[144:145], v20 offset:18432
    ds_read_b64_tr_b16 v[148:149], v21 offset:18432
    ds_read_b64_tr_b16 v[152:153], v22 offset:18432
    ds_read_b64_tr_b16 v[156:157], v19 offset:18560
    ds_read_b64_tr_b16 v[160:161], v20 offset:18560
    ds_read_b64_tr_b16 v[164:165], v21 offset:18560
    ds_read_b64_tr_b16 v[168:169], v22 offset:18560
    ds_read_b64_tr_b16 v[172:173], v19 offset:18688
    ds_read_b64_tr_b16 v[176:177], v20 offset:18688
    ds_read_b64_tr_b16 v[180:181], v21 offset:18688
    ds_read_b64_tr_b16 v[184:185], v22 offset:18688
    s_add_u32 m0, s55, 12288
    s_waitcnt vmcnt(8)
    buffer_load_dwordx4 v11, s[24:27], s57 offen offset:0 nt lds
    s_waitcnt vmcnt(8)
    buffer_load_dwordx4 v12, s[24:27], s57 offen offset:1024 nt lds
    ds_read_b64_tr_b16 a[162:163], v25 offset:30720
    ds_read_b64_tr_b16 a[166:167], v25 offset:30752
    ds_read_b64_tr_b16 a[170:171], v25 offset:30784
    ds_read_b64_tr_b16 a[174:175], v25 offset:30816
    ds_read_b64_tr_b16 a[178:179], v25 offset:30848
    ds_read_b64_tr_b16 a[182:183], v25 offset:30880
    ds_read_b64_tr_b16 a[186:187], v25 offset:30912
    ds_read_b64_tr_b16 a[190:191], v25 offset:30944
    ds_read_b64_tr_b16 a[194:195], v25 offset:30976
    ds_read_b64_tr_b16 a[198:199], v25 offset:31008
    s_add_u32 m0, s55, 0
    s_waitcnt vmcnt(8)
    buffer_load_dwordx4 v16, s[32:35], s75 offen offset:2048 lds
    s_add_u32 m0, s55, 12288
    s_waitcnt vmcnt(8)
    buffer_load_dwordx4 v13, s[24:27], s57 offen offset:2048 nt lds
    s_add_u32 m0, s55, 15360
    s_add_u32 s0, s57, 3072
    s_waitcnt vmcnt(8)
    buffer_load_dwordx4 v11, s[24:27], s0 offen offset:0 nt lds
    s_add_u32 m0, s55, 0
    s_waitcnt vmcnt(8)
    buffer_load_dwordx4 v17, s[32:35], s75 offen offset:3072 lds
    s_add_u32 m0, s55, 15360
    s_waitcnt vmcnt(8)
    buffer_load_dwordx4 v12, s[24:27], s0 offen offset:1024 nt lds
    s_waitcnt vmcnt(8)
    buffer_load_dwordx4 v13, s[24:27], s0 offen offset:2048 nt lds
    s_add_u32 s57, s57, 24576
    s_sub_u32 s0, s57, 393216
    s_min_u32 s57, s57, s0
    ds_read_b64_tr_b16 v[142:143], v19 offset:24576
    ds_read_b64_tr_b16 v[146:147], v20 offset:24576
    ds_read_b64_tr_b16 v[150:151], v21 offset:24576
    ds_read_b64_tr_b16 v[154:155], v22 offset:24576
    ds_read_b64_tr_b16 v[158:159], v19 offset:24704
    ds_read_b64_tr_b16 v[162:163], v20 offset:24704
    ds_read_b64_tr_b16 v[166:167], v21 offset:24704
    ds_read_b64_tr_b16 v[170:171], v22 offset:24704
    ds_read_b64_tr_b16 v[174:175], v19 offset:24832
    ds_read_b64_tr_b16 v[178:179], v20 offset:24832
    ds_read_b64_tr_b16 v[182:183], v21 offset:24832
    ds_read_b64_tr_b16 v[186:187], v22 offset:24832
    s_add_u32 m0, s55, 4096
    s_waitcnt vmcnt(8)
    buffer_load_dwordx4 v18, s[32:35], s75 offen offset:0 lds
    s_waitcnt lgkmcnt(0)
    v_mfma_f32_16x16x32_bf16 v[92:95], v[140:143], v[204:207], v[92:95]
    v_mfma_f32_16x16x32_bf16 v[96:99], v[144:147], v[204:207], v[96:99]
    v_mfma_f32_16x16x32_bf16 v[100:103], v[148:151], v[204:207], v[100:103]
    v_mfma_f32_16x16x32_bf16 v[104:107], v[152:155], v[204:207], v[104:107]
    v_mfma_f32_16x16x32_bf16 v[108:111], v[156:159], v[204:207], v[108:111]
    v_mfma_f32_16x16x32_bf16 v[112:115], v[160:163], v[204:207], v[112:115]
    s_add_u32 m0, s55, 30720
    s_waitcnt vmcnt(8)
    buffer_load_dwordx4 v11, s[24:27], s57 offen offset:0 nt lds
    v_mfma_f32_16x16x32_bf16 v[116:119], v[164:167], v[204:207], v[116:119]
    v_mfma_f32_16x16x32_bf16 v[120:123], v[168:171], v[204:207], v[120:123]
    v_mfma_f32_16x16x32_bf16 v[124:127], v[172:175], v[204:207], v[124:127]
    v_mfma_f32_16x16x32_bf16 v[128:131], v[176:179], v[204:207], v[128:131]
    v_mfma_f32_16x16x32_bf16 v[132:135], v[180:183], v[204:207], v[132:135]
    v_mfma_f32_16x16x32_bf16 v[136:139], v[184:187], v[204:207], v[136:139]
    s_waitcnt vmcnt(8)
    buffer_load_dwordx4 v12, s[24:27], s57 offen offset:1024 nt lds
    s_mov_b32 s75, 225280
    s_add_u32 m0, s55, 6144
    s_waitcnt vmcnt(8)
    buffer_load_dwordx4 v14, s[32:35], s75 offen offset:0 lds
    s_add_u32 m0, s55, 30720
    s_waitcnt vmcnt(8)
    buffer_load_dwordx4 v13, s[24:27], s57 offen offset:2048 nt lds
    s_add_u32 m0, s55, 33792
    s_add_u32 s0, s57, 3072
    s_waitcnt vmcnt(8)
    buffer_load_dwordx4 v11, s[24:27], s0 offen offset:0 nt lds
    s_waitcnt vmcnt(8)
    buffer_load_dwordx4 v12, s[24:27], s0 offen offset:1024 nt lds
    s_add_u32 m0, s55, 6144
    s_waitcnt vmcnt(8)
    buffer_load_dwordx4 v15, s[32:35], s75 offen offset:1024 lds
    s_add_u32 m0, s55, 33792
    s_waitcnt vmcnt(8)
    buffer_load_dwordx4 v13, s[24:27], s0 offen offset:2048 nt lds
    s_add_u32 s57, s57, 24576
    s_sub_u32 s0, s57, 393216
    s_min_u32 s57, s57, s0
    ds_read_b64_tr_b16 v[140:141], v19 offset:12288
    ds_read_b64_tr_b16 v[144:145], v20 offset:12288
    ds_read_b64_tr_b16 v[148:149], v21 offset:12288
    ds_read_b64_tr_b16 v[152:153], v22 offset:12288
    ds_read_b64_tr_b16 v[156:157], v19 offset:12416
    ds_read_b64_tr_b16 v[160:161], v20 offset:12416
    ds_read_b64_tr_b16 v[164:165], v21 offset:12416
    ds_read_b64_tr_b16 v[168:169], v22 offset:12416
    ds_read_b64_tr_b16 v[172:173], v19 offset:12544
    ds_read_b64_tr_b16 v[176:177], v20 offset:12544
    ds_read_b64_tr_b16 v[180:181], v21 offset:12544
    ds_read_b64_tr_b16 v[184:185], v22 offset:12544
    s_waitcnt lgkmcnt(0)
    s_mov_b32 s8, s57
    s_add_u32 s9, s8, 24576
    s_sub_u32 s0, s9, 393216
    s_min_u32 s9, s9, s0
    s_add_u32 s10, s9, 24576
    s_sub_u32 s0, s10, 393216
    s_min_u32 s10, s10, s0
    s_add_u32 s11, s10, 24576
    s_sub_u32 s0, s11, 393216
    s_min_u32 s11, s11, s0
    s_add_u32 m0, s55, 12288
    s_waitcnt vmcnt(8)
    buffer_load_dwordx4 v27, s[24:27], s8 offen offset:0 nt lds
    ds_read_b64_tr_b16 a[200:201], v25 offset:0
    ds_read_b64_tr_b16 a[204:205], v25 offset:32
    ds_read_b64_tr_b16 a[208:209], v25 offset:64
    ds_read_b64_tr_b16 a[212:213], v25 offset:96
    ds_read_b64_tr_b16 a[216:217], v25 offset:128
    ds_read_b64_tr_b16 a[220:221], v25 offset:160
    ds_read_b64_tr_b16 a[224:225], v25 offset:192
    ds_read_b64_tr_b16 a[228:229], v25 offset:224
    ds_read_b64_tr_b16 a[232:233], v25 offset:256
    ds_read_b64_tr_b16 a[236:237], v25 offset:288
    s_add_u32 m0, s55, 6144
    s_waitcnt vmcnt(8)
    buffer_load_dwordx4 v16, s[32:35], s75 offen offset:2048 lds
    s_add_u32 m0, s55, 12288
    s_waitcnt vmcnt(8)
    buffer_load_dwordx4 v27, s[24:27], s8 offen offset:3072 nt lds
    s_add_u32 m0, s55, 18432
    s_waitcnt vmcnt(8)
    buffer_load_dwordx4 v27, s[24:27], s9 offen offset:0 nt lds
    s_add_u32 m0, s55, 6144
    s_waitcnt vmcnt(8)
    buffer_load_dwordx4 v17, s[32:35], s75 offen offset:3072 lds
    s_add_u32 m0, s55, 18432
    s_waitcnt vmcnt(8)
    buffer_load_dwordx4 v27, s[24:27], s9 offen offset:3072 nt lds
    s_add_u32 m0, s55, 24576
    s_waitcnt vmcnt(8)
    buffer_load_dwordx4 v27, s[24:27], s10 offen offset:0 nt lds
    s_add_u32 m0, s55, 10240
    s_waitcnt vmcnt(8)
    buffer_load_dwordx4 v18, s[32:35], s75 offen offset:0 lds
    s_add_u32 m0, s55, 24576
    s_waitcnt vmcnt(8)
    buffer_load_dwordx4 v27, s[24:27], s10 offen offset:3072 nt lds
    ds_read_b64_tr_b16 v[142:143], v19 offset:30720
    ds_read_b64_tr_b16 v[146:147], v20 offset:30720
    ds_read_b64_tr_b16 v[150:151], v21 offset:30720
    ds_read_b64_tr_b16 v[154:155], v22 offset:30720
    ds_read_b64_tr_b16 v[158:159], v19 offset:30848
    ds_read_b64_tr_b16 v[162:163], v20 offset:30848
    ds_read_b64_tr_b16 v[166:167], v21 offset:30848
    ds_read_b64_tr_b16 v[170:171], v22 offset:30848
    ds_read_b64_tr_b16 v[174:175], v19 offset:30976
    ds_read_b64_tr_b16 v[178:179], v20 offset:30976
    ds_read_b64_tr_b16 v[182:183], v21 offset:30976
    ds_read_b64_tr_b16 v[186:187], v22 offset:30976
    s_waitcnt lgkmcnt(0)
    v_mfma_f32_16x16x32_bf16 v[92:95], v[140:143], v[208:211], v[92:95]
    v_mfma_f32_16x16x32_bf16 v[96:99], v[144:147], v[208:211], v[96:99]
    v_mfma_f32_16x16x32_bf16 v[100:103], v[148:151], v[208:211], v[100:103]
    v_mfma_f32_16x16x32_bf16 v[104:107], v[152:155], v[208:211], v[104:107]
    v_mfma_f32_16x16x32_bf16 v[108:111], v[156:159], v[208:211], v[108:111]
    v_mfma_f32_16x16x32_bf16 v[112:115], v[160:163], v[208:211], v[112:115]
    s_add_u32 m0, s55, 30720
    s_waitcnt vmcnt(8)
    buffer_load_dwordx4 v27, s[24:27], s11 offen offset:0 nt lds
    v_mfma_f32_16x16x32_bf16 v[116:119], v[164:167], v[208:211], v[116:119]
    v_mfma_f32_16x16x32_bf16 v[120:123], v[168:171], v[208:211], v[120:123]
    v_mfma_f32_16x16x32_bf16 v[124:127], v[172:175], v[208:211], v[124:127]
    v_mfma_f32_16x16x32_bf16 v[128:131], v[176:179], v[208:211], v[128:131]
    v_mfma_f32_16x16x32_bf16 v[132:135], v[180:183], v[208:211], v[132:135]
    v_mfma_f32_16x16x32_bf16 v[136:139], v[184:187], v[208:211], v[136:139]
    s_waitcnt vmcnt(8)
    buffer_load_dwordx4 v27, s[24:27], s11 offen offset:3072 nt lds
    s_add_u32 m0, s55, 13184
    s_waitcnt vmcnt(8)
    buffer_load_dwordx4 v27, s[24:27], s8 offen offset:128 nt lds
    s_waitcnt vmcnt(8)
    buffer_load_dwordx4 v27, s[24:27], s8 offen offset:3200 nt lds
    s_add_u32 m0, s55, 19328
    s_waitcnt vmcnt(8)
    buffer_load_dwordx4 v27, s[24:27], s9 offen offset:128 nt lds
    s_waitcnt vmcnt(8)
    buffer_load_dwordx4 v27, s[24:27], s9 offen offset:3200 nt lds
    s_add_u32 m0, s55, 25472
    s_waitcnt vmcnt(8)
    buffer_load_dwordx4 v27, s[24:27], s10 offen offset:128 nt lds
    s_waitcnt vmcnt(8)
    buffer_load_dwordx4 v27, s[24:27], s10 offen offset:3200 nt lds
    ds_read_b64_tr_b16 a[202:203], v25 offset:6144
    ds_read_b64_tr_b16 a[206:207], v25 offset:6176
    ds_read_b64_tr_b16 a[210:211], v25 offset:6208
    ds_read_b64_tr_b16 a[214:215], v25 offset:6240
    ds_read_b64_tr_b16 a[218:219], v25 offset:6272
    ds_read_b64_tr_b16 a[222:223], v25 offset:6304
    ds_read_b64_tr_b16 a[226:227], v25 offset:6336
    ds_read_b64_tr_b16 a[230:231], v25 offset:6368
    ds_read_b64_tr_b16 a[234:235], v25 offset:6400
    ds_read_b64_tr_b16 a[238:239], v25 offset:6432
    s_add_u32 m0, s55, 31616
    s_nop 0
    buffer_load_dwordx4 v27, s[24:27], s11 offen offset:128 nt lds
    s_waitcnt vmcnt(9)
    buffer_load_dwordx4 v27, s[24:27], s11 offen offset:3200 nt lds
    s_add_u32 m0, s55, 14080
    s_waitcnt vmcnt(9)
    buffer_load_dwordx4 v27, s[24:27], s8 offen offset:256 nt lds
    s_waitcnt vmcnt(9)
    buffer_load_dwordx4 v27, s[24:27], s8 offen offset:3328 nt lds
    s_add_u32 m0, s55, 20224
    s_waitcnt vmcnt(9)
    buffer_load_dwordx4 v27, s[24:27], s9 offen offset:256 nt lds
    s_waitcnt vmcnt(9)
    buffer_load_dwordx4 v27, s[24:27], s9 offen offset:3328 nt lds
    s_branch L_tail
L_G2:
    s_add_u32 m0, s55, 6144
    s_nop 0
    buffer_load_dwordx4 v5, s[20:23], s57 offen offset:0 nt lds
    buffer_load_dwordx4 v6, s[20:23], s57 offen offset:1024 nt lds
    buffer_load_dwordx4 v7, s[20:23], s57 offen offset:2048 nt lds
    s_add_u32 m0, s55, 9216
    s_add_u32 s0, s57, 3072
    buffer_load_dwordx4 v8, s[20:23], s0 offen offset:0 nt lds
    v_lshrrev_b32 v46, 4, v1
    v_and_b32 v41, 3, v1
    v_mul_u32_u24 v40, 320, v41
    v_lshl_add_u32 v40, v46, 3, v40
    v_add_u32 v26, s3, v40
    v_lshl_add_u32 v41, v41, 3, s55
    v_bfe_u32 v40, v1, 2, 3
    v_lshl_add_u32 v41, v40, 7, v41
    v_lshrrev_b32 v40, 5, v1
    v_mul_u32_u24 v40, 3072, v40
    v_add_u32 v41, v40, v41
    v_bfe_u32 v42, v1, 3, 2
    v_xor_b32 v43, 0, v42
    v_lshl_add_u32 v252, v43, 5, v41
    v_xor_b32 v43, 1, v42
    v_lshl_add_u32 v253, v43, 5, v41
    v_xor_b32 v43, 2, v42
    v_lshl_add_u32 v254, v43, 5, v41
    v_xor_b32 v43, 3, v42
    v_lshl_add_u32 v255, v43, 5, v41
    s_waitcnt vmcnt(11)
    buffer_load_dwordx4 v9, s[20:23], s0 offen offset:1024 nt lds
    s_waitcnt vmcnt(11)
    buffer_load_dwordx4 v10, s[20:23], s0 offen offset:2048 nt lds
    s_add_u32 s57, s57, 24576
    s_sub_u32 s0, s57, 393216
    s_min_u32 s57, s57, s0
    s_add_u32 m0, s55, 12288
    s_waitcnt vmcnt(11)
    buffer_load_dwordx4 v5, s[20:23], s57 offen offset:0 nt lds
    s_waitcnt vmcnt(11)
    buffer_load_dwordx4 v6, s[20:23], s57 offen offset:1024 nt lds
    s_waitcnt vmcnt(11)
    buffer_load_dwordx4 v7, s[20:23], s57 offen offset:2048 nt lds
    s_add_u32 m0, s55, 15360
    s_add_u32 s0, s57, 3072
    s_waitcnt vmcnt(11)
    buffer_load_dwordx4 v8, s[20:23], s0 offen offset:0 nt lds
    s_waitcnt vmcnt(11)
    buffer_load_dwordx4 v9, s[20:23], s0 offen offset:1024 nt lds
    s_waitcnt vmcnt(11)
    buffer_load_dwordx4 v10, s[20:23], s0 offen offset:2048 nt lds
    s_add_u32 s57, s57, 24576
    s_sub_u32 s0, s57, 393216
    s_min_u32 s57, s57, s0
    s_waitcnt vmcnt(11)
    buffer_load_dwordx4 a[0:3], v5, s[20:23], s57 offen offset:0 nt
    s_waitcnt vmcnt(11)
    buffer_load_dwordx4 a[4:7], v6, s[20:23], s57 offen offset:1024 nt
    s_waitcnt vmcnt(11)
    buffer_load_dwordx4 a[8:11], v7, s[20:23], s57 offen offset:2048 nt
    s_add_u32 s0, s57, 3072
    s_waitcnt vmcnt(11)
    buffer_load_dwordx4 a[12:15], v8, s[20:23], s0 offen offset:0 nt
    s_waitcnt vmcnt(11)
    buffer_load_dwordx4 a[16:19], v9, s[20:23], s0 offen offset:1024 nt
    s_waitcnt vmcnt(11)
    buffer_load_dwordx4 a[20:23], v10, s[20:23], s0 offen offset:2048 nt
    s_add_u32 s57, s57, 24576
    s_sub_u32 s0, s57, 393216
    s_min_u32 s57, s57, s0
    s_waitcnt vmcnt(11)
    buffer_load_dwordx4 a[24:27], v5, s[20:23], s57 offen offset:0 nt
    s_waitcnt vmcnt(11)
    buffer_load_dwordx4 a[28:31], v6, s[20:23], s57 offen offset:1024 nt
    s_waitcnt vmcnt(11)
    buffer_load_dwordx4 a[32:35], v7, s[20:23], s57 offen offset:2048 nt
    s_add_u32 s0, s57, 3072
    s_waitcnt vmcnt(11)
    buffer_load_dwordx4 a[36:39], v8, s[20:23], s0 offen offset:0 nt
    s_waitcnt vmcnt(11)
    buffer_load_dwordx4 a[40:43], v9, s[20:23], s0 offen offset:1024 nt
    s_waitcnt vmcnt(11)
    buffer_load_dwordx4 a[44:47], v10, s[20:23], s0 offen offset:2048 nt
    s_add_u32 s57, s57, 24576
    s_sub_u32 s0, s57, 393216
    s_min_u32 s57, s57, s0
    s_waitcnt vmcnt(11)
    buffer_load_dwordx4 a[48:51], v5, s[20:23], s57 offen offset:0 nt
    s_waitcnt vmcnt(11)
    buffer_load_dwordx4 a[52:55], v6, s[20:23], s57 offen offset:1024 nt
    s_waitcnt vmcnt(11)
    buffer_load_dwordx4 a[56:59], v7, s[20:23], s57 offen offset:2048 nt
    s_add_u32 s0, s57, 3072
    s_waitcnt vmcnt(11)
    buffer_load_dwordx4 a[60:63], v8, s[20:23], s0 offen offset:0 nt
    s_waitcnt vmcnt(11)
    buffer_load_dwordx4 a[64:67], v9, s[20:23], s0 offen offset:1024 nt
    s_waitcnt vmcnt(11)
    buffer_load_dwordx4 a[68:71], v10, s[20:23], s0 offen offset:2048 nt
    s_add_u32 s57, s57, 24576
    s_sub_u32 s0, s57, 393216
    s_min_u32 s57, s57, s0
    s_add_u32 m0, s55, 18432
    s_waitcnt vmcnt(11)
    buffer_load_dwordx4 v2, s[28:31], s74 offen offset:0 lds
    s_waitcnt vmcnt(11)
    buffer_load_dwordx4 v3, s[28:31], s74 offen offset:1024 lds
    s_waitcnt vmcnt(11)
    buffer_load_dwordx4 v4, s[28:31], s74 offen offset:2048 lds
    s_add_u32 m0, s55, 21504
    s_add_u32 s75, s74, 98304
    s_waitcnt vmcnt(11)
    buffer_load_dwordx4 v2, s[28:31], s75 offen offset:0 lds
    s_waitcnt vmcnt(11)
    buffer_load_dwordx4 v3, s[28:31], s75 offen offset:1024 lds
    s_waitcnt vmcnt(11)
    buffer_load_dwordx4 v4, s[28:31], s75 offen offset:2048 lds
    s_add_u32 s74, s74, 196608
    s_cmp_eq_u32 s74, 7864320
    s_cselect_b32 s74, 0, s74
    s_add_u32 m0, s55, 24576
    s_waitcnt vmcnt(11)
    buffer_load_dwordx4 v2, s[28:31], s74 offen offset:0 lds
    s_waitcnt vmcnt(11)
    buffer_load_dwordx4 v3, s[28:31], s74 offen offset:1024 lds
    s_waitcnt vmcnt(11)
    buffer_load_dwordx4 v4, s[28:31], s74 offen offset:2048 lds
    s_add_u32 m0, s55, 27648
    s_add_u32 s75, s74, 98304
    s_waitcnt vmcnt(11)
    buffer_load_dwordx4 v2, s[28:31], s75 offen offset:0 lds
    s_waitcnt vmcnt(11)
    buffer_load_dwordx4 v3, s[28:31], s75 offen offset:1024 lds
    s_waitcnt vmcnt(11)
    buffer_load_dwordx4 v4, s[28:31], s75 offen offset:2048 lds
    s_add_u32 s74, s74, 196608
    s_cmp_eq_u32 s74, 7864320
    s_cselect_b32 s74, 0, s74
    s_add_u32 m0, s55, 30720
    s_waitcnt vmcnt(11)
    buffer_load_dwordx4 v2, s[28:31], s74 offen offset:0 lds
    s_waitcnt vmcnt(11)
    buffer_load_dwordx4 v3, s[28:31], s74 offen offset:1024 lds
    s_waitcnt vmcnt(11)
    buffer_load_dwordx4 v4, s[28:31], s74 offen offset:2048 lds
    s_add_u32 m0, s55, 33792
    s_add_u32 s75, s74, 98304
    s_waitcnt vmcnt(11)
    buffer_load_dwordx4 v2, s[28:31], s75 offen offset:0 lds
    s_waitcnt vmcnt(11)
    buffer_load_dwordx4 v3, s[28:31], s75 offen offset:1024 lds
    s_waitcnt vmcnt(11)
    buffer_load_dwordx4 v4, s[28:31], s75 offen offset:2048 lds
    s_add_u32 s74, s74, 196608
    s_cmp_eq_u32 s74, 7864320
    s_cselect_b32 s74, 0, s74
    ds_read_b64_tr_b16 v[140:141], v252 offset:18432
    ds_read_b64_tr_b16 v[144:145], v253 offset:18432
    ds_read_b64_tr_b16 v[148:149], v254 offset:18432
    ds_read_b64_tr_b16 v[152:153], v255 offset:18432
    ds_read_b64_tr_b16 v[156:157], v252 offset:19456
    ds_read_b64_tr_b16 v[160:161], v253 offset:19456
    ds_read_b64_tr_b16 v[164:165], v254 offset:19456
    ds_read_b64_tr_b16 v[168:169], v255 offset:19456
    ds_read_b64_tr_b16 v[172:173], v252 offset:20480
    ds_read_b64_tr_b16 v[176:177], v253 offset:20480
    ds_read_b64_tr_b16 v[180:181], v254 offset:20480
    ds_read_b64_tr_b16 v[184:185], v255 offset:20480
    s_waitcnt lgkmcnt(0)
    s_add_u32 m0, s55, 18432
    s_waitcnt vmcnt(11)
    buffer_load_dwordx4 v2, s[28:31], s74 offen offset:0 lds
    s_waitcnt vmcnt(11)
    buffer_load_dwordx4 v3, s[28:31], s74 offen offset:1024 lds
    s_waitcnt vmcnt(11)
    buffer_load_dwordx4 v4, s[28:31], s74 offen offset:2048 lds
    s_add_u32 m0, s55, 21504
    s_add_u32 s75, s74, 98304
    s_waitcnt vmcnt(11)
    buffer_load_dwordx4 v2, s[28:31], s75 offen offset:0 lds
    s_waitcnt vmcnt(11)
    buffer_load_dwordx4 v3, s[28:31], s75 offen offset:1024 lds
    s_waitcnt vmcnt(11)
    buffer_load_dwordx4 v4, s[28:31], s75 offen offset:2048 lds
    s_add_u32 s74, s74, 196608
    s_cmp_eq_u32 s74, 7864320
    s_cselect_b32 s74, 0, s74
    ds_read_b64 v[48:49], v26 offset:0
    ds_read_b64 v[50:51], v26 offset:32
    ds_read_b64 v[52:53], v26 offset:64
    ds_read_b64 v[54:55], v26 offset:96
    ds_read_b64 v[56:57], v26 offset:128
    ds_read_b64 v[58:59], v26 offset:160
    ds_read_b64 v[60:61], v26 offset:192
    ds_read_b64 v[62:63], v26 offset:224
    ds_read_b64 v[64:65], v26 offset:256
    ds_read_b64 v[66:67], v26 offset:288
    ds_read_b64_tr_b16 v[142:143], v252 offset:24576
    ds_read_b64_tr_b16 v[146:147], v253 offset:24576
    ds_read_b64_tr_b16 v[150:151], v254 offset:24576
    ds_read_b64_tr_b16 v[154:155], v255 offset:24576
    ds_read_b64_tr_b16 v[158:159], v252 offset:25600
    ds_read_b64_tr_b16 v[162:163], v253 offset:25600
    ds_read_b64_tr_b16 v[166:167], v254 offset:25600
    ds_read_b64_tr_b16 v[170:171], v255 offset:25600
    ds_read_b64_tr_b16 v[174:175], v252 offset:26624
    ds_read_b64_tr_b16 v[178:179], v253 offset:26624
    ds_read_b64_tr_b16 v[182:183], v254 offset:26624
    ds_read_b64_tr_b16 v[186:187], v255 offset:26624
    s_waitcnt lgkmcnt(0)
    v_mfma_f32_16x16x32_bf16 v[92:95], v[140:143], v[48:51], 0
    v_mfma_f32_16x16x32_bf16 v[96:99], v[144:147], v[48:51], 0
    s_add_u32 m0, s55, 24576
    s_waitcnt vmcnt(11)
    buffer_load_dwordx4 v2, s[28:31], s74 offen offset:0 lds
    v_mfma_f32_16x16x32_bf16 v[100:103], v[148:151], v[48:51], 0
    v_mfma_f32_16x16x32_bf16 v[104:107], v[152:155], v[48:51], 0
    s_waitcnt vmcnt(11)
    buffer_load_dwordx4 v3, s[28:31], s74 offen offset:1024 lds
    v_mfma_f32_16x16x32_bf16 v[108:111], v[156:159], v[48:51], 0
    v_mfma_f32_16x16x32_bf16 v[112:115], v[160:163], v[48:51], 0
    s_waitcnt vmcnt(11)
    buffer_load_dwordx4 v4, s[28:31], s74 offen offset:2048 lds
    v_mfma_f32_16x16x32_bf16 v[116:119], v[164:167], v[48:51], 0
    v_mfma_f32_16x16x32_bf16 v[120:123], v[168:171], v[48:51], 0
    s_add_u32 m0, s55, 27648
    s_add_u32 s75, s74, 98304
    s_waitcnt vmcnt(11)
    buffer_load_dwordx4 v2, s[28:31], s75 offen offset:0 lds
    v_mfma_f32_16x16x32_bf16 v[124:127], v[172:175], v[48:51], 0
    v_mfma_f32_16x16x32_bf16 v[128:131], v[176:179], v[48:51], 0
    s_waitcnt vmcnt(11)
    buffer_load_dwordx4 v3, s[28:31], s75 offen offset:1024 lds
    v_mfma_f32_16x16x32_bf16 v[132:135], v[180:183], v[48:51], 0
    v_mfma_f32_16x16x32_bf16 v[136:139], v[184:187], v[48:51], 0
    s_waitcnt vmcnt(11)
    buffer_load_dwordx4 v4, s[28:31], s75 offen offset:2048 lds
    s_add_u32 s74, s74, 196608
    s_cmp_eq_u32 s74, 7864320
    s_cselect_b32 s74, 0, s74
    ds_read_b64_tr_b16 v[140:141], v252 offset:30720
    ds_read_b64_tr_b16 v[144:145], v253 offset:30720
    ds_read_b64_tr_b16 v[148:149], v254 offset:30720
    ds_read_b64_tr_b16 v[152:153], v255 offset:30720
    ds_read_b64_tr_b16 v[156:157], v252 offset:31744
    ds_read_b64_tr_b16 v[160:161], v253 offset:31744
    ds_read_b64_tr_b16 v[164:165], v254 offset:31744
    ds_read_b64_tr_b16 v[168:169], v255 offset:31744
    ds_read_b64_tr_b16 v[172:173], v252 offset:32768
    ds_read_b64_tr_b16 v[176:177], v253 offset:32768
    ds_read_b64_tr_b16 v[180:181], v254 offset:32768
    ds_read_b64_tr_b16 v[184:185], v255 offset:32768
    s_waitcnt lgkmcnt(0)
    s_add_u32 m0, s55, 30720
    s_waitcnt vmcnt(11)
    buffer_load_dwordx4 v2, s[28:31], s74 offen offset:0 lds
    s_waitcnt vmcnt(11)
    buffer_load_dwordx4 v3, s[28:31], s74 offen offset:1024 lds
    s_waitcnt vmcnt(11)
    buffer_load_dwordx4 v4, s[28:31], s74 offen offset:2048 lds
    s_add_u32 m0, s55, 33792
    s_add_u32 s75, s74, 98304
    s_waitcnt vmcnt(11)
    buffer_load_dwordx4 v2, s[28:31], s75 offen offset:0 lds
    s_waitcnt vmcnt(11)
    buffer_load_dwordx4 v3, s[28:31], s75 offen offset:1024 lds
    s_waitcnt vmcnt(11)
    buffer_load_dwordx4 v4, s[28:31], s75 offen offset:2048 lds
    s_add_u32 s74, s74, 196608
    s_cmp_eq_u32 s74, 7864320
    s_cselect_b32 s74, 0, s74
    ds_read_b64_tr_b16 v[142:143], v252 offset:18432
    ds_read_b64_tr_b16 v[146:147], v253 offset:18432
    ds_read_b64_tr_b16 v[150:151], v254 offset:18432
    ds_read_b64_tr_b16 v[154:155], v255 offset:18432
    ds_read_b64_tr_b16 v[158:159], v252 offset:19456
    ds_read_b64_tr_b16 v[162:163], v253 offset:19456
    ds_read_b64_tr_b16 v[166:167], v254 offset:19456
    ds_read_b64_tr_b16 v[170:171], v255 offset:19456
    ds_read_b64_tr_b16 v[174:175], v252 offset:20480
    ds_read_b64_tr_b16 v[178:179], v253 offset:20480
    ds_read_b64_tr_b16 v[182:183], v254 offset:20480
    ds_read_b64_tr_b16 v[186:187], v255 offset:20480
    s_waitcnt lgkmcnt(0)
    v_mfma_f32_16x16x32_bf16 v[92:95], v[140:143], v[52:55], v[92:95]
    v_mfma_f32_16x16x32_bf16 v[96:99], v[144:147], v[52:55], v[96:99]
    s_add_u32 m0, s55, 18432
    s_waitcnt vmcnt(11)
    buffer_load_dwordx4 v2, s[28:31], s74 offen offset:0 lds
    v_mfma_f32_16x16x32_bf16 v[100:103], v[148:151], v[52:55], v[100:103]
    v_mfma_f32_16x16x32_bf16 v[104:107], v[152:155], v[52:55], v[104:107]
    s_waitcnt vmcnt(11)
    buffer_load_dwordx4 v3, s[28:31], s74 offen offset:1024 lds
    v_mfma_f32_16x16x32_bf16 v[108:111], v[156:159], v[52:55], v[108:111]
    v_mfma_f32_16x16x32_bf16 v[112:115], v[160:163], v[52:55], v[112:115]
    s_waitcnt vmcnt(11)
    buffer_load_dwordx4 v4, s[28:31], s74 offen offset:2048 lds
    v_mfma_f32_16x16x32_bf16 v[116:119], v[164:167], v[52:55], v[116:119]
    v_mfma_f32_16x16x32_bf16 v[120:123], v[168:171], v[52:55], v[120:123]
    s_add_u32 m0, s55, 21504
    s_add_u32 s75, s74, 98304
    s_waitcnt vmcnt(11)
    buffer_load_dwordx4 v2, s[28:31], s75 offen offset:0 lds
    v_mfma_f32_16x16x32_bf16 v[124:127], v[172:175], v[52:55], v[124:127]
    v_mfma_f32_16x16x32_bf16 v[128:131], v[176:179], v[52:55], v[128:131]
    s_waitcnt vmcnt(11)
    buffer_load_dwordx4 v3, s[28:31], s75 offen offset:1024 lds
    v_mfma_f32_16x16x32_bf16 v[132:135], v[180:183], v[52:55], v[132:135]
    v_mfma_f32_16x16x32_bf16 v[136:139], v[184:187], v[52:55], v[136:139]
    s_waitcnt vmcnt(11)
    buffer_load_dwordx4 v4, s[28:31], s75 offen offset:2048 lds
    s_add_u32 s74, s74, 196608
    s_cmp_eq_u32 s74, 7864320
    s_cselect_b32 s74, 0, s74
    ds_read_b64_tr_b16 v[140:141], v252 offset:24576
    ds_read_b64_tr_b16 v[144:145], v253 offset:24576
    ds_read_b64_tr_b16 v[148:149], v254 offset:24576
    ds_read_b64_tr_b16 v[152:153], v255 offset:24576
    ds_read_b64_tr_b16 v[156:157], v252 offset:25600
    ds_read_b64_tr_b16 v[160:161], v253 offset:25600
    ds_read_b64_tr_b16 v[164:165], v254 offset:25600
    ds_read_b64_tr_b16 v[168:169], v255 offset:25600
    ds_read_b64_tr_b16 v[172:173], v252 offset:26624
    ds_read_b64_tr_b16 v[176:177], v253 offset:26624
    ds_read_b64_tr_b16 v[180:181], v254 offset:26624
    ds_read_b64_tr_b16 v[184:185], v255 offset:26624
    s_waitcnt lgkmcnt(0)
    s_add_u32 m0, s55, 24576
    s_waitcnt vmcnt(11)
    buffer_load_dwordx4 v2, s[28:31], s74 offen offset:0 lds
    s_waitcnt vmcnt(11)
    buffer_load_dwordx4 v3, s[28:31], s74 offen offset:1024 lds
    s_waitcnt vmcnt(11)
    buffer_load_dwordx4 v4, s[28:31], s74 offen offset:2048 lds
    s_add_u32 m0, s55, 27648
    s_add_u32 s75, s74, 98304
    s_waitcnt vmcnt(11)
    buffer_load_dwordx4 v2, s[28:31], s75 offen offset:0 lds
    s_waitcnt vmcnt(11)
    buffer_load_dwordx4 v3, s[28:31], s75 offen offset:1024 lds
    s_waitcnt vmcnt(11)
    buffer_load_dwordx4 v4, s[28:31], s75 offen offset:2048 lds
    s_add_u32 s74, s74, 196608
    s_cmp_eq_u32 s74, 7864320
    s_cselect_b32 s74, 0, s74
    ds_read_b64_tr_b16 v[142:143], v252 offset:30720
    ds_read_b64_tr_b16 v[146:147], v253 offset:30720
    ds_read_b64_tr_b16 v[150:151], v254 offset:30720
    ds_read_b64_tr_b16 v[154:155], v255 offset:30720
    ds_read_b64_tr_b16 v[158:159], v252 offset:31744
    ds_read_b64_tr_b16 v[162:163], v253 offset:31744
    ds_read_b64_tr_b16 v[166:167], v254 offset:31744
    ds_read_b64_tr_b16 v[170:171], v255 offset:31744
    ds_read_b64_tr_b16 v[174:175], v252 offset:32768
    ds_read_b64_tr_b16 v[178:179], v253 offset:32768
    ds_read_b64_tr_b16 v[182:183], v254 offset:32768
    ds_read_b64_tr_b16 v[186:187], v255 offset:32768
    s_waitcnt lgkmcnt(0)
    v_mfma_f32_16x16x32_bf16 v[92:95], v[140:143], v[56:59], v[92:95]
    v_mfma_f32_16x16x32_bf16 v[96:99], v[144:147], v[56:59], v[96:99]
    s_add_u32 m0, s55, 30720
    s_waitcnt vmcnt(11)
    buffer_load_dwordx4 v2, s[28:31], s74 offen offset:0 lds
    v_mfma_f32_16x16x32_bf16 v[100:103], v[148:151], v[56:59], v[100:103]
    v_mfma_f32_16x16x32_bf16 v[104:107], v[152:155], v[56:59], v[104:107]
    s_waitcnt vmcnt(11)
    buffer_load_dwordx4 v3, s[28:31], s74 offen offset:1024 lds
    v_mfma_f32_16x16x32_bf16 v[108:111], v[156:159], v[56:59], v[108:111]
    v_mfma_f32_16x16x32_bf16 v[112:115], v[160:163], v[56:59], v[112:115]
    s_waitcnt vmcnt(11)
    buffer_load_dwordx4 v4, s[28:31], s74 offen offset:2048 lds
    v_mfma_f32_16x16x32_bf16 v[116:119], v[164:167], v[56:59], v[116:119]
    v_mfma_f32_16x16x32_bf16 v[120:123], v[168:171], v[56:59], v[120:123]
    s_add_u32 m0, s55, 33792
    s_add_u32 s75, s74, 98304
    s_waitcnt vmcnt(11)
    buffer_load_dwordx4 v2, s[28:31], s75 offen offset:0 lds
    v_mfma_f32_16x16x32_bf16 v[124:127], v[172:175], v[56:59], v[124:127]
    v_mfma_f32_16x16x32_bf16 v[128:131], v[176:179], v[56:59], v[128:131]
    s_waitcnt vmcnt(11)
    buffer_load_dwordx4 v3, s[28:31], s75 offen offset:1024 lds
    v_mfma_f32_16x16x32_bf16 v[132:135], v[180:183], v[56:59], v[132:135]
    v_mfma_f32_16x16x32_bf16 v[136:139], v[184:187], v[56:59], v[136:139]
    s_waitcnt vmcnt(11)
    buffer_load_dwordx4 v4, s[28:31], s75 offen offset:2048 lds
    s_add_u32 s74, s74, 196608
    s_cmp_eq_u32 s74, 7864320
    s_cselect_b32 s74, 0, s74
    ds_read_b64_tr_b16 v[140:141], v252 offset:18432
    ds_read_b64_tr_b16 v[144:145], v253 offset:18432
    ds_read_b64_tr_b16 v[148:149], v254 offset:18432
    ds_read_b64_tr_b16 v[152:153], v255 offset:18432
    ds_read_b64_tr_b16 v[156:157], v252 offset:19456
    ds_read_b64_tr_b16 v[160:161], v253 offset:19456
    ds_read_b64_tr_b16 v[164:165], v254 offset:19456
    ds_read_b64_tr_b16 v[168:169], v255 offset:19456
    ds_read_b64_tr_b16 v[172:173], v252 offset:20480
    ds_read_b64_tr_b16 v[176:177], v253 offset:20480
    ds_read_b64_tr_b16 v[180:181], v254 offset:20480
    ds_read_b64_tr_b16 v[184:185], v255 offset:20480
    s_waitcnt lgkmcnt(0)
    s_add_u32 m0, s55, 18432
    s_waitcnt vmcnt(11)
    buffer_load_dwordx4 v2, s[28:31], s74 offen offset:0 lds
    s_waitcnt vmcnt(11)
    buffer_load_dwordx4 v3, s[28:31], s74 offen offset:1024 lds
    s_waitcnt vmcnt(11)
    buffer_load_dwordx4 v4, s[28:31], s74 offen offset:2048 lds
    s_add_u32 m0, s55, 21504
    s_add_u32 s75, s74, 98304
    s_waitcnt vmcnt(11)
    buffer_load_dwordx4 v2, s[28:31], s75 offen offset:0 lds
    s_waitcnt vmcnt(11)
    buffer_load_dwordx4 v3, s[28:31], s75 offen offset:1024 lds
    s_waitcnt vmcnt(11)
    buffer_load_dwordx4 v4, s[28:31], s75 offen offset:2048 lds
    s_add_u32 s74, s74, 196608
    s_cmp_eq_u32 s74, 7864320
    s_cselect_b32 s74, 0, s74
    ds_read_b64_tr_b16 v[142:143], v252 offset:24576
    ds_read_b64_tr_b16 v[146:147], v253 offset:24576
    ds_read_b64_tr_b16 v[150:151], v254 offset:24576
    ds_read_b64_tr_b16 v[154:155], v255 offset:24576
    ds_read_b64_tr_b16 v[158:159], v252 offset:25600
    ds_read_b64_tr_b16 v[162:163], v253 offset:25600
    ds_read_b64_tr_b16 v[166:167], v254 offset:25600
    ds_read_b64_tr_b16 v[170:171], v255 offset:25600
    ds_read_b64_tr_b16 v[174:175], v252 offset:26624
    ds_read_b64_tr_b16 v[178:179], v253 offset:26624
    ds_read_b64_tr_b16 v[182:183], v254 offset:26624
    ds_read_b64_tr_b16 v[186:187], v255 offset:26624
    s_waitcnt lgkmcnt(0)
    v_mfma_f32_16x16x32_bf16 v[92:95], v[140:143], v[60:63], v[92:95]
    v_mfma_f32_16x16x32_bf16 v[96:99], v[144:147], v[60:63], v[96:99]
    s_add_u32 m0, s55, 24576
    s_waitcnt vmcnt(11)
    buffer_load_dwordx4 v5, s[20:23], s57 offen offset:0 nt lds
    v_mfma_f32_16x16x32_bf16 v[100:103], v[148:151], v[60:63], v[100:103]
    v_mfma_f32_16x16x32_bf16 v[104:107], v[152:155], v[60:63], v[104:107]
    s_waitcnt vmcnt(11)
    buffer_load_dwordx4 v6, s[20:23], s57 offen offset:1024 nt lds
    v_mfma_f32_16x16x32_bf16 v[108:111], v[156:159], v[60:63], v[108:111]
    v_mfma_f32_16x16x32_bf16 v[112:115], v[160:163], v[60:63], v[112:115]
    s_waitcnt vmcnt(11)
    buffer_load_dwordx4 v7, s[20:23], s57 offen offset:2048 nt lds
    v_mfma_f32_16x16x32_bf16 v[116:119], v[164:167], v[60:63], v[116:119]
    v_mfma_f32_16x16x32_bf16 v[120:123], v[168:171], v[60:63], v[120:123]
    s_add_u32 m0, s55, 27648
    s_add_u32 s0, s57, 3072
    s_waitcnt vmcnt(11)
    buffer_load_dwordx4 v8, s[20:23], s0 offen offset:0 nt lds
    v_mfma_f32_16x16x32_bf16 v[124:127], v[172:175], v[60:63], v[124:127]
    v_mfma_f32_16x16x32_bf16 v[128:131], v[176:179], v[60:63], v[128:131]
    s_waitcnt vmcnt(11)
    buffer_load_dwordx4 v9, s[20:23], s0 offen offset:1024 nt lds
    v_mfma_f32_16x16x32_bf16 v[132:135], v[180:183], v[60:63], v[132:135]
    v_mfma_f32_16x16x32_bf16 v[136:139], v[184:187], v[60:63], v[136:139]
    s_waitcnt vmcnt(11)
    buffer_load_dwordx4 v10, s[20:23], s0 offen offset:2048 nt lds
    s_add_u32 s57, s57, 24576
    s_sub_u32 s0, s57, 393216
    s_min_u32 s57, s57, s0
    v_lshlrev_b32 v44, 4, v1
    v_xor_b32 v40, v44, v5
    v_lshlrev_b32 v40, 1, v40
    v_xor_b32 v11, v44, v40
    v_xor_b32 v40, v44, v6
    v_lshlrev_b32 v40, 1, v40
    v_xor_b32 v12, v44, v40
    v_xor_b32 v40, v44, v7
    v_lshlrev_b32 v40, 1, v40
    v_xor_b32 v13, v44, v40
    v_lshrrev_b32 v40, 3, v1
    v_and_b32 v41, 6, v40
    v_xor_b32 v41, v41, v1
    v_and_b32 v41, 7, v41
    v_mul_u32_u24 v40, 384, v40
    v_lshl_add_u32 v27, v41, 4, v40
    v_add_u32 v41, 0, v1
    v_mul_u32_u24 v40, 3277, v41
    v_lshrrev_b32 v40, 16, v40
    v_mul_u32_u24 v42, 20, v40
    v_sub_u32 v41, v41, v42
    v_mul_u32_u24 v40, 1280, v40
    v_lshl_add_u32 v14, v41, 4, v40
    v_add_u32 v41, 64, v1
    v_mul_u32_u24 v40, 3277, v41
    v_lshrrev_b32 v40, 16, v40
    v_mul_u32_u24 v42, 20, v40
    v_sub_u32 v41, v41, v42
    v_mul_u32_u24 v40, 1280, v40
    v_lshl_add_u32 v15, v41, 4, v40
    v_subrev_u32 v15, 1024, v15
    v_add_u32 v41, 128, v1
    v_mul_u32_u24 v40, 3277, v41
    v_lshrrev_b32 v40, 16, v40
    v_mul_u32_u24 v42, 20, v40
    v_sub_u32 v41, v41, v42
    v_mul_u32_u24 v40, 1280, v40
    v_lshl_add_u32 v16, v41, 4, v40
    v_subrev_u32 v16, 2048, v16
    v_add_u32 v41, 192, v1
    v_mul_u32_u24 v40, 3277, v41
    v_lshrrev_b32 v40, 16, v40
    v_mul_u32_u24 v42, 20, v40
    v_sub_u32 v41, v41, v42
    v_mul_u32_u24 v40, 1280, v40
    v_lshl_add_u32 v17, v41, 4, v40
    v_subrev_u32 v17, 3072, v17
    v_add_u32 v41, 256, v1
    v_mul_u32_u24 v40, 3277, v41
    v_lshrrev_b32 v40, 16, v40
    v_mul_u32_u24 v42, 20, v40
    v_sub_u32 v41, v41, v42
    v_mul_u32_u24 v40, 1280, v40
    v_lshl_add_u32 v18, v41, 4, v40
    v_lshrrev_b32 v40, 2, v1
    v_and_b32 v41, 3, v1
    v_lshlrev_b32 v41, 3, v41
    v_add_u32 v41, s55, v41
    v_mul_u32_u24 v42, 320, v40
    v_add_u32 v25, v42, v41
    v_mul_u32_u24 v42, 384, v40
    v_add_u32 v41, v42, v41
    v_bfe_u32 v42, v1, 3, 2
    v_xor_b32 v43, 0, v42
    v_lshl_add_u32 v19, v43, 5, v41
    v_xor_b32 v43, 1, v42
    v_lshl_add_u32 v20, v43, 5, v41
    v_xor_b32 v43, 2, v42
    v_lshl_add_u32 v21, v43, 5, v41
    v_xor_b32 v43, 3, v42
    v_lshl_add_u32 v22, v43, 5, v41
    v_and_b32 v45, 15, v1
    v_lshrrev_b32 v46, 4, v1
    v_mul_u32_u24 v40, 384, v45
    v_add_u32 v40, s55, v40
    v_lshrrev_b32 v41, 1, v45
    v_xor_b32 v41, v41, v46
    v_lshl_add_u32 v23, v41, 4, v40
    v_xor_b32 v41, 4, v41
    v_lshl_add_u32 v24, v41, 4, v40
    v_mul_u32_u24 v40, 784, v45
    v_add_u32 v40, 147456, v40
    v_lshl_add_u32 v29, v46, 5, v40
    s_mul_i32 s58, s52, 3136
    v_lshl_add_u32 v28, v46, 4, v40
    v_add_u32 v28, s58, v28
    v_and_b32 v40, 3, v1
    v_lshlrev_b32 v40, 7, v40
    v_add_u32 v31, 160000, v40
    s_lshl_b32 s58, s52, 5
    v_lshl_add_u32 v30, v46, 3, v31
    v_add_u32 v30, s58, v30
    v_add_u32 v33, 147456, v44
    s_lshl_b32 s58, s52, 6
    v_add_u32 v32, s58, v33
    v_lshrrev_b32 v40, 5, v1
    v_and_b32 v41, 31, v1
    v_lshlrev_b32 v41, 4, v41
    v_lshl_add_u32 v34, v40, 14, v41
    v_lshlrev_b32 v41, 4, v45
    v_lshl_add_u32 v35, v40, 8, v41
    v_bfe_u32 v40, v1, 4, 1
    v_lshl_add_u32 v35, v40, 3, v35
    v_lshrrev_b32 v40, 3, v1
    v_and_b32 v41, 7, v1
    v_lshlrev_b32 v42, 4, v41
    v_lshl_add_u32 v36, v40, 9, v42
    v_mul_u32_u24 v40, 1280, v46
    v_lshl_add_u32 v37, v41, 1, v40
    s_lshl_b32 s58, s54, 7
    s_add_u32 s58, s58, 2621440
    v_mov_b32 v38, s58
    v_add_u32 v26, s55, v44
    s_mov_b32 s1, 0xfffff000
    s_mov_b32 s60, 0x3dd53b95
    s_mov_b32 s62, 0xf000f
    s_mov_b32 s63, 0xf000f
    s_mov_b32 s66, 0x550055
    s_mov_b32 s67, 0x550055
    s_mov_b32 s68, 4096
    s_mov_b32 s69, 8192
    s_mov_b32 s70, 12288
    s_mov_b32 s71, 32768
    s_mov_b32 s4, 65536
    s_mul_i32 s58, s53, 245760
    s_mul_i32 s59, s52, 320
    s_add_u32 s58, s58, s59
    s_add_u32 s32, s12, s58
    s_addc_u32 s33, s13, 0
    s_sub_u32 s34, 7864320, s58
    s_mov_b32 s35, 0x20000
    s_mul_i32 s58, s54, 20
    s_mul_i32 s59, s52, 5
    s_add_u32 s59, s58, s59
    s_lshl_b32 s59, s59, 5
    s_add_u32 s59, s59, s53
    s_lshl_b32 s59, s59, 9
    s_add_u32 s40, s18, s59
    s_addc_u32 s41, s19, 0
    s_sub_u32 s42, 2621440, s59
    s_mov_b32 s43, 0x20000
    s_add_u32 s58, s58, s53
    s_lshl_b32 s58, s58, 14
    s_lshl_b32 s59, s52, 7
    s_add_u32 s58, s58, s59
    s_add_u32 s44, s18, s58
    s_addc_u32 s45, s19, 0
    s_mov_b32 s46, 16384
    s_mov_b32 s47, 0x20000
    s_mul_i32 s58, s54, 5120
    s_lshl_b32 s59, s53, 6
    s_add_u32 s58, s58, s59
    s_lshl_b32 s59, s52, 4
    s_add_u32 s58, s58, s59
    s_add_u32 s48, s14, s58
    s_addc_u32 s49, s15, 0
    s_sub_u32 s50, 40960, s58
    s_mov_b32 s51, 0x20000
    global_load_dword v39, v38, s[18:19] sc1
    ds_read_b64_tr_b16 v[140:141], v252 offset:30720
    ds_read_b64_tr_b16 v[144:145], v253 offset:30720
    ds_read_b64_tr_b16 v[148:149], v254 offset:30720
    ds_read_b64_tr_b16 v[152:153], v255 offset:30720
    ds_read_b64_tr_b16 v[156:157], v252 offset:31744
    ds_read_b64_tr_b16 v[160:161], v253 offset:31744
    ds_read_b64_tr_b16 v[164:165], v254 offset:31744
    ds_read_b64_tr_b16 v[168:169], v255 offset:31744
    ds_read_b64_tr_b16 v[172:173], v252 offset:32768
    ds_read_b64_tr_b16 v[176:177], v253 offset:32768
    ds_read_b64_tr_b16 v[180:181], v254 offset:32768
    ds_read_b64_tr_b16 v[184:185], v255 offset:32768
    s_waitcnt lgkmcnt(0)
    s_add_u32 m0, s55, 30720
    s_waitcnt vmcnt(8)
    buffer_load_dwordx4 v5, s[20:23], s57 offen offset:0 nt lds
    s_waitcnt vmcnt(8)
    buffer_load_dwordx4 v6, s[20:23], s57 offen offset:1024 nt lds
    ds_read_b64_tr_b16 v[142:143], v252 offset:18432
    ds_read_b64_tr_b16 v[146:147], v253 offset:18432
    ds_read_b64_tr_b16 v[150:151], v254 offset:18432
    ds_read_b64_tr_b16 v[154:155], v255 offset:18432
    ds_read_b64_tr_b16 v[158:159], v252 offset:19456
    ds_read_b64_tr_b16 v[162:163], v253 offset:19456
    ds_read_b64_tr_b16 v[166:167], v254 offset:19456
    ds_read_b64_tr_b16 v[170:171], v255 offset:19456
    ds_read_b64_tr_b16 v[174:175], v252 offset:20480
    ds_read_b64_tr_b16 v[178:179], v253 offset:20480
    ds_read_b64_tr_b16 v[182:183], v254 offset:20480
    ds_read_b64_tr_b16 v[186:187], v255 offset:20480
    s_waitcnt lgkmcnt(0)
    v_mfma_f32_16x16x32_bf16 v[92:95], v[140:143], v[64:67], v[92:95]
    v_mfma_f32_16x16x32_bf16 v[96:99], v[144:147], v[64:67], v[96:99]
    s_waitcnt vmcnt(8)
    buffer_load_dwordx4 v7, s[20:23], s57 offen offset:2048 nt lds
    v_mfma_f32_16x16x32_bf16 v[100:103], v[148:151], v[64:67], v[100:103]
    v_mfma_f32_16x16x32_bf16 v[104:107], v[152:155], v[64:67], v[104:107]
    s_add_u32 m0, s55, 33792
    s_add_u32 s0, s57, 3072
    s_waitcnt vmcnt(8)
    buffer_load_dwordx4 v8, s[20:23], s0 offen offset:0 nt lds
    v_mfma_f32_16x16x32_bf16 v[108:111], v[156:159], v[64:67], v[108:111]
    v_mfma_f32_16x16x32_bf16 v[112:115], v[160:163], v[64:67], v[112:115]
    s_waitcnt vmcnt(8)
    buffer_load_dwordx4 v9, s[20:23], s0 offen offset:1024 nt lds
    v_mfma_f32_16x16x32_bf16 v[116:119], v[164:167], v[64:67], v[116:119]
    v_mfma_f32_16x16x32_bf16 v[120:123], v[168:171], v[64:67], v[120:123]
    s_waitcnt vmcnt(8)
    buffer_load_dwordx4 v10, s[20:23], s0 offen offset:2048 nt lds
    s_add_u32 s57, s57, 24576
    s_sub_u32 s0, s57, 393216
    s_min_u32 s57, s57, s0
    v_mfma_f32_16x16x32_bf16 v[124:127], v[172:175], v[64:67], v[124:127]
    v_mfma_f32_16x16x32_bf16 v[128:131], v[176:179], v[64:67], v[128:131]
    s_add_u32 m0, s55, 18432
    s_waitcnt vmcnt(8)
    buffer_load_dwordx4 v5, s[20:23], s57 offen offset:0 nt lds
    v_mfma_f32_16x16x32_bf16 v[132:135], v[180:183], v[64:67], v[132:135]
    v_mfma_f32_16x16x32_bf16 v[136:139], v[184:187], v[64:67], v[136:139]
    s_waitcnt vmcnt(8)
    buffer_load_dwordx4 v6, s[20:23], s57 offen offset:1024 nt lds
    s_mov_b64 exec, s[62:63]
    ds_write_b128 v28, v[92:95] offset:0
    ds_write_b128 v28, v[96:99] offset:64
    ds_write_b128 v28, v[100:103] offset:128
    ds_write_b128 v28, v[104:107] offset:192
    ds_write_b128 v28, v[108:111] offset:256
    ds_write_b128 v28, v[112:115] offset:320
    ds_write_b128 v28, v[116:119] offset:384
    ds_write_b128 v28, v[120:123] offset:448
    ds_write_b128 v28, v[124:127] offset:512
    ds_write_b128 v28, v[128:131] offset:576
    ds_write_b128 v28, v[132:135] offset:640
    ds_write_b128 v28, v[136:139] offset:704
    s_mov_b64 exec, -1
    buffer_load_dwordx4 v7, s[20:23], s57 offen offset:2048 nt lds
    s_add_u32 m0, s55, 21504
    s_add_u32 s0, s57, 3072
    buffer_load_dwordx4 v8, s[20:23], s0 offen offset:0 nt lds
    buffer_load_dwordx4 v9, s[20:23], s0 offen offset:1024 nt lds
    s_waitcnt lgkmcnt(0)
    s_barrier
    ds_read_b128 v[188:191], v29 offset:0
    ds_read_b128 v[192:195], v29 offset:16
    ds_read_b128 v[196:199], v29 offset:128
    ds_read_b128 v[200:203], v29 offset:144
    ds_read_b128 v[204:207], v29 offset:256
    ds_read_b128 v[208:211], v29 offset:272
    ds_read_b128 v[212:215], v29 offset:384
    ds_read_b128 v[216:219], v29 offset:400
    ds_read_b128 v[220:223], v29 offset:512
    ds_read_b128 v[224:227], v29 offset:528
    ds_read_b128 v[228:231], v29 offset:640
    ds_read_b128 v[232:235], v29 offset:656
    s_waitcnt lgkmcnt(0)
    v_add_f32_dpp v188, v188, v188 row_ror:4 row_mask:0xf bank_mask:0xf
    v_add_f32_dpp v189, v189, v189 row_ror:4 row_mask:0xf bank_mask:0xf
    v_add_f32_dpp v190, v190, v190 row_ror:4 row_mask:0xf bank_mask:0xf
    v_add_f32_dpp v191, v191, v191 row_ror:4 row_mask:0xf bank_mask:0xf
    v_add_f32_dpp v192, v192, v192 row_ror:4 row_mask:0xf bank_mask:0xf
    v_add_f32_dpp v193, v193, v193 row_ror:4 row_mask:0xf bank_mask:0xf
    v_add_f32_dpp v194, v194, v194 row_ror:4 row_mask:0xf bank_mask:0xf
    v_add_f32_dpp v195, v195, v195 row_ror:4 row_mask:0xf bank_mask:0xf
    v_add_f32_dpp v196, v196, v196 row_ror:4 row_mask:0xf bank_mask:0xf
    v_add_f32_dpp v197, v197, v197 row_ror:4 row_mask:0xf bank_mask:0xf
    v_add_f32_dpp v198, v198, v198 row_ror:4 row_mask:0xf bank_mask:0xf
    v_add_f32_dpp v199, v199, v199 row_ror:4 row_mask:0xf bank_mask:0xf
    v_add_f32_dpp v200, v200, v200 row_ror:4 row_mask:0xf bank_mask:0xf
    v_add_f32_dpp v201, v201, v201 row_ror:4 row_mask:0xf bank_mask:0xf
    v_add_f32_dpp v202, v202, v202 row_ror:4 row_mask:0xf bank_mask:0xf
    v_add_f32_dpp v203, v203, v203 row_ror:4 row_mask:0xf bank_mask:0xf
    v_add_f32_dpp v204, v204, v204 row_ror:4 row_mask:0xf bank_mask:0xf
    v_add_f32_dpp v205, v205, v205 row_ror:4 row_mask:0xf bank_mask:0xf
    v_add_f32_dpp v206, v206, v206 row_ror:4 row_mask:0xf bank_mask:0xf
    v_add_f32_dpp v207, v207, v207 row_ror:4 row_mask:0xf bank_mask:0xf
    v_add_f32_dpp v208, v208, v208 row_ror:4 row_mask:0xf bank_mask:0xf
    v_add_f32_dpp v209, v209, v209 row_ror:4 row_mask:0xf bank_mask:0xf
    v_add_f32_dpp v210, v210, v210 row_ror:4 row_mask:0xf bank_mask:0xf
    v_add_f32_dpp v211, v211, v211 row_ror:4 row_mask:0xf bank_mask:0xf
    s_waitcnt vmcnt(8)
    buffer_load_dwordx4 v10, s[20:23], s0 offen offset:2048 nt lds
    s_add_u32 s57, s57, 24576
    s_sub_u32 s0, s57, 393216
    s_min_u32 s57, s57, s0
    v_add_f32_dpp v212, v212, v212 row_ror:4 row_mask:0xf bank_mask:0xf
    v_add_f32_dpp v213, v213, v213 row_ror:4 row_mask:0xf bank_mask:0xf
    v_add_f32_dpp v214, v214, v214 row_ror:4 row_mask:0xf bank_mask:0xf
    v_add_f32_dpp v215, v215, v215 row_ror:4 row_mask:0xf bank_mask:0xf
    v_add_f32_dpp v216, v216, v216 row_ror:4 row_mask:0xf bank_mask:0xf
    v_add_f32_dpp v217, v217, v217 row_ror:4 row_mask:0xf bank_mask:0xf
    v_add_f32_dpp v218, v218, v218 row_ror:4 row_mask:0xf bank_mask:0xf
    v_add_f32_dpp v219, v219, v219 row_ror:4 row_mask:0xf bank_mask:0xf
    v_add_f32_dpp v220, v220, v220 row_ror:4 row_mask:0xf bank_mask:0xf
    v_add_f32_dpp v221, v221, v221 row_ror:4 row_mask:0xf bank_mask:0xf
    v_add_f32_dpp v222, v222, v222 row_ror:4 row_mask:0xf bank_mask:0xf
    v_add_f32_dpp v223, v223, v223 row_ror:4 row_mask:0xf bank_mask:0xf
    v_add_f32_dpp v224, v224, v224 row_ror:4 row_mask:0xf bank_mask:0xf
    v_add_f32_dpp v225, v225, v225 row_ror:4 row_mask:0xf bank_mask:0xf
    v_add_f32_dpp v226, v226, v226 row_ror:4 row_mask:0xf bank_mask:0xf
    v_add_f32_dpp v227, v227, v227 row_ror:4 row_mask:0xf bank_mask:0xf
    v_add_f32_dpp v228, v228, v228 row_ror:4 row_mask:0xf bank_mask:0xf
    v_add_f32_dpp v229, v229, v229 row_ror:4 row_mask:0xf bank_mask:0xf
    v_add_f32_dpp v230, v230, v230 row_ror:4 row_mask:0xf bank_mask:0xf
    v_add_f32_dpp v231, v231, v231 row_ror:4 row_mask:0xf bank_mask:0xf
    v_add_f32_dpp v232, v232, v232 row_ror:4 row_mask:0xf bank_mask:0xf
    v_add_f32_dpp v233, v233, v233 row_ror:4 row_mask:0xf bank_mask:0xf
    v_add_f32_dpp v234, v234, v234 row_ror:4 row_mask:0xf bank_mask:0xf
    v_add_f32_dpp v235, v235, v235 row_ror:4 row_mask:0xf bank_mask:0xf
    v_add_f32_dpp v188, v188, v188 row_ror:8 row_mask:0xf bank_mask:0xf
    v_add_f32_dpp v189, v189, v189 row_ror:8 row_mask:0xf bank_mask:0xf
    v_add_f32_dpp v190, v190, v190 row_ror:8 row_mask:0xf bank_mask:0xf
    v_add_f32_dpp v191, v191, v191 row_ror:8 row_mask:0xf bank_mask:0xf
    v_add_f32_dpp v192, v192, v192 row_ror:8 row_mask:0xf bank_mask:0xf
    v_add_f32_dpp v193, v193, v193 row_ror:8 row_mask:0xf bank_mask:0xf
    v_add_f32_dpp v194, v194, v194 row_ror:8 row_mask:0xf bank_mask:0xf
    v_add_f32_dpp v195, v195, v195 row_ror:8 row_mask:0xf bank_mask:0xf
    v_add_f32_dpp v196, v196, v196 row_ror:8 row_mask:0xf bank_mask:0xf
    v_add_f32_dpp v197, v197, v197 row_ror:8 row_mask:0xf bank_mask:0xf
    v_add_f32_dpp v198, v198, v198 row_ror:8 row_mask:0xf bank_mask:0xf
    v_add_f32_dpp v199, v199, v199 row_ror:8 row_mask:0xf bank_mask:0xf
    v_add_f32_dpp v200, v200, v200 row_ror:8 row_mask:0xf bank_mask:0xf
    v_add_f32_dpp v201, v201, v201 row_ror:8 row_mask:0xf bank_mask:0xf
    v_add_f32_dpp v202, v202, v202 row_ror:8 row_mask:0xf bank_mask:0xf
    v_add_f32_dpp v203, v203, v203 row_ror:8 row_mask:0xf bank_mask:0xf
    v_add_f32_dpp v204, v204, v204 row_ror:8 row_mask:0xf bank_mask:0xf
    v_add_f32_dpp v205, v205, v205 row_ror:8 row_mask:0xf bank_mask:0xf
    v_add_f32_dpp v206, v206, v206 row_ror:8 row_mask:0xf bank_mask:0xf
    v_add_f32_dpp v207, v207, v207 row_ror:8 row_mask:0xf bank_mask:0xf
    v_add_f32_dpp v208, v208, v208 row_ror:8 row_mask:0xf bank_mask:0xf
    v_add_f32_dpp v209, v209, v209 row_ror:8 row_mask:0xf bank_mask:0xf
    v_add_f32_dpp v210, v210, v210 row_ror:8 row_mask:0xf bank_mask:0xf
    v_add_f32_dpp v211, v211, v211 row_ror:8 row_mask:0xf bank_mask:0xf
    v_add_f32_dpp v212, v212, v212 row_ror:8 row_mask:0xf bank_mask:0xf
    v_add_f32_dpp v213, v213, v213 row_ror:8 row_mask:0xf bank_mask:0xf
    v_add_f32_dpp v214, v214, v214 row_ror:8 row_mask:0xf bank_mask:0xf
    v_add_f32_dpp v215, v215, v215 row_ror:8 row_mask:0xf bank_mask:0xf
    v_add_f32_dpp v216, v216, v216 row_ror:8 row_mask:0xf bank_mask:0xf
    v_add_f32_dpp v217, v217, v217 row_ror:8 row_mask:0xf bank_mask:0xf
    v_add_f32_dpp v218, v218, v218 row_ror:8 row_mask:0xf bank_mask:0xf
    v_add_f32_dpp v219, v219, v219 row_ror:8 row_mask:0xf bank_mask:0xf
    v_add_f32_dpp v220, v220, v220 row_ror:8 row_mask:0xf bank_mask:0xf
    v_add_f32_dpp v221, v221, v221 row_ror:8 row_mask:0xf bank_mask:0xf
    v_add_f32_dpp v222, v222, v222 row_ror:8 row_mask:0xf bank_mask:0xf
    v_add_f32_dpp v223, v223, v223 row_ror:8 row_mask:0xf bank_mask:0xf
    v_add_f32_dpp v224, v224, v224 row_ror:8 row_mask:0xf bank_mask:0xf
    v_add_f32_dpp v225, v225, v225 row_ror:8 row_mask:0xf bank_mask:0xf
    v_add_f32_dpp v226, v226, v226 row_ror:8 row_mask:0xf bank_mask:0xf
    v_add_f32_dpp v227, v227, v227 row_ror:8 row_mask:0xf bank_mask:0xf
    v_add_f32_dpp v228, v228, v228 row_ror:8 row_mask:0xf bank_mask:0xf
    v_add_f32_dpp v229, v229, v229 row_ror:8 row_mask:0xf bank_mask:0xf
    v_add_f32_dpp v230, v230, v230 row_ror:8 row_mask:0xf bank_mask:0xf
    v_add_f32_dpp v231, v231, v231 row_ror:8 row_mask:0xf bank_mask:0xf
    v_add_f32_dpp v232, v232, v232 row_ror:8 row_mask:0xf bank_mask:0xf
    v_add_f32_dpp v233, v233, v233 row_ror:8 row_mask:0xf bank_mask:0xf
    v_add_f32_dpp v234, v234, v234 row_ror:8 row_mask:0xf bank_mask:0xf
    v_add_f32_dpp v235, v235, v235 row_ror:8 row_mask:0xf bank_mask:0xf
    v_cvt_pk_bf16_f32 v68, v188, v189
    v_cvt_pk_bf16_f32 v69, v190, v191
    v_cvt_pk_bf16_f32 v70, v192, v193
    v_cvt_pk_bf16_f32 v71, v194, v195
    v_cvt_pk_bf16_f32 v72, v196, v197
    v_cvt_pk_bf16_f32 v73, v198, v199
    v_cvt_pk_bf16_f32 v74, v200, v201
    v_cvt_pk_bf16_f32 v75, v202, v203
    v_cvt_pk_bf16_f32 v76, v204, v205
    v_cvt_pk_bf16_f32 v77, v206, v207
    v_cvt_pk_bf16_f32 v78, v208, v209
    v_cvt_pk_bf16_f32 v79, v210, v211
    v_cvt_pk_bf16_f32 v80, v212, v213
    v_cvt_pk_bf16_f32 v81, v214, v215
    v_cvt_pk_bf16_f32 v82, v216, v217
    v_cvt_pk_bf16_f32 v83, v218, v219
    v_cvt_pk_bf16_f32 v84, v220, v221
    v_cvt_pk_bf16_f32 v85, v222, v223
    v_cvt_pk_bf16_f32 v86, v224, v225
    v_cvt_pk_bf16_f32 v87, v226, v227
    v_cvt_pk_bf16_f32 v88, v228, v229
    v_cvt_pk_bf16_f32 v89, v230, v231
    v_cvt_pk_bf16_f32 v90, v232, v233
    v_cvt_pk_bf16_f32 v91, v234, v235
    ds_read_b128 v[140:143], v23 offset:6144
    ds_read_b128 v[144:147], v24 offset:6144
    ds_read_b128 v[148:151], v23 offset:6272
    ds_read_b128 v[152:155], v24 offset:6272
    ds_read_b128 v[156:159], v23 offset:6400
    ds_read_b128 v[160:163], v24 offset:6400
    s_waitcnt lgkmcnt(0)
    v_mfma_f32_16x16x32_bf16 v[192:195], v[140:143], v[68:71], 0
    v_mfma_f32_16x16x32_bf16 v[192:195], v[144:147], v[72:75], v[192:195]
    s_add_u32 m0, s55, 6144
    s_waitcnt vmcnt(8)
    buffer_load_dwordx4 v5, s[20:23], s57 offen offset:0 nt lds
    v_mfma_f32_16x16x32_bf16 v[192:195], v[148:151], v[76:79], v[192:195]
    v_mfma_f32_16x16x32_bf16 v[192:195], v[152:155], v[80:83], v[192:195]
    s_waitcnt vmcnt(8)
    buffer_load_dwordx4 v6, s[20:23], s57 offen offset:1024 nt lds
    v_mfma_f32_16x16x32_bf16 v[192:195], v[156:159], v[84:87], v[192:195]
    v_mfma_f32_16x16x32_bf16 v[192:195], v[160:163], v[88:91], v[192:195]
    s_waitcnt vmcnt(8)
    buffer_load_dwordx4 v7, s[20:23], s57 offen offset:2048 nt lds
    ds_read_b128 v[140:143], v23 offset:0
    ds_read_b128 v[144:147], v24 offset:0
    ds_read_b128 v[148:151], v23 offset:128
    ds_read_b128 v[152:155], v24 offset:128
    ds_read_b128 v[156:159], v23 offset:256
    ds_read_b128 v[160:163], v24 offset:256
    s_add_u32 m0, s55, 9216
    s_add_u32 s0, s57, 3072
    s_waitcnt vmcnt(8)
    buffer_load_dwordx4 v8, s[20:23], s0 offen offset:0 nt lds
    s_waitcnt lgkmcnt(0)
    v_mfma_f32_16x16x32_bf16 v[188:191], v[140:143], v[68:71], 0
    v_mfma_f32_16x16x32_bf16 v[188:191], v[144:147], v[72:75], v[188:191]
    s_waitcnt vmcnt(8)
    buffer_load_dwordx4 v9, s[20:23], s0 offen offset:1024 nt lds
    v_mfma_f32_16x16x32_bf16 v[188:191], v[148:151], v[76:79], v[188:191]
    v_mfma_f32_16x16x32_bf16 v[188:191], v[152:155], v[80:83], v[188:191]
    s_waitcnt vmcnt(8)
    buffer_load_dwordx4 v10, s[20:23], s0 offen offset:2048 nt lds
    s_add_u32 s57, s57, 24576
    s_sub_u32 s0, s57, 393216
    s_min_u32 s57, s57, s0
    v_mfma_f32_16x16x32_bf16 v[188:191], v[156:159], v[84:87], v[188:191]
    v_mfma_f32_16x16x32_bf16 v[188:191], v[160:163], v[88:91], v[188:191]
    ds_write_b128 v26, a[0:3] offset:0
    ds_write_b128 v26, a[4:7] offset:1024
    ds_write_b128 v26, a[8:11] offset:2048
    ds_write_b128 v26, a[12:15] offset:3072
    ds_write_b128 v26, a[16:19] offset:4096
    ds_write_b128 v26, a[20:23] offset:5120
    s_waitcnt lgkmcnt(0)
    ds_read_b128 v[140:143], v23 offset:0
    ds_read_b128 v[144:147], v24 offset:0
    ds_read_b128 v[148:151], v23 offset:128
    ds_read_b128 v[152:155], v24 offset:128
    ds_read_b128 v[156:159], v23 offset:256
    ds_read_b128 v[160:163], v24 offset:256
    s_waitcnt lgkmcnt(0)
    v_mfma_f32_16x16x32_bf16 v[200:203], v[140:143], v[68:71], 0
    v_mfma_f32_16x16x32_bf16 v[200:203], v[144:147], v[72:75], v[200:203]
    v_mfma_f32_16x16x32_bf16 v[200:203], v[148:151], v[76:79], v[200:203]
    v_mfma_f32_16x16x32_bf16 v[200:203], v[152:155], v[80:83], v[200:203]
    v_mfma_f32_16x16x32_bf16 v[200:203], v[156:159], v[84:87], v[200:203]
    v_mfma_f32_16x16x32_bf16 v[200:203], v[160:163], v[88:91], v[200:203]
    ds_read_b128 v[140:143], v23 offset:12288
    ds_read_b128 v[144:147], v24 offset:12288
    ds_read_b128 v[148:151], v23 offset:12416
    ds_read_b128 v[152:155], v24 offset:12416
    ds_read_b128 v[156:159], v23 offset:12544
    ds_read_b128 v[160:163], v24 offset:12544
    s_waitcnt lgkmcnt(0)
    v_mfma_f32_16x16x32_bf16 v[196:199], v[140:143], v[68:71], 0
    v_mfma_f32_16x16x32_bf16 v[196:199], v[144:147], v[72:75], v[196:199]
    s_add_u32 m0, s55, 12288
    s_waitcnt vmcnt(8)
    buffer_load_dwordx4 v5, s[20:23], s57 offen offset:0 nt lds
    v_mfma_f32_16x16x32_bf16 v[196:199], v[148:151], v[76:79], v[196:199]
    v_mfma_f32_16x16x32_bf16 v[196:199], v[152:155], v[80:83], v[196:199]
    s_waitcnt vmcnt(8)
    buffer_load_dwordx4 v6, s[20:23], s57 offen offset:1024 nt lds
    v_mfma_f32_16x16x32_bf16 v[196:199], v[156:159], v[84:87], v[196:199]
    v_mfma_f32_16x16x32_bf16 v[196:199], v[160:163], v[88:91], v[196:199]
    s_waitcnt vmcnt(8)
    buffer_load_dwordx4 v7, s[20:23], s57 offen offset:2048 nt lds
    ds_write_b128 v26, a[24:27] offset:0
    ds_write_b128 v26, a[28:31] offset:1024
    ds_write_b128 v26, a[32:35] offset:2048
    ds_write_b128 v26, a[36:39] offset:3072
    ds_write_b128 v26, a[40:43] offset:4096
    ds_write_b128 v26, a[44:47] offset:5120
    s_add_u32 m0, s55, 15360
    s_add_u32 s0, s57, 3072
    s_waitcnt vmcnt(8)
    buffer_load_dwordx4 v8, s[20:23], s0 offen offset:0 nt lds
    s_waitcnt lgkmcnt(0)
    ds_read_b128 v[140:143], v23 offset:0
    ds_read_b128 v[144:147], v24 offset:0
    ds_read_b128 v[148:151], v23 offset:128
    ds_read_b128 v[152:155], v24 offset:128
    ds_read_b128 v[156:159], v23 offset:256
    ds_read_b128 v[160:163], v24 offset:256
    s_waitcnt vmcnt(8)
    buffer_load_dwordx4 v9, s[20:23], s0 offen offset:1024 nt lds
    s_waitcnt lgkmcnt(0)
    v_mfma_f32_16x16x32_bf16 v[204:207], v[140:143], v[68:71], 0
    v_mfma_f32_16x16x32_bf16 v[204:207], v[144:147], v[72:75], v[204:207]
    s_waitcnt vmcnt(8)
    buffer_load_dwordx4 v10, s[20:23], s0 offen offset:2048 nt lds
    s_add_u32 s57, s57, 24576
    s_sub_u32 s0, s57, 393216
    s_min_u32 s57, s57, s0
    v_mfma_f32_16x16x32_bf16 v[204:207], v[148:151], v[76:79], v[204:207]
    v_mfma_f32_16x16x32_bf16 v[204:207], v[152:155], v[80:83], v[204:207]
    v_mfma_f32_16x16x32_bf16 v[204:207], v[156:159], v[84:87], v[204:207]
    v_mfma_f32_16x16x32_bf16 v[204:207], v[160:163], v[88:91], v[204:207]
    ds_write_b128 v26, a[48:51] offset:0
    ds_write_b128 v26, a[52:55] offset:1024
    ds_write_b128 v26, a[56:59] offset:2048
    ds_write_b128 v26, a[60:63] offset:3072
    ds_write_b128 v26, a[64:67] offset:4096
    ds_write_b128 v26, a[68:71] offset:5120
    s_waitcnt lgkmcnt(0)
    ds_read_b128 v[140:143], v23 offset:0
    ds_read_b128 v[144:147], v24 offset:0
    ds_read_b128 v[148:151], v23 offset:128
    ds_read_b128 v[152:155], v24 offset:128
    ds_read_b128 v[156:159], v23 offset:256
    ds_read_b128 v[160:163], v24 offset:256
    s_waitcnt lgkmcnt(0)
    v_mfma_f32_16x16x32_bf16 v[208:211], v[140:143], v[68:71], 0
    v_mfma_f32_16x16x32_bf16 v[208:211], v[144:147], v[72:75], v[208:211]
    s_mov_b32 s75, 0
    s_add_u32 m0, s55, 0
    s_waitcnt vmcnt(8)
    buffer_load_dwordx4 v14, s[32:35], s75 offen offset:0 lds
    v_mfma_f32_16x16x32_bf16 v[208:211], v[148:151], v[76:79], v[208:211]
    v_mfma_f32_16x16x32_bf16 v[208:211], v[152:155], v[80:83], v[208:211]
    s_waitcnt vmcnt(8)
    buffer_load_dwordx4 v15, s[32:35], s75 offen offset:1024 lds
    v_mfma_f32_16x16x32_bf16 v[208:211], v[156:159], v[84:87], v[208:211]
    v_mfma_f32_16x16x32_bf16 v[208:211], v[160:163], v[88:91], v[208:211]
    s_waitcnt vmcnt(8)
    buffer_load_dwordx4 v16, s[32:35], s75 offen offset:2048 lds
    ds_read_b128 v[140:143], v23 offset:24576
    ds_read_b128 v[144:147], v24 offset:24576
    ds_read_b128 v[148:151], v23 offset:24704
    ds_read_b128 v[152:155], v24 offset:24704
    ds_read_b128 v[156:159], v23 offset:24832
    ds_read_b128 v[160:163], v24 offset:24832
    s_waitcnt lgkmcnt(0)
    v_mfma_f32_16x16x32_bf16 v[212:215], v[140:143], v[68:71], 0
    v_mfma_f32_16x16x32_bf16 v[212:215], v[144:147], v[72:75], v[212:215]
    v_mfma_f32_16x16x32_bf16 v[212:215], v[148:151], v[76:79], v[212:215]
    v_mfma_f32_16x16x32_bf16 v[212:215], v[152:155], v[80:83], v[212:215]
    v_mfma_f32_16x16x32_bf16 v[212:215], v[156:159], v[84:87], v[212:215]
    v_mfma_f32_16x16x32_bf16 v[212:215], v[160:163], v[88:91], v[212:215]
    s_add_u32 m0, s55, 24576
    s_waitcnt vmcnt(8)
    buffer_load_dwordx4 v5, s[20:23], s57 offen offset:0 nt lds
    ds_read_b128 v[140:143], v23 offset:30720
    ds_read_b128 v[144:147], v24 offset:30720
    ds_read_b128 v[148:151], v23 offset:30848
    ds_read_b128 v[152:155], v24 offset:30848
    ds_read_b128 v[156:159], v23 offset:30976
    ds_read_b128 v[160:163], v24 offset:30976
    s_add_u32 m0, s55, 0
    s_waitcnt vmcnt(8)
    buffer_load_dwordx4 v17, s[32:35], s75 offen offset:3072 lds
    s_waitcnt lgkmcnt(0)
    v_mfma_f32_16x16x32_bf16 v[216:219], v[140:143], v[68:71], 0
    v_mfma_f32_16x16x32_bf16 v[216:219], v[144:147], v[72:75], v[216:219]
    v_mfma_f32_16x16x32_bf16 v[216:219], v[148:151], v[76:79], v[216:219]
    v_mfma_f32_16x16x32_bf16 v[216:219], v[152:155], v[80:83], v[216:219]
    v_mfma_f32_16x16x32_bf16 v[216:219], v[156:159], v[84:87], v[216:219]
    v_mfma_f32_16x16x32_bf16 v[216:219], v[160:163], v[88:91], v[216:219]
    s_add_u32 m0, s55, 24576
    s_waitcnt vmcnt(8)
    buffer_load_dwordx4 v6, s[20:23], s57 offen offset:1024 nt lds
    ds_read_b128 v[140:143], v23 offset:18432
    ds_read_b128 v[144:147], v24 offset:18432
    ds_read_b128 v[148:151], v23 offset:18560
    ds_read_b128 v[152:155], v24 offset:18560
    ds_read_b128 v[156:159], v23 offset:18688
    ds_read_b128 v[160:163], v24 offset:18688
    s_waitcnt vmcnt(8)
    buffer_load_dwordx4 v7, s[20:23], s57 offen offset:2048 nt lds
    s_waitcnt lgkmcnt(0)
    v_mfma_f32_16x16x32_bf16 v[220:223], v[140:143], v[68:71], 0
    v_mfma_f32_16x16x32_bf16 v[220:223], v[144:147], v[72:75], v[220:223]
    v_mfma_f32_16x16x32_bf16 v[220:223], v[148:151], v[76:79], v[220:223]
    v_mfma_f32_16x16x32_bf16 v[220:223], v[152:155], v[80:83], v[220:223]
    v_mfma_f32_16x16x32_bf16 v[220:223], v[156:159], v[84:87], v[220:223]
    v_mfma_f32_16x16x32_bf16 v[220:223], v[160:163], v[88:91], v[220:223]
    s_add_u32 m0, s55, 4096
    s_waitcnt vmcnt(8)
    buffer_load_dwordx4 v18, s[32:35], s75 offen offset:0 lds
    ds_read_b128 v[140:143], v23 offset:6144
    ds_read_b128 v[144:147], v24 offset:6144
    ds_read_b128 v[148:151], v23 offset:6272
    ds_read_b128 v[152:155], v24 offset:6272
    ds_read_b128 v[156:159], v23 offset:6400
    ds_read_b128 v[160:163], v24 offset:6400
    s_add_u32 m0, s55, 27648
    s_add_u32 s0, s57, 3072
    s_waitcnt vmcnt(8)
    buffer_load_dwordx4 v8, s[20:23], s0 offen offset:0 nt lds
    s_waitcnt lgkmcnt(0)
    v_mfma_f32_16x16x32_bf16 v[224:227], v[140:143], v[68:71], 0
    v_mfma_f32_16x16x32_bf16 v[224:227], v[144:147], v[72:75], v[224:227]
    v_mfma_f32_16x16x32_bf16 v[224:227], v[148:151], v[76:79], v[224:227]
    v_mfma_f32_16x16x32_bf16 v[224:227], v[152:155], v[80:83], v[224:227]
    v_mfma_f32_16x16x32_bf16 v[224:227], v[156:159], v[84:87], v[224:227]
    v_mfma_f32_16x16x32_bf16 v[224:227], v[160:163], v[88:91], v[224:227]
    s_waitcnt vmcnt(8)
    buffer_load_dwordx4 v9, s[20:23], s0 offen offset:1024 nt lds
    ds_read_b128 v[140:143], v23 offset:12288
    ds_read_b128 v[144:147], v24 offset:12288
    ds_read_b128 v[148:151], v23 offset:12416
    ds_read_b128 v[152:155], v24 offset:12416
    ds_read_b128 v[156:159], v23 offset:12544
    ds_read_b128 v[160:163], v24 offset:12544
    s_mov_b32 s75, 20480
    s_add_u32 m0, s55, 30720
    s_waitcnt vmcnt(8)
    buffer_load_dwordx4 v14, s[32:35], s75 offen offset:0 lds
    s_waitcnt lgkmcnt(0)
    v_mfma_f32_16x16x32_bf16 v[228:231], v[140:143], v[68:71], 0
    v_mfma_f32_16x16x32_bf16 v[228:231], v[144:147], v[72:75], v[228:231]
    v_mfma_f32_16x16x32_bf16 v[228:231], v[148:151], v[76:79], v[228:231]
    v_mfma_f32_16x16x32_bf16 v[228:231], v[152:155], v[80:83], v[228:231]
    v_mfma_f32_16x16x32_bf16 v[228:231], v[156:159], v[84:87], v[228:231]
    v_mfma_f32_16x16x32_bf16 v[228:231], v[160:163], v[88:91], v[228:231]
    s_add_u32 m0, s55, 27648
    s_waitcnt vmcnt(8)
    buffer_load_dwordx4 v10, s[20:23], s0 offen offset:2048 nt lds
    s_add_u32 s57, s57, 24576
    s_sub_u32 s0, s57, 393216
    s_min_u32 s57, s57, s0
    s_add_u32 m0, s55, 18432
    s_waitcnt vmcnt(8)
    buffer_load_dwordx4 v5, s[20:23], s57 offen offset:0 nt lds
    s_add_u32 m0, s55, 30720
    s_waitcnt vmcnt(8)
    buffer_load_dwordx4 v15, s[32:35], s75 offen offset:1024 lds
    s_add_u32 m0, s55, 18432
    s_waitcnt vmcnt(8)
    buffer_load_dwordx4 v6, s[20:23], s57 offen offset:1024 nt lds
    s_waitcnt vmcnt(8)
    buffer_load_dwordx4 v7, s[20:23], s57 offen offset:2048 nt lds
    s_add_u32 m0, s55, 30720
    s_waitcnt vmcnt(8)
    buffer_load_dwordx4 v16, s[32:35], s75 offen offset:2048 lds
    ds_read_b64_tr_b16 a[0:1], v25 offset:0
    ds_read_b64_tr_b16 a[4:5], v25 offset:32
    ds_read_b64_tr_b16 a[8:9], v25 offset:64
    ds_read_b64_tr_b16 a[12:13], v25 offset:96
    ds_read_b64_tr_b16 a[16:17], v25 offset:128
    ds_read_b64_tr_b16 a[20:21], v25 offset:160
    ds_read_b64_tr_b16 a[24:25], v25 offset:192
    ds_read_b64_tr_b16 a[28:29], v25 offset:224
    ds_read_b64_tr_b16 a[32:33], v25 offset:256
    ds_read_b64_tr_b16 a[36:37], v25 offset:288
    s_add_u32 m0, s55, 21504
    s_add_u32 s0, s57, 3072
    s_waitcnt vmcnt(8)
    buffer_load_dwordx4 v8, s[20:23], s0 offen offset:0 nt lds
    s_waitcnt vmcnt(8)
    buffer_load_dwordx4 v9, s[20:23], s0 offen offset:1024 nt lds
    s_add_u32 m0, s55, 30720
    s_waitcnt vmcnt(8)
    buffer_load_dwordx4 v17, s[32:35], s75 offen offset:3072 lds
    s_add_u32 m0, s55, 21504
    s_waitcnt vmcnt(8)
    buffer_load_dwordx4 v10, s[20:23], s0 offen offset:2048 nt lds
    s_add_u32 s57, s57, 24576
    s_sub_u32 s0, s57, 393216
    s_min_u32 s57, s57, s0
    ds_read_b128 v[140:143], v23 offset:24576
    ds_read_b128 v[144:147], v24 offset:24576
    ds_read_b128 v[148:151], v23 offset:24704
    ds_read_b128 v[152:155], v24 offset:24704
    ds_read_b128 v[156:159], v23 offset:24832
    ds_read_b128 v[160:163], v24 offset:24832
    s_add_u32 m0, s55, 6144
    s_waitcnt vmcnt(8)
    buffer_load_dwordx4 v5, s[20:23], s57 offen offset:0 nt lds
    s_waitcnt lgkmcnt(0)
    v_mfma_f32_16x16x32_bf16 v[232:235], v[140:143], v[68:71], 0
    v_mfma_f32_16x16x32_bf16 v[232:235], v[144:147], v[72:75], v[232:235]
    v_mfma_f32_16x16x32_bf16 v[232:235], v[148:151], v[76:79], v[232:235]
    v_mfma_f32_16x16x32_bf16 v[232:235], v[152:155], v[80:83], v[232:235]
    v_mfma_f32_16x16x32_bf16 v[232:235], v[156:159], v[84:87], v[232:235]
    v_mfma_f32_16x16x32_bf16 v[232:235], v[160:163], v[88:91], v[232:235]
    s_add_u32 m0, s55, 34816
    s_waitcnt vmcnt(8)
    buffer_load_dwordx4 v18, s[32:35], s75 offen offset:0 lds
    s_add_u32 m0, s55, 6144
    s_waitcnt vmcnt(8)
    buffer_load_dwordx4 v6, s[20:23], s57 offen offset:1024 nt lds
    s_mov_b32 s75, 40960
    s_add_u32 m0, s55, 12288
    s_waitcnt vmcnt(8)
    buffer_load_dwordx4 v14, s[32:35], s75 offen offset:0 lds
    s_add_u32 m0, s55, 6144
    s_waitcnt vmcnt(8)
    buffer_load_dwordx4 v7, s[20:23], s57 offen offset:2048 nt lds
    s_add_u32 m0, s55, 9216
    s_add_u32 s0, s57, 3072
    s_waitcnt vmcnt(8)
    buffer_load_dwordx4 v8, s[20:23], s0 offen offset:0 nt lds
    s_add_u32 m0, s55, 12288
    s_waitcnt vmcnt(8)
    buffer_load_dwordx4 v15, s[32:35], s75 offen offset:1024 lds
    s_add_u32 m0, s55, 9216
    s_waitcnt vmcnt(8)
    buffer_load_dwordx4 v9, s[20:23], s0 offen offset:1024 nt lds
    s_waitcnt vmcnt(8)
    buffer_load_dwordx4 v10, s[20:23], s0 offen offset:2048 nt lds
    s_add_u32 s57, s57, 24576
    s_sub_u32 s0, s57, 393216
    s_min_u32 s57, s57, s0
    ds_read_b128 v[140:143], v23 offset:18432
    ds_read_b128 v[144:147], v24 offset:18432
    ds_read_b128 v[148:151], v23 offset:18560
    ds_read_b128 v[152:155], v24 offset:18560
    ds_read_b128 v[156:159], v23 offset:18688
    ds_read_b128 v[160:163], v24 offset:18688
    s_add_u32 m0, s55, 12288
    s_waitcnt vmcnt(8)
    buffer_load_dwordx4 v16, s[32:35], s75 offen offset:2048 lds
    s_waitcnt lgkmcnt(0)
    v_mfma_f32_16x16x32_bf16 v[236:239], v[140:143], v[68:71], 0
    v_mfma_f32_16x16x32_bf16 v[236:239], v[144:147], v[72:75], v[236:239]
    v_mfma_f32_16x16x32_bf16 v[236:239], v[148:151], v[76:79], v[236:239]
    v_mfma_f32_16x16x32_bf16 v[236:239], v[152:155], v[80:83], v[236:239]
    v_mfma_f32_16x16x32_bf16 v[236:239], v[156:159], v[84:87], v[236:239]
    v_mfma_f32_16x16x32_bf16 v[236:239], v[160:163], v[88:91], v[236:239]
    s_add_u32 m0, s55, 0
    s_waitcnt vmcnt(8)
    buffer_load_dwordx4 v5, s[20:23], s57 offen offset:0 nt lds
    ds_read_b64_tr_b16 a[2:3], v25 offset:30720
    ds_read_b64_tr_b16 a[6:7], v25 offset:30752
    ds_read_b64_tr_b16 a[10:11], v25 offset:30784
    ds_read_b64_tr_b16 a[14:15], v25 offset:30816
    ds_read_b64_tr_b16 a[18:19], v25 offset:30848
    ds_read_b64_tr_b16 a[22:23], v25 offset:30880
    ds_read_b64_tr_b16 a[26:27], v25 offset:30912
    ds_read_b64_tr_b16 a[30:31], v25 offset:30944
    ds_read_b64_tr_b16 a[34:35], v25 offset:30976
    ds_read_b64_tr_b16 a[38:39], v25 offset:31008
    s_waitcnt vmcnt(8)
    buffer_load_dwordx4 v6, s[20:23], s57 offen offset:1024 nt lds
    s_add_u32 m0, s55, 12288
    s_waitcnt vmcnt(8)
    buffer_load_dwordx4 v17, s[32:35], s75 offen offset:3072 lds
    s_add_u32 m0, s55, 0
    s_waitcnt vmcnt(8)
    buffer_load_dwordx4 v7, s[20:23], s57 offen offset:2048 nt lds
    s_add_u32 m0, s55, 3072
    s_add_u32 s0, s57, 3072
    s_waitcnt vmcnt(8)
    buffer_load_dwordx4 v8, s[20:23], s0 offen offset:0 nt lds
    s_add_u32 m0, s55, 16384
    s_waitcnt vmcnt(8)
    buffer_load_dwordx4 v18, s[32:35], s75 offen offset:0 lds
    s_add_u32 m0, s55, 3072
    s_waitcnt vmcnt(8)
    buffer_load_dwordx4 v9, s[20:23], s0 offen offset:1024 nt lds
    s_waitcnt vmcnt(8)
    buffer_load_dwordx4 v10, s[20:23], s0 offen offset:2048 nt lds
    s_add_u32 s57, s57, 24576
    s_sub_u32 s0, s57, 393216
    s_min_u32 s57, s57, s0
    ds_read_b128 v[140:143], v23 offset:6144
    ds_read_b128 v[144:147], v24 offset:6144
    ds_read_b128 v[148:151], v23 offset:6272
    ds_read_b128 v[152:155], v24 offset:6272
    ds_read_b128 v[156:159], v23 offset:6400
    ds_read_b128 v[160:163], v24 offset:6400
    s_mov_b32 s75, 61440
    s_add_u32 m0, s55, 24576
    s_waitcnt vmcnt(8)
    buffer_load_dwordx4 v14, s[32:35], s75 offen offset:0 lds
    s_waitcnt lgkmcnt(0)
    v_mfma_f32_16x16x32_bf16 v[240:243], v[140:143], v[68:71], 0
    v_mfma_f32_16x16x32_bf16 v[240:243], v[144:147], v[72:75], v[240:243]
    v_mfma_f32_16x16x32_bf16 v[240:243], v[148:151], v[76:79], v[240:243]
    v_mfma_f32_16x16x32_bf16 v[240:243], v[152:155], v[80:83], v[240:243]
    v_mfma_f32_16x16x32_bf16 v[240:243], v[156:159], v[84:87], v[240:243]
    v_mfma_f32_16x16x32_bf16 v[240:243], v[160:163], v[88:91], v[240:243]
    s_add_u32 m0, s55, 18432
    s_waitcnt vmcnt(8)
    buffer_load_dwordx4 v5, s[20:23], s57 offen offset:0 nt lds
    s_waitcnt vmcnt(8)
    buffer_load_dwordx4 v6, s[20:23], s57 offen offset:1024 nt lds
    s_add_u32 m0, s55, 24576
    s_waitcnt vmcnt(8)
    buffer_load_dwordx4 v15, s[32:35], s75 offen offset:1024 lds
    s_add_u32 m0, s55, 18432
    s_waitcnt vmcnt(8)
    buffer_load_dwordx4 v7, s[20:23], s57 offen offset:2048 nt lds
    s_add_u32 m0, s55, 21504
    s_add_u32 s0, s57, 3072
    s_waitcnt vmcnt(8)
    buffer_load_dwordx4 v8, s[20:23], s0 offen offset:0 nt lds
    s_add_u32 m0, s55, 24576
    s_waitcnt vmcnt(8)
    buffer_load_dwordx4 v16, s[32:35], s75 offen offset:2048 lds
    ds_read_b64_tr_b16 a[40:41], v25 offset:12288
    ds_read_b64_tr_b16 a[44:45], v25 offset:12320
    ds_read_b64_tr_b16 a[48:49], v25 offset:12352
    ds_read_b64_tr_b16 a[52:53], v25 offset:12384
    ds_read_b64_tr_b16 a[56:57], v25 offset:12416
    ds_read_b64_tr_b16 a[60:61], v25 offset:12448
    ds_read_b64_tr_b16 a[64:65], v25 offset:12480
    ds_read_b64_tr_b16 a[68:69], v25 offset:12512
    ds_read_b64_tr_b16 a[72:73], v25 offset:12544
    ds_read_b64_tr_b16 a[76:77], v25 offset:12576
    s_add_u32 m0, s55, 21504
    s_waitcnt vmcnt(8)
    buffer_load_dwordx4 v9, s[20:23], s0 offen offset:1024 nt lds
    s_waitcnt vmcnt(8)
    buffer_load_dwordx4 v10, s[20:23], s0 offen offset:2048 nt lds
    s_add_u32 s57, s57, 24576
    s_sub_u32 s0, s57, 393216
    s_min_u32 s57, s57, s0
    ds_read_b128 v[140:143], v23 offset:0
    ds_read_b128 v[144:147], v24 offset:0
    ds_read_b128 v[148:151], v23 offset:128
    ds_read_b128 v[152:155], v24 offset:128
    ds_read_b128 v[156:159], v23 offset:256
    ds_read_b128 v[160:163], v24 offset:256
    s_add_u32 m0, s55, 24576
    s_waitcnt vmcnt(8)
    buffer_load_dwordx4 v17, s[32:35], s75 offen offset:3072 lds
    s_waitcnt lgkmcnt(0)
    v_mfma_f32_16x16x32_bf16 v[244:247], v[140:143], v[68:71], 0
    v_mfma_f32_16x16x32_bf16 v[244:247], v[144:147], v[72:75], v[244:247]
    v_mfma_f32_16x16x32_bf16 v[244:247], v[148:151], v[76:79], v[244:247]
    v_mfma_f32_16x16x32_bf16 v[244:247], v[152:155], v[80:83], v[244:247]
    v_mfma_f32_16x16x32_bf16 v[244:247], v[156:159], v[84:87], v[244:247]
    v_mfma_f32_16x16x32_bf16 v[244:247], v[160:163], v[88:91], v[244:247]
    s_add_u32 m0, s55, 30720
    s_waitcnt vmcnt(8)
    buffer_load_dwordx4 v11, s[24:27], s57 offen offset:0 nt lds
    s_waitcnt vmcnt(8)
    buffer_load_dwordx4 v12, s[24:27], s57 offen offset:1024 nt lds
    s_add_u32 m0, s55, 28672
    s_waitcnt vmcnt(8)
    buffer_load_dwordx4 v18, s[32:35], s75 offen offset:0 lds
    s_add_u32 m0, s55, 30720
    s_waitcnt vmcnt(8)
    buffer_load_dwordx4 v13, s[24:27], s57 offen offset:2048 nt lds
    s_mov_b32 s75, 81920
    s_add_u32 m0, s55, 6144
    s_waitcnt vmcnt(8)
    buffer_load_dwordx4 v14, s[32:35], s75 offen offset:0 lds
    s_add_u32 m0, s55, 33792
    s_add_u32 s0, s57, 3072
    s_waitcnt vmcnt(8)
    buffer_load_dwordx4 v11, s[24:27], s0 offen offset:0 nt lds
    s_waitcnt vmcnt(8)
    buffer_load_dwordx4 v12, s[24:27], s0 offen offset:1024 nt lds
    s_add_u32 m0, s55, 6144
    s_waitcnt vmcnt(8)
    buffer_load_dwordx4 v15, s[32:35], s75 offen offset:1024 lds
    ds_read_b128 v[140:143], v23 offset:18432
    ds_read_b128 v[144:147], v24 offset:18432
    ds_read_b128 v[148:151], v23 offset:18560
    ds_read_b128 v[152:155], v24 offset:18560
    ds_read_b128 v[156:159], v23 offset:18688
    ds_read_b128 v[160:163], v24 offset:18688
    s_add_u32 m0, s55, 33792
    s_waitcnt vmcnt(8)
    buffer_load_dwordx4 v13, s[24:27], s0 offen offset:2048 nt lds
    s_add_u32 s57, s57, 24576
    s_sub_u32 s0, s57, 393216
    s_min_u32 s57, s57, s0
    s_waitcnt lgkmcnt(0)
    v_mfma_f32_16x16x32_bf16 v[248:251], v[140:143], v[68:71], 0
    v_mfma_f32_16x16x32_bf16 v[248:251], v[144:147], v[72:75], v[248:251]
    v_mfma_f32_16x16x32_bf16 v[248:251], v[148:151], v[76:79], v[248:251]
    v_mfma_f32_16x16x32_bf16 v[248:251], v[152:155], v[80:83], v[248:251]
    v_mfma_f32_16x16x32_bf16 v[248:251], v[156:159], v[84:87], v[248:251]
    v_mfma_f32_16x16x32_bf16 v[248:251], v[160:163], v[88:91], v[248:251]
    s_add_u32 m0, s55, 12288
    s_waitcnt vmcnt(8)
    buffer_load_dwordx4 v11, s[24:27], s57 offen offset:0 nt lds
    v_max3_f32 v40, v188, v189, v190
    v_max3_f32 v41, v191, v192, v193
    v_max3_f32 v40, v40, v194, v195
    v_max3_f32 v41, v41, v196, v197
    v_max3_f32 v40, v40, v198, v199
    v_max3_f32 v41, v41, v200, v201
    v_max3_f32 v40, v40, v202, v203
    v_max3_f32 v41, v41, v204, v205
    v_max3_f32 v40, v40, v206, v207
    v_max3_f32 v41, v41, v208, v209
    v_max3_f32 v40, v40, v210, v211
    v_max3_f32 v41, v41, v212, v213
    v_max3_f32 v40, v40, v214, v215
    v_max3_f32 v41, v41, v216, v217
    v_max3_f32 v40, v40, v218, v219
    v_max3_f32 v41, v41, v220, v221
    v_max3_f32 v40, v40, v222, v223
    v_max3_f32 v41, v41, v224, v225
    v_max3_f32 v40, v40, v226, v227
    v_max3_f32 v41, v41, v228, v229
    v_max3_f32 v40, v40, v230, v231
    v_max3_f32 v41, v41, v232, v233
    v_max3_f32 v40, v40, v234, v235
    v_max3_f32 v41, v41, v236, v237
    v_max3_f32 v40, v40, v238, v239
    s_add_u32 m0, s55, 6144
    s_waitcnt vmcnt(8)
    buffer_load_dwordx4 v16, s[32:35], s75 offen offset:2048 lds
    v_max3_f32 v41, v41, v240, v241
    v_max3_f32 v40, v40, v242, v243
    v_max3_f32 v41, v41, v244, v245
    v_max3_f32 v40, v40, v246, v247
    v_max3_f32 v41, v41, v248, v249
    v_max3_f32 v40, v40, v250, v251
    v_max_f32 v40, v40, v41
    v_mul_f32 v41, s60, v40
    v_max_f32 v41, 0xff7fffff, v41
    v_fma_f32 v188, v188, s60, -v41
    v_fma_f32 v189, v189, s60, -v41
    v_fma_f32 v190, v190, s60, -v41
    v_fma_f32 v191, v191, s60, -v41
    v_fma_f32 v192, v192, s60, -v41
    v_fma_f32 v193, v193, s60, -v41
    v_fma_f32 v194, v194, s60, -v41
    v_fma_f32 v195, v195, s60, -v41
    v_fma_f32 v196, v196, s60, -v41
    v_fma_f32 v197, v197, s60, -v41
    v_fma_f32 v198, v198, s60, -v41
    v_fma_f32 v199, v199, s60, -v41
    v_fma_f32 v200, v200, s60, -v41
    v_fma_f32 v201, v201, s60, -v41
    v_fma_f32 v202, v202, s60, -v41
    v_fma_f32 v203, v203, s60, -v41
    s_add_u32 m0, s55, 12288
    s_waitcnt vmcnt(8)
    buffer_load_dwordx4 v12, s[24:27], s57 offen offset:1024 nt lds
    v_fma_f32 v204, v204, s60, -v41
    v_fma_f32 v205, v205, s60, -v41
    v_fma_f32 v206, v206, s60, -v41
    v_fma_f32 v207, v207, s60, -v41
    v_fma_f32 v208, v208, s60, -v41
    v_fma_f32 v209, v209, s60, -v41
    v_fma_f32 v210, v210, s60, -v41
    v_fma_f32 v211, v211, s60, -v41
    v_fma_f32 v212, v212, s60, -v41
    v_fma_f32 v213, v213, s60, -v41
    v_fma_f32 v214, v214, s60, -v41
    v_fma_f32 v215, v215, s60, -v41
    v_fma_f32 v216, v216, s60, -v41
    v_fma_f32 v217, v217, s60, -v41
    v_fma_f32 v218, v218, s60, -v41
    v_fma_f32 v219, v219, s60, -v41
    v_fma_f32 v220, v220, s60, -v41
    v_fma_f32 v221, v221, s60, -v41
    v_fma_f32 v222, v222, s60, -v41
    v_fma_f32 v223, v223, s60, -v41
    v_fma_f32 v224, v224, s60, -v41
    v_fma_f32 v225, v225, s60, -v41
    v_fma_f32 v226, v226, s60, -v41
    v_fma_f32 v227, v227, s60, -v41
    v_fma_f32 v228, v228, s60, -v41
    s_waitcnt vmcnt(8)
    buffer_load_dwordx4 v13, s[24:27], s57 offen offset:2048 nt lds
    v_fma_f32 v229, v229, s60, -v41
    v_fma_f32 v230, v230, s60, -v41
    v_fma_f32 v231, v231, s60, -v41
    v_fma_f32 v232, v232, s60, -v41
    v_fma_f32 v233, v233, s60, -v41
    v_fma_f32 v234, v234, s60, -v41
    v_fma_f32 v235, v235, s60, -v41
    v_fma_f32 v236, v236, s60, -v41
    v_fma_f32 v237, v237, s60, -v41
    v_fma_f32 v238, v238, s60, -v41
    v_fma_f32 v239, v239, s60, -v41
    v_fma_f32 v240, v240, s60, -v41
    v_fma_f32 v241, v241, s60, -v41
    v_fma_f32 v242, v242, s60, -v41
    v_fma_f32 v243, v243, s60, -v41
    v_fma_f32 v244, v244, s60, -v41
    v_fma_f32 v245, v245, s60, -v41
    v_fma_f32 v246, v246, s60, -v41
    v_fma_f32 v247, v247, s60, -v41
    v_fma_f32 v248, v248, s60, -v41
    v_fma_f32 v249, v249, s60, -v41
    v_fma_f32 v250, v250, s60, -v41
    v_fma_f32 v251, v251, s60, -v41
    v_exp_f32 v188, v188
    v_exp_f32 v189, v189
    s_add_u32 m0, s55, 6144
    s_waitcnt vmcnt(8)
    buffer_load_dwordx4 v17, s[32:35], s75 offen offset:3072 lds
    v_exp_f32 v190, v190
    v_exp_f32 v191, v191
    v_exp_f32 v192, v192
    v_exp_f32 v193, v193
    v_exp_f32 v194, v194
    v_exp_f32 v195, v195
    v_exp_f32 v196, v196
    v_exp_f32 v197, v197
    v_exp_f32 v198, v198
    v_exp_f32 v199, v199
    v_exp_f32 v200, v200
    v_exp_f32 v201, v201
    v_exp_f32 v202, v202
    v_exp_f32 v203, v203
    v_exp_f32 v204, v204
    v_exp_f32 v205, v205
    v_exp_f32 v206, v206
    v_exp_f32 v207, v207
    v_exp_f32 v208, v208
    v_exp_f32 v209, v209
    v_exp_f32 v210, v210
    v_exp_f32 v211, v211
    v_exp_f32 v212, v212
    v_exp_f32 v213, v213
    v_exp_f32 v214, v214
    s_add_u32 m0, s55, 15360
    s_add_u32 s0, s57, 3072
    s_waitcnt vmcnt(8)
    buffer_load_dwordx4 v11, s[24:27], s0 offen offset:0 nt lds
    v_exp_f32 v215, v215
    v_exp_f32 v216, v216
    v_exp_f32 v217, v217
    v_exp_f32 v218, v218
    v_exp_f32 v219, v219
    v_exp_f32 v220, v220
    v_exp_f32 v221, v221
    v_exp_f32 v222, v222
    v_exp_f32 v223, v223
    v_exp_f32 v224, v224
    v_exp_f32 v225, v225
    v_exp_f32 v226, v226
    v_exp_f32 v227, v227
    v_exp_f32 v228, v228
    v_exp_f32 v229, v229
    v_exp_f32 v230, v230
    v_exp_f32 v231, v231
    v_exp_f32 v232, v232
    v_exp_f32 v233, v233
    v_exp_f32 v234, v234
    v_exp_f32 v235, v235
    v_exp_f32 v236, v236
    v_exp_f32 v237, v237
    v_exp_f32 v238, v238
    v_exp_f32 v239, v239
    s_waitcnt vmcnt(8)
    buffer_load_dwordx4 v12, s[24:27], s0 offen offset:1024 nt lds
    v_exp_f32 v240, v240
    v_exp_f32 v241, v241
    v_exp_f32 v242, v242
    v_exp_f32 v243, v243
    v_exp_f32 v244, v244
    v_exp_f32 v245, v245
    v_exp_f32 v246, v246
    v_exp_f32 v247, v247
    v_exp_f32 v248, v248
    v_exp_f32 v249, v249
    v_exp_f32 v250, v250
    v_exp_f32 v251, v251
    v_add_f32 v42, v188, v189
    v_add_f32 v43, v190, v191
    v_add_f32 v42, v42, v192
    v_add_f32 v43, v43, v193
    v_add_f32 v42, v42, v194
    v_add_f32 v43, v43, v195
    v_add_f32 v42, v42, v196
    v_add_f32 v43, v43, v197
    v_add_f32 v42, v42, v198
    v_add_f32 v43, v43, v199
    v_add_f32 v42, v42, v200
    v_add_f32 v43, v43, v201
    v_add_f32 v42, v42, v202
    s_add_u32 m0, s55, 10240
    s_waitcnt vmcnt(8)
    buffer_load_dwordx4 v18, s[32:35], s75 offen offset:0 lds
    v_add_f32 v43, v43, v203
    v_add_f32 v42, v42, v204
    v_add_f32 v43, v43, v205
    v_add_f32 v42, v42, v206
    v_add_f32 v43, v43, v207
    v_add_f32 v42, v42, v208
    v_add_f32 v43, v43, v209
    v_add_f32 v42, v42, v210
    v_add_f32 v43, v43, v211
    v_add_f32 v42, v42, v212
    v_add_f32 v43, v43, v213
    v_add_f32 v42, v42, v214
    v_add_f32 v43, v43, v215
    v_add_f32 v42, v42, v216
    v_add_f32 v43, v43, v217
    v_add_f32 v42, v42, v218
    v_add_f32 v43, v43, v219
    v_add_f32 v42, v42, v220
    v_add_f32 v43, v43, v221
    v_add_f32 v42, v42, v222
    v_add_f32 v43, v43, v223
    v_add_f32 v42, v42, v224
    v_add_f32 v43, v43, v225
    v_add_f32 v42, v42, v226
    v_add_f32 v43, v43, v227
    s_add_u32 m0, s55, 15360
    s_waitcnt vmcnt(8)
    buffer_load_dwordx4 v13, s[24:27], s0 offen offset:2048 nt lds
    s_add_u32 s57, s57, 24576
    s_sub_u32 s0, s57, 393216
    s_min_u32 s57, s57, s0
    v_add_f32 v42, v42, v228
    v_add_f32 v43, v43, v229
    v_add_f32 v42, v42, v230
    v_add_f32 v43, v43, v231
    v_add_f32 v42, v42, v232
    v_add_f32 v43, v43, v233
    v_add_f32 v42, v42, v234
    v_add_f32 v43, v43, v235
    v_add_f32 v42, v42, v236
    v_add_f32 v43, v43, v237
    v_add_f32 v42, v42, v238
    v_add_f32 v43, v43, v239
    v_add_f32 v42, v42, v240
    v_add_f32 v43, v43, v241
    v_add_f32 v42, v42, v242
    v_add_f32 v43, v43, v243
    v_add_f32 v42, v42, v244
    v_add_f32 v43, v43, v245
    v_add_f32 v42, v42, v246
    v_add_f32 v43, v43, v247
    v_add_f32 v42, v42, v248
    v_add_f32 v43, v43, v249
    v_add_f32 v42, v42, v250
    v_add_f32 v43, v43, v251
    v_mov_b32 v44, v41
    s_add_u32 m0, s55, 0
    s_waitcnt vmcnt(8)
    buffer_load_dwordx4 v11, s[24:27], s57 offen offset:0 nt lds
    v_add_f32 v45, v42, v43
    s_mov_b64 exec, s[62:63]
    ds_write_b64 v30, v[44:45]
    s_mov_b64 exec, -1
    v_add_u32 v39, 1, v39
    v_and_b32 v2, 0xfff, v39
    v_bfe_u32 v3, v39, 12, 12
    v_lshrrev_b32 v4, 20, v39
    v_lshrrev_b32 v46, 1, v1
    v_and_b32 v46, 8, v46
    v_add_u32 v46, 12, v46
    v_bfe_u32 v0, v39, v46, 12
    v_xor_b32 v3, v2, v3
    v_xor_b32 v4, v2, v4
    v_xor_b32 v0, v2, v0
    s_mov_b32 s75, 102400
    s_add_u32 m0, s55, 18432
    s_nop 0
    buffer_load_dwordx4 v14, s[32:35], s75 offen offset:0 lds
    s_add_u32 m0, s55, 0
    s_nop 0
    buffer_load_dwordx4 v12, s[24:27], s57 offen offset:1024 nt lds
    buffer_load_dwordx4 v13, s[24:27], s57 offen offset:2048 nt lds
    s_waitcnt lgkmcnt(0)
    s_barrier
    ds_read_b128 v[92:95], v31 offset:0
    ds_read_b128 v[96:99], v31 offset:16
    ds_read_b128 v[100:103], v31 offset:32
    ds_read_b128 v[104:107], v31 offset:48
    ds_read_b128 v[108:111], v31 offset:64
    ds_read_b128 v[112:115], v31 offset:80
    ds_read_b128 v[116:119], v31 offset:96
    ds_read_b128 v[120:123], v31 offset:112
    s_waitcnt lgkmcnt(0)
    v_max3_f32 v40, v92, v94, v96
    v_max3_f32 v40, v40, v98, v100
    v_max3_f32 v40, v40, v102, v104
    v_max3_f32 v40, v40, v106, v108
    v_max3_f32 v40, v40, v110, v112
    v_max3_f32 v40, v40, v114, v116
    v_max3_f32 v40, v40, v118, v120
    v_max_f32 v40, v40, v122
    v_sub_f32 v92, v92, v40
    v_sub_f32 v94, v94, v40
    v_sub_f32 v96, v96, v40
    v_sub_f32 v98, v98, v40
    v_sub_f32 v100, v100, v40
    v_sub_f32 v102, v102, v40
    v_sub_f32 v104, v104, v40
    v_sub_f32 v106, v106, v40
    v_sub_f32 v108, v108, v40
    v_sub_f32 v110, v110, v40
    v_sub_f32 v112, v112, v40
    v_sub_f32 v114, v114, v40
    v_sub_f32 v116, v116, v40
    v_sub_f32 v118, v118, v40
    v_sub_f32 v120, v120, v40
    v_sub_f32 v122, v122, v40
    v_sub_f32 v41, v41, v40
    s_add_u32 m0, s55, 18432
    s_waitcnt vmcnt(8)
    buffer_load_dwordx4 v15, s[32:35], s75 offen offset:1024 lds
    v_exp_f32 v92, v92
    v_exp_f32 v94, v94
    v_exp_f32 v96, v96
    v_exp_f32 v98, v98
    v_exp_f32 v100, v100
    v_exp_f32 v102, v102
    v_exp_f32 v104, v104
    v_exp_f32 v106, v106
    v_exp_f32 v108, v108
    v_exp_f32 v110, v110
    v_exp_f32 v112, v112
    v_exp_f32 v114, v114
    v_exp_f32 v116, v116
    v_exp_f32 v118, v118
    v_exp_f32 v120, v120
    v_exp_f32 v122, v122
    v_exp_f32 v41, v41
    v_mul_f32 v42, v92, v93
    v_fmac_f32 v42, v94, v95
    v_fmac_f32 v42, v96, v97
    v_fmac_f32 v42, v98, v99
    v_fmac_f32 v42, v100, v101
    v_fmac_f32 v42, v102, v103
    v_fmac_f32 v42, v104, v105
    v_fmac_f32 v42, v106, v107
    s_add_u32 m0, s55, 3072
    s_add_u32 s0, s57, 3072
    s_waitcnt vmcnt(8)
    buffer_load_dwordx4 v11, s[24:27], s0 offen offset:0 nt lds
    v_fmac_f32 v42, v108, v109
    v_fmac_f32 v42, v110, v111
    v_fmac_f32 v42, v112, v113
    v_fmac_f32 v42, v114, v115
    v_fmac_f32 v42, v116, v117
    v_fmac_f32 v42, v118, v119
    v_fmac_f32 v42, v120, v121
    v_fmac_f32 v42, v122, v123
    v_rcp_f32 v42, v42
    s_nop 0
    v_mul_f32 v41, v41, v42
    v_mul_f32 v188, v41, v188
    v_mul_f32 v189, v41, v189
    v_mul_f32 v190, v41, v190
    v_mul_f32 v191, v41, v191
    v_mul_f32 v192, v41, v192
    v_mul_f32 v193, v41, v193
    v_mul_f32 v194, v41, v194
    v_mul_f32 v195, v41, v195
    v_mul_f32 v196, v41, v196
    v_mul_f32 v197, v41, v197
    v_mul_f32 v198, v41, v198
    v_mul_f32 v199, v41, v199
    v_mul_f32 v200, v41, v200
    v_mul_f32 v201, v41, v201
    v_mul_f32 v202, v41, v202
    s_waitcnt vmcnt(8)
    buffer_load_dwordx4 v12, s[24:27], s0 offen offset:1024 nt lds
    v_mul_f32 v203, v41, v203
    v_mul_f32 v204, v41, v204
    v_mul_f32 v205, v41, v205
    v_mul_f32 v206, v41, v206
    v_mul_f32 v207, v41, v207
    v_mul_f32 v208, v41, v208
    v_mul_f32 v209, v41, v209
    v_mul_f32 v210, v41, v210
    v_mul_f32 v211, v41, v211
    v_mul_f32 v212, v41, v212
    v_mul_f32 v213, v41, v213
    v_mul_f32 v214, v41, v214
    v_mul_f32 v215, v41, v215
    v_mul_f32 v216, v41, v216
    v_mul_f32 v217, v41, v217
    v_mul_f32 v218, v41, v218
    v_mul_f32 v219, v41, v219
    v_mul_f32 v220, v41, v220
    v_mul_f32 v221, v41, v221
    v_mul_f32 v222, v41, v222
    v_mul_f32 v223, v41, v223
    v_mul_f32 v224, v41, v224
    v_mul_f32 v225, v41, v225
    v_mul_f32 v226, v41, v226
    v_mul_f32 v227, v41, v227
    s_add_u32 m0, s55, 18432
    s_waitcnt vmcnt(8)
    buffer_load_dwordx4 v16, s[32:35], s75 offen offset:2048 lds
    v_mul_f32 v228, v41, v228
    v_mul_f32 v229, v41, v229
    v_mul_f32 v230, v41, v230
    v_mul_f32 v231, v41, v231
    v_mul_f32 v232, v41, v232
    v_mul_f32 v233, v41, v233
    v_mul_f32 v234, v41, v234
    v_mul_f32 v235, v41, v235
    v_mul_f32 v236, v41, v236
    v_mul_f32 v237, v41, v237
    v_mul_f32 v238, v41, v238
    v_mul_f32 v239, v41, v239
    v_mul_f32 v240, v41, v240
    v_mul_f32 v241, v41, v241
    v_mul_f32 v242, v41, v242
    v_mul_f32 v243, v41, v243
    v_mul_f32 v244, v41, v244
    v_mul_f32 v245, v41, v245
    v_mul_f32 v246, v41, v246
    v_mul_f32 v247, v41, v247
    v_mul_f32 v248, v41, v248
    v_mul_f32 v249, v41, v249
    v_mul_f32 v250, v41, v250
    v_mul_f32 v251, v41, v251
    v_cvt_pk_bf16_f32 v188, v188, v189
    s_add_u32 m0, s55, 3072
    s_waitcnt vmcnt(8)
    buffer_load_dwordx4 v13, s[24:27], s0 offen offset:2048 nt lds
    s_add_u32 s57, s57, 24576
    s_sub_u32 s0, s57, 393216
    s_min_u32 s57, s57, s0
    v_cvt_pk_bf16_f32 v189, v190, v191
    v_cvt_pk_bf16_f32 v190, v192, v193
    v_cvt_pk_bf16_f32 v191, v194, v195
    v_cvt_pk_bf16_f32 v192, v196, v197
    v_cvt_pk_bf16_f32 v193, v198, v199
    v_cvt_pk_bf16_f32 v194, v200, v201
    v_cvt_pk_bf16_f32 v195, v202, v203
    v_cvt_pk_bf16_f32 v196, v204, v205
    v_cvt_pk_bf16_f32 v197, v206, v207
    v_cvt_pk_bf16_f32 v198, v208, v209
    v_cvt_pk_bf16_f32 v199, v210, v211
    v_cvt_pk_bf16_f32 v200, v212, v213
    v_cvt_pk_bf16_f32 v201, v214, v215
    v_cvt_pk_bf16_f32 v202, v216, v217
    v_cvt_pk_bf16_f32 v203, v218, v219
    v_cvt_pk_bf16_f32 v204, v220, v221
    v_cvt_pk_bf16_f32 v205, v222, v223
    v_cvt_pk_bf16_f32 v206, v224, v225
    v_cvt_pk_bf16_f32 v207, v226, v227
    v_cvt_pk_bf16_f32 v208, v228, v229
    v_cvt_pk_bf16_f32 v209, v230, v231
    v_cvt_pk_bf16_f32 v210, v232, v233
    v_cvt_pk_bf16_f32 v211, v234, v235
    v_cvt_pk_bf16_f32 v212, v236, v237
    v_cvt_pk_bf16_f32 v213, v238, v239
    v_cvt_pk_bf16_f32 v214, v240, v241
    v_cvt_pk_bf16_f32 v215, v242, v243
    v_cvt_pk_bf16_f32 v216, v244, v245
    v_cvt_pk_bf16_f32 v217, v246, v247
    v_cvt_pk_bf16_f32 v218, v248, v249
    v_cvt_pk_bf16_f32 v219, v250, v251
    ds_read_b64_tr_b16 a[42:43], v25 offset:24576
    ds_read_b64_tr_b16 a[46:47], v25 offset:24608
    ds_read_b64_tr_b16 a[50:51], v25 offset:24640
    ds_read_b64_tr_b16 a[54:55], v25 offset:24672
    ds_read_b64_tr_b16 a[58:59], v25 offset:24704
    ds_read_b64_tr_b16 a[62:63], v25 offset:24736
    ds_read_b64_tr_b16 a[66:67], v25 offset:24768
    ds_read_b64_tr_b16 a[70:71], v25 offset:24800
    ds_read_b64_tr_b16 a[74:75], v25 offset:24832
    ds_read_b64_tr_b16 a[78:79], v25 offset:24864
    ds_read_b64_tr_b16 v[140:141], v19 offset:30720
    ds_read_b64_tr_b16 v[144:145], v20 offset:30720
    ds_read_b64_tr_b16 v[148:149], v21 offset:30720
    ds_read_b64_tr_b16 v[152:153], v22 offset:30720
    ds_read_b64_tr_b16 v[156:157], v19 offset:30848
    ds_read_b64_tr_b16 v[160:161], v20 offset:30848
    ds_read_b64_tr_b16 v[164:165], v21 offset:30848
    ds_read_b64_tr_b16 v[168:169], v22 offset:30848
    ds_read_b64_tr_b16 v[172:173], v19 offset:30976
    ds_read_b64_tr_b16 v[176:177], v20 offset:30976
    ds_read_b64_tr_b16 v[180:181], v21 offset:30976
    ds_read_b64_tr_b16 v[184:185], v22 offset:30976
    ds_read_b64_tr_b16 a[80:81], v25 offset:6144
    ds_read_b64_tr_b16 a[84:85], v25 offset:6176
    ds_read_b64_tr_b16 a[88:89], v25 offset:6208
    ds_read_b64_tr_b16 a[92:93], v25 offset:6240
    ds_read_b64_tr_b16 a[96:97], v25 offset:6272
    ds_read_b64_tr_b16 a[100:101], v25 offset:6304
    ds_read_b64_tr_b16 a[104:105], v25 offset:6336
    ds_read_b64_tr_b16 a[108:109], v25 offset:6368
    ds_read_b64_tr_b16 a[112:113], v25 offset:6400
    ds_read_b64_tr_b16 a[116:117], v25 offset:6432
    ds_read_b64_tr_b16 v[142:143], v19 offset:12288
    ds_read_b64_tr_b16 v[146:147], v20 offset:12288
    ds_read_b64_tr_b16 v[150:151], v21 offset:12288
    ds_read_b64_tr_b16 v[154:155], v22 offset:12288
    ds_read_b64_tr_b16 v[158:159], v19 offset:12416
    ds_read_b64_tr_b16 v[162:163], v20 offset:12416
    ds_read_b64_tr_b16 v[166:167], v21 offset:12416
    ds_read_b64_tr_b16 v[170:171], v22 offset:12416
    ds_read_b64_tr_b16 v[174:175], v19 offset:12544
    ds_read_b64_tr_b16 v[178:179], v20 offset:12544
    ds_read_b64_tr_b16 v[182:183], v21 offset:12544
    ds_read_b64_tr_b16 v[186:187], v22 offset:12544
    s_waitcnt lgkmcnt(0)
    v_mfma_f32_16x16x32_bf16 v[92:95], v[140:143], v[188:191], 0
    v_mfma_f32_16x16x32_bf16 v[96:99], v[144:147], v[188:191], 0
    v_mfma_f32_16x16x32_bf16 v[100:103], v[148:151], v[188:191], 0
    v_mfma_f32_16x16x32_bf16 v[104:107], v[152:155], v[188:191], 0
    v_mfma_f32_16x16x32_bf16 v[108:111], v[156:159], v[188:191], 0
    v_mfma_f32_16x16x32_bf16 v[112:115], v[160:163], v[188:191], 0
    s_add_u32 m0, s55, 24576
    s_waitcnt vmcnt(8)
    buffer_load_dwordx4 v11, s[24:27], s57 offen offset:0 nt lds
    v_mfma_f32_16x16x32_bf16 v[116:119], v[164:167], v[188:191], 0
    v_mfma_f32_16x16x32_bf16 v[120:123], v[168:171], v[188:191], 0
    v_mfma_f32_16x16x32_bf16 v[124:127], v[172:175], v[188:191], 0
    v_mfma_f32_16x16x32_bf16 v[128:131], v[176:179], v[188:191], 0
    v_mfma_f32_16x16x32_bf16 v[132:135], v[180:183], v[188:191], 0
    v_mfma_f32_16x16x32_bf16 v[136:139], v[184:187], v[188:191], 0
    s_add_u32 m0, s55, 18432
    s_waitcnt vmcnt(8)
    buffer_load_dwordx4 v17, s[32:35], s75 offen offset:3072 lds
    s_add_u32 m0, s55, 24576
    s_waitcnt vmcnt(8)
    buffer_load_dwordx4 v12, s[24:27], s57 offen offset:1024 nt lds
    s_waitcnt vmcnt(8)
    buffer_load_dwordx4 v13, s[24:27], s57 offen offset:2048 nt lds
    s_add_u32 m0, s55, 22528
    s_waitcnt vmcnt(8)
    buffer_load_dwordx4 v18, s[32:35], s75 offen offset:0 lds
    s_add_u32 m0, s55, 27648
    s_add_u32 s0, s57, 3072
    s_waitcnt vmcnt(8)
    buffer_load_dwordx4 v11, s[24:27], s0 offen offset:0 nt lds
    s_mov_b32 s75, 122880
    s_add_u32 m0, s55, 30720
    s_waitcnt vmcnt(8)
    buffer_load_dwordx4 v14, s[32:35], s75 offen offset:0 lds
    s_add_u32 m0, s55, 27648
    s_waitcnt vmcnt(8)
    buffer_load_dwordx4 v12, s[24:27], s0 offen offset:1024 nt lds
    s_waitcnt vmcnt(8)
    buffer_load_dwordx4 v13, s[24:27], s0 offen offset:2048 nt lds
    s_add_u32 s57, s57, 24576
    s_sub_u32 s0, s57, 393216
    s_min_u32 s57, s57, s0
    ds_read_b64_tr_b16 v[140:141], v19 offset:0
    ds_read_b64_tr_b16 v[144:145], v20 offset:0
    ds_read_b64_tr_b16 v[148:149], v21 offset:0
    ds_read_b64_tr_b16 v[152:153], v22 offset:0
    ds_read_b64_tr_b16 v[156:157], v19 offset:128
    ds_read_b64_tr_b16 v[160:161], v20 offset:128
    ds_read_b64_tr_b16 v[164:165], v21 offset:128
    ds_read_b64_tr_b16 v[168:169], v22 offset:128
    ds_read_b64_tr_b16 v[172:173], v19 offset:256
    ds_read_b64_tr_b16 v[176:177], v20 offset:256
    ds_read_b64_tr_b16 v[180:181], v21 offset:256
    ds_read_b64_tr_b16 v[184:185], v22 offset:256
    s_add_u32 m0, s55, 30720
    s_waitcnt vmcnt(8)
    buffer_load_dwordx4 v15, s[32:35], s75 offen offset:1024 lds
    s_add_u32 m0, s55, 12288
    s_waitcnt vmcnt(8)
    buffer_load_dwordx4 v11, s[24:27], s57 offen offset:0 nt lds
    s_waitcnt vmcnt(8)
    buffer_load_dwordx4 v12, s[24:27], s57 offen offset:1024 nt lds
    s_add_u32 m0, s55, 30720
    s_waitcnt vmcnt(8)
    buffer_load_dwordx4 v16, s[32:35], s75 offen offset:2048 lds
    s_add_u32 m0, s55, 12288
    s_waitcnt vmcnt(8)
    buffer_load_dwordx4 v13, s[24:27], s57 offen offset:2048 nt lds
    ds_read_b64_tr_b16 a[82:83], v25 offset:18432
    ds_read_b64_tr_b16 a[86:87], v25 offset:18464
    ds_read_b64_tr_b16 a[90:91], v25 offset:18496
    ds_read_b64_tr_b16 a[94:95], v25 offset:18528
    ds_read_b64_tr_b16 a[98:99], v25 offset:18560
    ds_read_b64_tr_b16 a[102:103], v25 offset:18592
    ds_read_b64_tr_b16 a[106:107], v25 offset:18624
    ds_read_b64_tr_b16 a[110:111], v25 offset:18656
    ds_read_b64_tr_b16 a[114:115], v25 offset:18688
    ds_read_b64_tr_b16 a[118:119], v25 offset:18720
    s_add_u32 m0, s55, 15360
    s_add_u32 s0, s57, 3072
    s_waitcnt vmcnt(8)
    buffer_load_dwordx4 v11, s[24:27], s0 offen offset:0 nt lds
    s_add_u32 m0, s55, 30720
    s_waitcnt vmcnt(8)
    buffer_load_dwordx4 v17, s[32:35], s75 offen offset:3072 lds
    s_add_u32 m0, s55, 15360
    s_waitcnt vmcnt(8)
    buffer_load_dwordx4 v12, s[24:27], s0 offen offset:1024 nt lds
    s_waitcnt vmcnt(8)
    buffer_load_dwordx4 v13, s[24:27], s0 offen offset:2048 nt lds
    s_add_u32 s57, s57, 24576
    s_sub_u32 s0, s57, 393216
    s_min_u32 s57, s57, s0
    ds_read_b64_tr_b16 v[142:143], v19 offset:24576
    ds_read_b64_tr_b16 v[146:147], v20 offset:24576
    ds_read_b64_tr_b16 v[150:151], v21 offset:24576
    ds_read_b64_tr_b16 v[154:155], v22 offset:24576
    ds_read_b64_tr_b16 v[158:159], v19 offset:24704
    ds_read_b64_tr_b16 v[162:163], v20 offset:24704
    ds_read_b64_tr_b16 v[166:167], v21 offset:24704
    ds_read_b64_tr_b16 v[170:171], v22 offset:24704
    ds_read_b64_tr_b16 v[174:175], v19 offset:24832
    ds_read_b64_tr_b16 v[178:179], v20 offset:24832
    ds_read_b64_tr_b16 v[182:183], v21 offset:24832
    ds_read_b64_tr_b16 v[186:187], v22 offset:24832
    s_add_u32 m0, s55, 34816
    s_waitcnt vmcnt(8)
    buffer_load_dwordx4 v18, s[32:35], s75 offen offset:0 lds
    s_waitcnt lgkmcnt(0)
    v_mfma_f32_16x16x32_bf16 v[92:95], v[140:143], v[192:195], v[92:95]
    v_mfma_f32_16x16x32_bf16 v[96:99], v[144:147], v[192:195], v[96:99]
    v_mfma_f32_16x16x32_bf16 v[100:103], v[148:151], v[192:195], v[100:103]
    v_mfma_f32_16x16x32_bf16 v[104:107], v[152:155], v[192:195], v[104:107]
    v_mfma_f32_16x16x32_bf16 v[108:111], v[156:159], v[192:195], v[108:111]
    v_mfma_f32_16x16x32_bf16 v[112:115], v[160:163], v[192:195], v[112:115]
    s_add_u32 m0, s55, 6144
    s_waitcnt vmcnt(8)
    buffer_load_dwordx4 v11, s[24:27], s57 offen offset:0 nt lds
    v_mfma_f32_16x16x32_bf16 v[116:119], v[164:167], v[192:195], v[116:119]
    v_mfma_f32_16x16x32_bf16 v[120:123], v[168:171], v[192:195], v[120:123]
    v_mfma_f32_16x16x32_bf16 v[124:127], v[172:175], v[192:195], v[124:127]
    v_mfma_f32_16x16x32_bf16 v[128:131], v[176:179], v[192:195], v[128:131]
    v_mfma_f32_16x16x32_bf16 v[132:135], v[180:183], v[192:195], v[132:135]
    v_mfma_f32_16x16x32_bf16 v[136:139], v[184:187], v[192:195], v[136:139]
    s_waitcnt vmcnt(8)
    buffer_load_dwordx4 v12, s[24:27], s57 offen offset:1024 nt lds
    s_mov_b32 s75, 143360
    s_add_u32 m0, s55, 0
    s_waitcnt vmcnt(8)
    buffer_load_dwordx4 v14, s[32:35], s75 offen offset:0 lds
    s_add_u32 m0, s55, 6144
    s_waitcnt vmcnt(8)
    buffer_load_dwordx4 v13, s[24:27], s57 offen offset:2048 nt lds
    s_add_u32 m0, s55, 9216
    s_add_u32 s0, s57, 3072
    s_waitcnt vmcnt(8)
    buffer_load_dwordx4 v11, s[24:27], s0 offen offset:0 nt lds
    s_add_u32 m0, s55, 0
    s_waitcnt vmcnt(8)
    buffer_load_dwordx4 v15, s[32:35], s75 offen offset:1024 lds
    s_add_u32 m0, s55, 9216
    s_waitcnt vmcnt(8)
    buffer_load_dwordx4 v12, s[24:27], s0 offen offset:1024 nt lds
    s_waitcnt vmcnt(8)
    buffer_load_dwordx4 v13, s[24:27], s0 offen offset:2048 nt lds
    s_add_u32 s57, s57, 24576
    s_sub_u32 s0, s57, 393216
    s_min_u32 s57, s57, s0
    ds_read_b64_tr_b16 v[140:141], v19 offset:12288
    ds_read_b64_tr_b16 v[144:145], v20 offset:12288
    ds_read_b64_tr_b16 v[148:149], v21 offset:12288
    ds_read_b64_tr_b16 v[152:153], v22 offset:12288
    ds_read_b64_tr_b16 v[156:157], v19 offset:12416
    ds_read_b64_tr_b16 v[160:161], v20 offset:12416
    ds_read_b64_tr_b16 v[164:165], v21 offset:12416
    ds_read_b64_tr_b16 v[168:169], v22 offset:12416
    ds_read_b64_tr_b16 v[172:173], v19 offset:12544
    ds_read_b64_tr_b16 v[176:177], v20 offset:12544
    ds_read_b64_tr_b16 v[180:181], v21 offset:12544
    ds_read_b64_tr_b16 v[184:185], v22 offset:12544
    s_add_u32 m0, s55, 0
    s_waitcnt vmcnt(8)
    buffer_load_dwordx4 v16, s[32:35], s75 offen offset:2048 lds
    ds_read_b64_tr_b16 a[120:121], v25 offset:30720
    ds_read_b64_tr_b16 a[124:125], v25 offset:30752
    ds_read_b64_tr_b16 a[128:129], v25 offset:30784
    ds_read_b64_tr_b16 a[132:133], v25 offset:30816
    ds_read_b64_tr_b16 a[136:137], v25 offset:30848
    ds_read_b64_tr_b16 a[140:141], v25 offset:30880
    ds_read_b64_tr_b16 a[144:145], v25 offset:30912
    ds_read_b64_tr_b16 a[148:149], v25 offset:30944
    ds_read_b64_tr_b16 a[152:153], v25 offset:30976
    ds_read_b64_tr_b16 a[156:157], v25 offset:31008
    s_add_u32 m0, s55, 18432
    s_waitcnt vmcnt(8)
    buffer_load_dwordx4 v11, s[24:27], s57 offen offset:0 nt lds
    s_waitcnt vmcnt(8)
    buffer_load_dwordx4 v12, s[24:27], s57 offen offset:1024 nt lds
    s_add_u32 m0, s55, 0
    s_waitcnt vmcnt(8)
    buffer_load_dwordx4 v17, s[32:35], s75 offen offset:3072 lds
    s_add_u32 m0, s55, 18432
    s_waitcnt vmcnt(8)
    buffer_load_dwordx4 v13, s[24:27], s57 offen offset:2048 nt lds
    s_add_u32 m0, s55, 21504
    s_add_u32 s0, s57, 3072
    s_waitcnt vmcnt(8)
    buffer_load_dwordx4 v11, s[24:27], s0 offen offset:0 nt lds
    s_add_u32 m0, s55, 4096
    s_waitcnt vmcnt(8)
    buffer_load_dwordx4 v18, s[32:35], s75 offen offset:0 lds
    s_add_u32 m0, s55, 21504
    s_waitcnt vmcnt(8)
    buffer_load_dwordx4 v12, s[24:27], s0 offen offset:1024 nt lds
    s_mov_b32 s75, 163840
    s_add_u32 m0, s55, 24576
    s_waitcnt vmcnt(8)
    buffer_load_dwordx4 v14, s[32:35], s75 offen offset:0 lds
    ds_read_b64_tr_b16 v[142:143], v19 offset:6144
    ds_read_b64_tr_b16 v[146:147], v20 offset:6144
    ds_read_b64_tr_b16 v[150:151], v21 offset:6144
    ds_read_b64_tr_b16 v[154:155], v22 offset:6144
    ds_read_b64_tr_b16 v[158:159], v19 offset:6272
    ds_read_b64_tr_b16 v[162:163], v20 offset:6272
    ds_read_b64_tr_b16 v[166:167], v21 offset:6272
    ds_read_b64_tr_b16 v[170:171], v22 offset:6272
    ds_read_b64_tr_b16 v[174:175], v19 offset:6400
    ds_read_b64_tr_b16 v[178:179], v20 offset:6400
    ds_read_b64_tr_b16 v[182:183], v21 offset:6400
    ds_read_b64_tr_b16 v[186:187], v22 offset:6400
    s_add_u32 m0, s55, 21504
    s_waitcnt vmcnt(8)
    buffer_load_dwordx4 v13, s[24:27], s0 offen offset:2048 nt lds
    s_add_u32 s57, s57, 24576
    s_sub_u32 s0, s57, 393216
    s_min_u32 s57, s57, s0
    s_waitcnt lgkmcnt(0)
    v_mfma_f32_16x16x32_bf16 v[92:95], v[140:143], v[196:199], v[92:95]
    v_mfma_f32_16x16x32_bf16 v[96:99], v[144:147], v[196:199], v[96:99]
    v_mfma_f32_16x16x32_bf16 v[100:103], v[148:151], v[196:199], v[100:103]
    v_mfma_f32_16x16x32_bf16 v[104:107], v[152:155], v[196:199], v[104:107]
    v_mfma_f32_16x16x32_bf16 v[108:111], v[156:159], v[196:199], v[108:111]
    v_mfma_f32_16x16x32_bf16 v[112:115], v[160:163], v[196:199], v[112:115]
    s_add_u32 m0, s55, 6144
    s_waitcnt vmcnt(8)
    buffer_load_dwordx4 v11, s[24:27], s57 offen offset:0 nt lds
    v_mfma_f32_16x16x32_bf16 v[116:119], v[164:167], v[196:199], v[116:119]
    v_mfma_f32_16x16x32_bf16 v[120:123], v[168:171], v[196:199], v[120:123]
    v_mfma_f32_16x16x32_bf16 v[124:127], v[172:175], v[196:199], v[124:127]
    v_mfma_f32_16x16x32_bf16 v[128:131], v[176:179], v[196:199], v[128:131]
    v_mfma_f32_16x16x32_bf16 v[132:135], v[180:183], v[196:199], v[132:135]
    v_mfma_f32_16x16x32_bf16 v[136:139], v[184:187], v[196:199], v[136:139]
    s_add_u32 m0, s55, 24576
    s_waitcnt vmcnt(8)
    buffer_load_dwordx4 v15, s[32:35], s75 offen offset:1024 lds
    s_add_u32 m0, s55, 6144
    s_waitcnt vmcnt(8)
    buffer_load_dwordx4 v12, s[24:27], s57 offen offset:1024 nt lds
    s_waitcnt vmcnt(8)
    buffer_load_dwordx4 v13, s[24:27], s57 offen offset:2048 nt lds
    s_add_u32 m0, s55, 24576
    s_waitcnt vmcnt(8)
    buffer_load_dwordx4 v16, s[32:35], s75 offen offset:2048 lds
    s_add_u32 m0, s55, 9216
    s_add_u32 s0, s57, 3072
    s_waitcnt vmcnt(8)
    buffer_load_dwordx4 v11, s[24:27], s0 offen offset:0 nt lds
    ds_read_b64_tr_b16 a[122:123], v25 offset:0
    ds_read_b64_tr_b16 a[126:127], v25 offset:32
    ds_read_b64_tr_b16 a[130:131], v25 offset:64
    ds_read_b64_tr_b16 a[134:135], v25 offset:96
    ds_read_b64_tr_b16 a[138:139], v25 offset:128
    ds_read_b64_tr_b16 a[142:143], v25 offset:160
    ds_read_b64_tr_b16 a[146:147], v25 offset:192
    ds_read_b64_tr_b16 a[150:151], v25 offset:224
    ds_read_b64_tr_b16 a[154:155], v25 offset:256
    ds_read_b64_tr_b16 a[158:159], v25 offset:288
    s_waitcnt vmcnt(8)
    buffer_load_dwordx4 v12, s[24:27], s0 offen offset:1024 nt lds
    s_add_u32 m0, s55, 24576
    s_waitcnt vmcnt(8)
    buffer_load_dwordx4 v17, s[32:35], s75 offen offset:3072 lds
    s_add_u32 m0, s55, 9216
    s_waitcnt vmcnt(8)
    buffer_load_dwordx4 v13, s[24:27], s0 offen offset:2048 nt lds
    s_add_u32 s57, s57, 24576
    s_sub_u32 s0, s57, 393216
    s_min_u32 s57, s57, s0
    ds_read_b64_tr_b16 v[140:141], v19 offset:18432
    ds_read_b64_tr_b16 v[144:145], v20 offset:18432
    ds_read_b64_tr_b16 v[148:149], v21 offset:18432
    ds_read_b64_tr_b16 v[152:153], v22 offset:18432
    ds_read_b64_tr_b16 v[156:157], v19 offset:18560
    ds_read_b64_tr_b16 v[160:161], v20 offset:18560
    ds_read_b64_tr_b16 v[164:165], v21 offset:18560
    ds_read_b64_tr_b16 v[168:169], v22 offset:18560
    ds_read_b64_tr_b16 v[172:173], v19 offset:18688
    ds_read_b64_tr_b16 v[176:177], v20 offset:18688
    ds_read_b64_tr_b16 v[180:181], v21 offset:18688
    ds_read_b64_tr_b16 v[184:185], v22 offset:18688
    s_add_u32 m0, s55, 30720
    s_waitcnt vmcnt(8)
    buffer_load_dwordx4 v11, s[24:27], s57 offen offset:0 nt lds
    s_add_u32 m0, s55, 28672
    s_waitcnt vmcnt(8)
    buffer_load_dwordx4 v18, s[32:35], s75 offen offset:0 lds
    s_add_u32 m0, s55, 30720
    s_waitcnt vmcnt(8)
    buffer_load_dwordx4 v12, s[24:27], s57 offen offset:1024 nt lds
    s_waitcnt vmcnt(8)
    buffer_load_dwordx4 v13, s[24:27], s57 offen offset:2048 nt lds
    s_mov_b32 s75, 184320
    s_add_u32 m0, s55, 12288
    s_waitcnt vmcnt(8)
    buffer_load_dwordx4 v14, s[32:35], s75 offen offset:0 lds
    s_add_u32 m0, s55, 33792
    s_add_u32 s0, s57, 3072
    s_waitcnt vmcnt(8)
    buffer_load_dwordx4 v11, s[24:27], s0 offen offset:0 nt lds
    s_waitcnt vmcnt(8)
    buffer_load_dwordx4 v12, s[24:27], s0 offen offset:1024 nt lds
    s_add_u32 m0, s55, 12288
    s_waitcnt vmcnt(8)
    buffer_load_dwordx4 v15, s[32:35], s75 offen offset:1024 lds
    s_add_u32 m0, s55, 33792
    s_waitcnt vmcnt(8)
    buffer_load_dwordx4 v13, s[24:27], s0 offen offset:2048 nt lds
    s_add_u32 s57, s57, 24576
    s_sub_u32 s0, s57, 393216
    s_min_u32 s57, s57, s0
    ds_read_b64_tr_b16 v[142:143], v19 offset:6144
    ds_read_b64_tr_b16 v[146:147], v20 offset:6144
    ds_read_b64_tr_b16 v[150:151], v21 offset:6144
    ds_read_b64_tr_b16 v[154:155], v22 offset:6144
    ds_read_b64_tr_b16 v[158:159], v19 offset:6272
    ds_read_b64_tr_b16 v[162:163], v20 offset:6272
    ds_read_b64_tr_b16 v[166:167], v21 offset:6272
    ds_read_b64_tr_b16 v[170:171], v22 offset:6272
    ds_read_b64_tr_b16 v[174:175], v19 offset:6400
    ds_read_b64_tr_b16 v[178:179], v20 offset:6400
    ds_read_b64_tr_b16 v[182:183], v21 offset:6400
    ds_read_b64_tr_b16 v[186:187], v22 offset:6400
    s_waitcnt lgkmcnt(0)
    v_mfma_f32_16x16x32_bf16 v[92:95], v[140:143], v[200:203], v[92:95]
    v_mfma_f32_16x16x32_bf16 v[96:99], v[144:147], v[200:203], v[96:99]
    v_mfma_f32_16x16x32_bf16 v[100:103], v[148:151], v[200:203], v[100:103]
    v_mfma_f32_16x16x32_bf16 v[104:107], v[152:155], v[200:203], v[104:107]
    v_mfma_f32_16x16x32_bf16 v[108:111], v[156:159], v[200:203], v[108:111]
    v_mfma_f32_16x16x32_bf16 v[112:115], v[160:163], v[200:203], v[112:115]
    s_add_u32 m0, s55, 6144
    s_waitcnt vmcnt(8)
    buffer_load_dwordx4 v11, s[24:27], s57 offen offset:0 nt lds
    v_mfma_f32_16x16x32_bf16 v[116:119], v[164:167], v[200:203], v[116:119]
    v_mfma_f32_16x16x32_bf16 v[120:123], v[168:171], v[200:203], v[120:123]
    v_mfma_f32_16x16x32_bf16 v[124:127], v[172:175], v[200:203], v[124:127]
    v_mfma_f32_16x16x32_bf16 v[128:131], v[176:179], v[200:203], v[128:131]
    v_mfma_f32_16x16x32_bf16 v[132:135], v[180:183], v[200:203], v[132:135]
    v_mfma_f32_16x16x32_bf16 v[136:139], v[184:187], v[200:203], v[136:139]
    s_add_u32 m0, s55, 12288
    s_waitcnt vmcnt(8)
    buffer_load_dwordx4 v16, s[32:35], s75 offen offset:2048 lds
    ds_read_b64_tr_b16 a[160:161], v25 offset:24576
    ds_read_b64_tr_b16 a[164:165], v25 offset:24608
    ds_read_b64_tr_b16 a[168:169], v25 offset:24640
    ds_read_b64_tr_b16 a[172:173], v25 offset:24672
    ds_read_b64_tr_b16 a[176:177], v25 offset:24704
    ds_read_b64_tr_b16 a[180:181], v25 offset:24736
    ds_read_b64_tr_b16 a[184:185], v25 offset:24768
    ds_read_b64_tr_b16 a[188:189], v25 offset:24800
    ds_read_b64_tr_b16 a[192:193], v25 offset:24832
    ds_read_b64_tr_b16 a[196:197], v25 offset:24864
    s_add_u32 m0, s55, 6144
    s_waitcnt vmcnt(8)
    buffer_load_dwordx4 v12, s[24:27], s57 offen offset:1024 nt lds
    s_waitcnt vmcnt(8)
    buffer_load_dwordx4 v13, s[24:27], s57 offen offset:2048 nt lds
    s_add_u32 m0, s55, 12288
    s_waitcnt vmcnt(8)
    buffer_load_dwordx4 v17, s[32:35], s75 offen offset:3072 lds
    s_add_u32 m0, s55, 9216
    s_add_u32 s0, s57, 3072
    s_waitcnt vmcnt(8)
    buffer_load_dwordx4 v11, s[24:27], s0 offen offset:0 nt lds
    s_waitcnt vmcnt(8)
    buffer_load_dwordx4 v12, s[24:27], s0 offen offset:1024 nt lds
    s_add_u32 m0, s55, 16384
    s_waitcnt vmcnt(8)
    buffer_load_dwordx4 v18, s[32:35], s75 offen offset:0 lds
    s_add_u32 m0, s55, 9216
    s_waitcnt vmcnt(8)
    buffer_load_dwordx4 v13, s[24:27], s0 offen offset:2048 nt lds
    s_add_u32 s57, s57, 24576
    s_sub_u32 s0, s57, 393216
    s_min_u32 s57, s57, s0
    ds_read_b64_tr_b16 v[140:141], v19 offset:30720
    ds_read_b64_tr_b16 v[144:145], v20 offset:30720
    ds_read_b64_tr_b16 v[148:149], v21 offset:30720
    ds_read_b64_tr_b16 v[152:153], v22 offset:30720
    ds_read_b64_tr_b16 v[156:157], v19 offset:30848
    ds_read_b64_tr_b16 v[160:161], v20 offset:30848
    ds_read_b64_tr_b16 v[164:165], v21 offset:30848
    ds_read_b64_tr_b16 v[168:169], v22 offset:30848
    ds_read_b64_tr_b16 v[172:173], v19 offset:30976
    ds_read_b64_tr_b16 v[176:177], v20 offset:30976
    ds_read_b64_tr_b16 v[180:181], v21 offset:30976
    ds_read_b64_tr_b16 v[184:185], v22 offset:30976
    s_mov_b32 s75, 204800
    s_add_u32 m0, s55, 18432
    s_waitcnt vmcnt(8)
    buffer_load_dwordx4 v14, s[32:35], s75 offen offset:0 lds
    s_add_u32 m0, s55, 0
    s_waitcnt vmcnt(8)
    buffer_load_dwordx4 v11, s[24:27], s57 offen offset:0 nt lds
    s_waitcnt vmcnt(8)
    buffer_load_dwordx4 v12, s[24:27], s57 offen offset:1024 nt lds
    s_add_u32 m0, s55, 18432
    s_waitcnt vmcnt(8)
    buffer_load_dwordx4 v15, s[32:35], s75 offen offset:1024 lds
    s_add_u32 m0, s55, 0
    s_waitcnt vmcnt(8)
    buffer_load_dwordx4 v13, s[24:27], s57 offen offset:2048 nt lds
    s_add_u32 m0, s55, 3072
    s_add_u32 s0, s57, 3072
    s_waitcnt vmcnt(8)
    buffer_load_dwordx4 v11, s[24:27], s0 offen offset:0 nt lds
    s_add_u32 m0, s55, 18432
    s_waitcnt vmcnt(8)
    buffer_load_dwordx4 v16, s[32:35], s75 offen offset:2048 lds
    s_add_u32 m0, s55, 3072
    s_waitcnt vmcnt(8)
    buffer_load_dwordx4 v12, s[24:27], s0 offen offset:1024 nt lds
    ds_read_b64_tr_b16 a[162:163], v25 offset:12288
    ds_read_b64_tr_b16 a[166:167], v25 offset:12320
    ds_read_b64_tr_b16 a[170:171], v25 offset:12352
    ds_read_b64_tr_b16 a[174:175], v25 offset:12384
    ds_read_b64_tr_b16 a[178:179], v25 offset:12416
    ds_read_b64_tr_b16 a[182:183], v25 offset:12448
    ds_read_b64_tr_b16 a[186:187], v25 offset:12480
    ds_read_b64_tr_b16 a[190:191], v25 offset:12512
    ds_read_b64_tr_b16 a[194:195], v25 offset:12544
    ds_read_b64_tr_b16 a[198:199], v25 offset:12576
    s_waitcnt vmcnt(8)
    buffer_load_dwordx4 v13, s[24:27], s0 offen offset:2048 nt lds
    s_add_u32 s57, s57, 24576
    s_sub_u32 s0, s57, 393216
    s_min_u32 s57, s57, s0
    ds_read_b64_tr_b16 v[142:143], v19 offset:6144
    ds_read_b64_tr_b16 v[146:147], v20 offset:6144
    ds_read_b64_tr_b16 v[150:151], v21 offset:6144
    ds_read_b64_tr_b16 v[154:155], v22 offset:6144
    ds_read_b64_tr_b16 v[158:159], v19 offset:6272
    ds_read_b64_tr_b16 v[162:163], v20 offset:6272
    ds_read_b64_tr_b16 v[166:167], v21 offset:6272
    ds_read_b64_tr_b16 v[170:171], v22 offset:6272
    ds_read_b64_tr_b16 v[174:175], v19 offset:6400
    ds_read_b64_tr_b16 v[178:179], v20 offset:6400
    ds_read_b64_tr_b16 v[182:183], v21 offset:6400
    ds_read_b64_tr_b16 v[186:187], v22 offset:6400
    s_add_u32 m0, s55, 18432
    s_waitcnt vmcnt(8)
    buffer_load_dwordx4 v17, s[32:35], s75 offen offset:3072 lds
    s_waitcnt lgkmcnt(0)
    v_mfma_f32_16x16x32_bf16 v[92:95], v[140:143], v[204:207], v[92:95]
    v_mfma_f32_16x16x32_bf16 v[96:99], v[144:147], v[204:207], v[96:99]
    v_mfma_f32_16x16x32_bf16 v[100:103], v[148:151], v[204:207], v[100:103]
    v_mfma_f32_16x16x32_bf16 v[104:107], v[152:155], v[204:207], v[104:107]
    v_mfma_f32_16x16x32_bf16 v[108:111], v[156:159], v[204:207], v[108:111]
    v_mfma_f32_16x16x32_bf16 v[112:115], v[160:163], v[204:207], v[112:115]
    s_add_u32 m0, s55, 30720
    s_waitcnt vmcnt(8)
    buffer_load_dwordx4 v11, s[24:27], s57 offen offset:0 nt lds
    v_mfma_f32_16x16x32_bf16 v[116:119], v[164:167], v[204:207], v[116:119]
    v_mfma_f32_16x16x32_bf16 v[120:123], v[168:171], v[204:207], v[120:123]
    v_mfma_f32_16x16x32_bf16 v[124:127], v[172:175], v[204:207], v[124:127]
    v_mfma_f32_16x16x32_bf16 v[128:131], v[176:179], v[204:207], v[128:131]
    v_mfma_f32_16x16x32_bf16 v[132:135], v[180:183], v[204:207], v[132:135]
    v_mfma_f32_16x16x32_bf16 v[136:139], v[184:187], v[204:207], v[136:139]
    s_waitcnt vmcnt(8)
    buffer_load_dwordx4 v12, s[24:27], s57 offen offset:1024 nt lds
    s_add_u32 m0, s55, 22528
    s_waitcnt vmcnt(8)
    buffer_load_dwordx4 v18, s[32:35], s75 offen offset:0 lds
    s_add_u32 m0, s55, 30720
    s_waitcnt vmcnt(8)
    buffer_load_dwordx4 v13, s[24:27], s57 offen offset:2048 nt lds
    s_add_u32 m0, s55, 33792
    s_add_u32 s0, s57, 3072
    s_waitcnt vmcnt(8)
    buffer_load_dwordx4 v11, s[24:27], s0 offen offset:0 nt lds
    s_mov_b32 s75, 225280
    s_add_u32 m0, s55, 6144
    s_waitcnt vmcnt(8)
    buffer_load_dwordx4 v14, s[32:35], s75 offen offset:0 lds
    s_add_u32 m0, s55, 33792
    s_waitcnt vmcnt(8)
    buffer_load_dwordx4 v12, s[24:27], s0 offen offset:1024 nt lds
    s_waitcnt vmcnt(8)
    buffer_load_dwordx4 v13, s[24:27], s0 offen offset:2048 nt lds
    s_add_u32 s57, s57, 24576
    s_sub_u32 s0, s57, 393216
    s_min_u32 s57, s57, s0
    ds_read_b64_tr_b16 v[140:141], v19 offset:0
    ds_read_b64_tr_b16 v[144:145], v20 offset:0
    ds_read_b64_tr_b16 v[148:149], v21 offset:0
    ds_read_b64_tr_b16 v[152:153], v22 offset:0
    ds_read_b64_tr_b16 v[156:157], v19 offset:128
    ds_read_b64_tr_b16 v[160:161], v20 offset:128
    ds_read_b64_tr_b16 v[164:165], v21 offset:128
    ds_read_b64_tr_b16 v[168:169], v22 offset:128
    ds_read_b64_tr_b16 v[172:173], v19 offset:256
    ds_read_b64_tr_b16 v[176:177], v20 offset:256
    ds_read_b64_tr_b16 v[180:181], v21 offset:256
    ds_read_b64_tr_b16 v[184:185], v22 offset:256
    s_add_u32 m0, s55, 6144
    s_waitcnt vmcnt(8)
    buffer_load_dwordx4 v15, s[32:35], s75 offen offset:1024 lds
    s_mov_b32 s8, s57
    s_add_u32 s9, s8, 24576
    s_sub_u32 s0, s9, 393216
    s_min_u32 s9, s9, s0
    s_add_u32 s10, s9, 24576
    s_sub_u32 s0, s10, 393216
    s_min_u32 s10, s10, s0
    s_add_u32 s11, s10, 24576
    s_sub_u32 s0, s11, 393216
    s_min_u32 s11, s11, s0
    s_add_u32 m0, s55, 12288
    s_waitcnt vmcnt(8)
    buffer_load_dwordx4 v27, s[24:27], s8 offen offset:0 nt lds
    s_waitcnt vmcnt(8)
    buffer_load_dwordx4 v27, s[24:27], s8 offen offset:3072 nt lds
    s_add_u32 m0, s55, 6144
    s_waitcnt vmcnt(8)
    buffer_load_dwordx4 v16, s[32:35], s75 offen offset:2048 lds
    ds_read_b64_tr_b16 a[200:201], v25 offset:18432
    ds_read_b64_tr_b16 a[204:205], v25 offset:18464
    ds_read_b64_tr_b16 a[208:209], v25 offset:18496
    ds_read_b64_tr_b16 a[212:213], v25 offset:18528
    ds_read_b64_tr_b16 a[216:217], v25 offset:18560
    ds_read_b64_tr_b16 a[220:221], v25 offset:18592
    ds_read_b64_tr_b16 a[224:225], v25 offset:18624
    ds_read_b64_tr_b16 a[228:229], v25 offset:18656
    ds_read_b64_tr_b16 a[232:233], v25 offset:18688
    ds_read_b64_tr_b16 a[236:237], v25 offset:18720
    s_waitcnt lgkmcnt(0)
    s_add_u32 m0, s55, 18432
    s_waitcnt vmcnt(8)
    buffer_load_dwordx4 v27, s[24:27], s9 offen offset:0 nt lds
    s_waitcnt vmcnt(8)
    buffer_load_dwordx4 v27, s[24:27], s9 offen offset:3072 nt lds
    s_add_u32 m0, s55, 6144
    s_waitcnt vmcnt(8)
    buffer_load_dwordx4 v17, s[32:35], s75 offen offset:3072 lds
    s_add_u32 m0, s55, 24576
    s_waitcnt vmcnt(8)
    buffer_load_dwordx4 v27, s[24:27], s10 offen offset:0 nt lds
    s_waitcnt vmcnt(8)
    buffer_load_dwordx4 v27, s[24:27], s10 offen offset:3072 nt lds
    ds_read_b64_tr_b16 v[142:143], v19 offset:30720
    ds_read_b64_tr_b16 v[146:147], v20 offset:30720
    ds_read_b64_tr_b16 v[150:151], v21 offset:30720
    ds_read_b64_tr_b16 v[154:155], v22 offset:30720
    ds_read_b64_tr_b16 v[158:159], v19 offset:30848
    ds_read_b64_tr_b16 v[162:163], v20 offset:30848
    ds_read_b64_tr_b16 v[166:167], v21 offset:30848
    ds_read_b64_tr_b16 v[170:171], v22 offset:30848
    ds_read_b64_tr_b16 v[174:175], v19 offset:30976
    ds_read_b64_tr_b16 v[178:179], v20 offset:30976
    ds_read_b64_tr_b16 v[182:183], v21 offset:30976
    ds_read_b64_tr_b16 v[186:187], v22 offset:30976
    s_add_u32 m0, s55, 10240
    s_waitcnt vmcnt(8)
    buffer_load_dwordx4 v18, s[32:35], s75 offen offset:0 lds
    s_waitcnt lgkmcnt(0)
    v_mfma_f32_16x16x32_bf16 v[92:95], v[140:143], v[208:211], v[92:95]
    v_mfma_f32_16x16x32_bf16 v[96:99], v[144:147], v[208:211], v[96:99]
    v_mfma_f32_16x16x32_bf16 v[100:103], v[148:151], v[208:211], v[100:103]
    v_mfma_f32_16x16x32_bf16 v[104:107], v[152:155], v[208:211], v[104:107]
    v_mfma_f32_16x16x32_bf16 v[108:111], v[156:159], v[208:211], v[108:111]
    v_mfma_f32_16x16x32_bf16 v[112:115], v[160:163], v[208:211], v[112:115]
    s_add_u32 m0, s55, 30720
    s_waitcnt vmcnt(8)
    buffer_load_dwordx4 v27, s[24:27], s11 offen offset:0 nt lds
    v_mfma_f32_16x16x32_bf16 v[116:119], v[164:167], v[208:211], v[116:119]
    v_mfma_f32_16x16x32_bf16 v[120:123], v[168:171], v[208:211], v[120:123]
    v_mfma_f32_16x16x32_bf16 v[124:127], v[172:175], v[208:211], v[124:127]
    v_mfma_f32_16x16x32_bf16 v[128:131], v[176:179], v[208:211], v[128:131]
    v_mfma_f32_16x16x32_bf16 v[132:135], v[180:183], v[208:211], v[132:135]
    v_mfma_f32_16x16x32_bf16 v[136:139], v[184:187], v[208:211], v[136:139]
    s_waitcnt vmcnt(8)
    buffer_load_dwordx4 v27, s[24:27], s11 offen offset:3072 nt lds
    s_add_u32 m0, s55, 13184
    s_waitcnt vmcnt(8)
    buffer_load_dwordx4 v27, s[24:27], s8 offen offset:128 nt lds
    s_waitcnt vmcnt(8)
    buffer_load_dwordx4 v27, s[24:27], s8 offen offset:3200 nt lds
    s_add_u32 m0, s55, 19328
    s_waitcnt vmcnt(8)
    buffer_load_dwordx4 v27, s[24:27], s9 offen offset:128 nt lds
    s_waitcnt vmcnt(8)
    buffer_load_dwordx4 v27, s[24:27], s9 offen offset:3200 nt lds
    s_add_u32 m0, s55, 25472
    s_waitcnt vmcnt(8)
    buffer_load_dwordx4 v27, s[24:27], s10 offen offset:128 nt lds
    s_waitcnt vmcnt(8)
    buffer_load_dwordx4 v27, s[24:27], s10 offen offset:3200 nt lds
    s_add_u32 m0, s55, 31616
    s_waitcnt vmcnt(8)
    buffer_load_dwordx4 v27, s[24:27], s11 offen offset:128 nt lds
    ds_read_b64_tr_b16 a[202:203], v25 offset:6144
    ds_read_b64_tr_b16 a[206:207], v25 offset:6176
    ds_read_b64_tr_b16 a[210:211], v25 offset:6208
    ds_read_b64_tr_b16 a[214:215], v25 offset:6240
    ds_read_b64_tr_b16 a[218:219], v25 offset:6272
    ds_read_b64_tr_b16 a[222:223], v25 offset:6304
    ds_read_b64_tr_b16 a[226:227], v25 offset:6336
    ds_read_b64_tr_b16 a[230:231], v25 offset:6368
    ds_read_b64_tr_b16 a[234:235], v25 offset:6400
    ds_read_b64_tr_b16 a[238:239], v25 offset:6432
    buffer_load_dwordx4 v27, s[24:27], s11 offen offset:3200 nt lds
    s_add_u32 m0, s55, 14080
    s_waitcnt vmcnt(9)
    buffer_load_dwordx4 v27, s[24:27], s8 offen offset:256 nt lds
    s_waitcnt vmcnt(9)
    buffer_load_dwordx4 v27, s[24:27], s8 offen offset:3328 nt lds
    s_add_u32 m0, s55, 20224
    s_waitcnt vmcnt(9)
    buffer_load_dwordx4 v27, s[24:27], s9 offen offset:256 nt lds
    s_waitcnt vmcnt(9)
    buffer_load_dwordx4 v27, s[24:27], s9 offen offset:3328 nt lds
L_tail:
    s_waitcnt lgkmcnt(0)
    s_waitcnt vmcnt(12)
    ds_read_b64_tr_b16 v[140:141], v252 offset:12288
    ds_read_b64_tr_b16 v[142:143], v252 offset:18432
    ds_read_b64_tr_b16 v[144:145], v253 offset:12288
    ds_read_b64_tr_b16 v[146:147], v253 offset:18432
    ds_read_b64_tr_b16 v[148:149], v254 offset:12288
    ds_read_b64_tr_b16 v[150:151], v254 offset:18432
    ds_read_b64_tr_b16 v[152:153], v255 offset:12288
    ds_read_b64_tr_b16 v[154:155], v255 offset:18432
    ds_read_b64_tr_b16 v[156:157], v252 offset:24576
    ds_read_b64_tr_b16 v[158:159], v252 offset:30720
    ds_read_b64_tr_b16 v[160:161], v253 offset:24576
    ds_read_b64_tr_b16 v[162:163], v253 offset:30720
    ds_read_b64_tr_b16 v[164:165], v254 offset:24576
    ds_read_b64_tr_b16 v[166:167], v254 offset:30720
    s_waitcnt lgkmcnt(10)
    v_mfma_f32_16x16x32_bf16 v[92:95], v[140:143], v[212:215], v[92:95]
    ds_read_b64_tr_b16 v[168:169], v255 offset:24576
    ds_read_b64_tr_b16 v[170:171], v255 offset:30720
    v_mfma_f32_16x16x32_bf16 v[96:99], v[144:147], v[212:215], v[96:99]
    s_waitcnt lgkmcnt(8)
    v_mfma_f32_16x16x32_bf16 v[100:103], v[148:151], v[212:215], v[100:103]
    v_mfma_f32_16x16x32_bf16 v[104:107], v[152:155], v[212:215], v[104:107]
    s_waitcnt lgkmcnt(4)
    v_mfma_f32_16x16x32_bf16 v[92:95], v[156:159], v[216:219], v[92:95]
    v_mfma_f32_16x16x32_bf16 v[96:99], v[160:163], v[216:219], v[96:99]
    s_waitcnt lgkmcnt(0)
    v_mfma_f32_16x16x32_bf16 v[100:103], v[164:167], v[216:219], v[100:103]
    v_mfma_f32_16x16x32_bf16 v[104:107], v[168:171], v[216:219], v[104:107]
    s_add_u32 m0, s55, 26368
    s_waitcnt vmcnt(9)
    buffer_load_dwordx4 v27, s[24:27], s10 offen offset:256 nt lds
    s_mov_b64 exec, s[62:63]
    v_cvt_pk_bf16_f32 v236, v92, v93
    v_cvt_pk_bf16_f32 v237, v94, v95
    v_cvt_pk_bf16_f32 v238, v96, v97
    v_cvt_pk_bf16_f32 v239, v98, v99
    ds_write_b128 v32, v[236:239] offset:0
    v_cvt_pk_bf16_f32 v240, v100, v101
    v_cvt_pk_bf16_f32 v241, v102, v103
    v_cvt_pk_bf16_f32 v242, v104, v105
    v_cvt_pk_bf16_f32 v243, v106, v107
    ds_write_b128 v32, v[240:243] offset:1024
    s_mov_b64 exec, -1
    s_waitcnt lgkmcnt(0)
    s_barrier
    ds_read_b128 v[68:71], v33 offset:0
    ds_read_b128 v[72:75], v33 offset:1024
    s_waitcnt vmcnt(9)
    buffer_load_dwordx4 v27, s[24:27], s10 offen offset:3328 nt lds
    s_waitcnt lgkmcnt(1)
    v_mfma_f32_16x16x32_bf16 v[188:191], v[68:71], a[0:3], 0
    v_mfma_f32_16x16x32_bf16 v[192:195], v[68:71], a[4:7], 0
    v_mfma_f32_16x16x32_bf16 v[196:199], v[68:71], a[8:11], 0
    s_add_u32 m0, s55, 32512
    s_waitcnt vmcnt(9)
    buffer_load_dwordx4 v27, s[24:27], s11 offen offset:256 nt lds
    v_mfma_f32_16x16x32_bf16 v[200:203], v[68:71], a[12:15], 0
    v_mfma_f32_16x16x32_bf16 v[204:207], v[68:71], a[16:19], 0
    v_mfma_f32_16x16x32_bf16 v[208:211], v[68:71], a[20:23], 0
    s_waitcnt vmcnt(9)
    buffer_load_dwordx4 v27, s[24:27], s11 offen offset:3328 nt lds
    v_mfma_f32_16x16x32_bf16 v[220:223], v[68:71], a[24:27], 0
    v_mfma_f32_16x16x32_bf16 v[224:227], v[68:71], a[28:31], 0
    v_mfma_f32_16x16x32_bf16 v[228:231], v[68:71], a[32:35], 0
    v_mfma_f32_16x16x32_bf16 v[232:235], v[68:71], a[36:39], 0
    s_waitcnt lgkmcnt(0)
    v_mfma_f32_16x16x32_bf16 v[188:191], v[72:75], a[40:43], v[188:191]
    v_mfma_f32_16x16x32_bf16 v[192:195], v[72:75], a[44:47], v[192:195]
    v_mfma_f32_16x16x32_bf16 v[196:199], v[72:75], a[48:51], v[196:199]
    v_mfma_f32_16x16x32_bf16 v[200:203], v[72:75], a[52:55], v[200:203]
    v_mfma_f32_16x16x32_bf16 v[204:207], v[72:75], a[56:59], v[204:207]
    v_mfma_f32_16x16x32_bf16 v[208:211], v[72:75], a[60:63], v[208:211]
    v_mfma_f32_16x16x32_bf16 v[220:223], v[72:75], a[64:67], v[220:223]
    v_mfma_f32_16x16x32_bf16 v[224:227], v[72:75], a[68:71], v[224:227]
    v_mfma_f32_16x16x32_bf16 v[228:231], v[72:75], a[72:75], v[228:231]
    v_mfma_f32_16x16x32_bf16 v[232:235], v[72:75], a[76:79], v[232:235]
    s_waitcnt vmcnt(8)
    ds_read_b64_tr_b16 v[140:141], v252 offset:13312
    ds_read_b64_tr_b16 v[142:143], v252 offset:19456
    ds_read_b64_tr_b16 v[144:145], v253 offset:13312
    ds_read_b64_tr_b16 v[146:147], v253 offset:19456
    ds_read_b64_tr_b16 v[148:149], v254 offset:13312
    ds_read_b64_tr_b16 v[150:151], v254 offset:19456
    ds_read_b64_tr_b16 v[152:153], v255 offset:13312
    ds_read_b64_tr_b16 v[154:155], v255 offset:19456
    ds_read_b64_tr_b16 v[156:157], v252 offset:25600
    ds_read_b64_tr_b16 v[158:159], v252 offset:31744
    ds_read_b64_tr_b16 v[160:161], v253 offset:25600
    ds_read_b64_tr_b16 v[162:163], v253 offset:31744
    ds_read_b64_tr_b16 v[164:165], v254 offset:25600
    ds_read_b64_tr_b16 v[166:167], v254 offset:31744
    s_waitcnt lgkmcnt(10)
    v_mfma_f32_16x16x32_bf16 v[108:111], v[140:143], v[212:215], v[108:111]
    ds_read_b64_tr_b16 v[168:169], v255 offset:25600
    ds_read_b64_tr_b16 v[170:171], v255 offset:31744
    v_mfma_f32_16x16x32_bf16 v[112:115], v[144:147], v[212:215], v[112:115]
    s_waitcnt lgkmcnt(8)
    v_mfma_f32_16x16x32_bf16 v[116:119], v[148:151], v[212:215], v[116:119]
    v_mfma_f32_16x16x32_bf16 v[120:123], v[152:155], v[212:215], v[120:123]
    s_waitcnt lgkmcnt(4)
    v_mfma_f32_16x16x32_bf16 v[108:111], v[156:159], v[216:219], v[108:111]
    v_mfma_f32_16x16x32_bf16 v[112:115], v[160:163], v[216:219], v[112:115]
    s_waitcnt lgkmcnt(0)
    v_mfma_f32_16x16x32_bf16 v[116:119], v[164:167], v[216:219], v[116:119]
    v_mfma_f32_16x16x32_bf16 v[120:123], v[168:171], v[216:219], v[120:123]
    s_mov_b64 exec, s[62:63]
    s_nop 2
    v_cvt_pk_bf16_f32 v236, v108, v109
    v_cvt_pk_bf16_f32 v237, v110, v111
    v_cvt_pk_bf16_f32 v238, v112, v113
    v_cvt_pk_bf16_f32 v239, v114, v115
    ds_write_b128 v32, v[236:239] offset:2048
    v_cvt_pk_bf16_f32 v240, v116, v117
    v_cvt_pk_bf16_f32 v241, v118, v119
    v_cvt_pk_bf16_f32 v242, v120, v121
    v_cvt_pk_bf16_f32 v243, v122, v123
    ds_write_b128 v32, v[240:243] offset:3072
    s_mov_b64 exec, -1
    s_waitcnt lgkmcnt(0)
    s_barrier
    ds_read_b128 v[76:79], v33 offset:2048
    ds_read_b128 v[80:83], v33 offset:3072
    s_waitcnt lgkmcnt(1)
    v_mfma_f32_16x16x32_bf16 v[188:191], v[76:79], a[80:83], v[188:191]
    v_mfma_f32_16x16x32_bf16 v[192:195], v[76:79], a[84:87], v[192:195]
    v_mfma_f32_16x16x32_bf16 v[196:199], v[76:79], a[88:91], v[196:199]
    v_mfma_f32_16x16x32_bf16 v[200:203], v[76:79], a[92:95], v[200:203]
    v_mfma_f32_16x16x32_bf16 v[204:207], v[76:79], a[96:99], v[204:207]
    v_mfma_f32_16x16x32_bf16 v[208:211], v[76:79], a[100:103], v[208:211]
    v_mfma_f32_16x16x32_bf16 v[220:223], v[76:79], a[104:107], v[220:223]
    v_mfma_f32_16x16x32_bf16 v[224:227], v[76:79], a[108:111], v[224:227]
    v_mfma_f32_16x16x32_bf16 v[228:231], v[76:79], a[112:115], v[228:231]
    v_mfma_f32_16x16x32_bf16 v[232:235], v[76:79], a[116:119], v[232:235]
    s_waitcnt lgkmcnt(0)
    v_mfma_f32_16x16x32_bf16 v[188:191], v[80:83], a[120:123], v[188:191]
    v_mfma_f32_16x16x32_bf16 v[192:195], v[80:83], a[124:127], v[192:195]
    v_mfma_f32_16x16x32_bf16 v[196:199], v[80:83], a[128:131], v[196:199]
    v_mfma_f32_16x16x32_bf16 v[200:203], v[80:83], a[132:135], v[200:203]
    v_mfma_f32_16x16x32_bf16 v[204:207], v[80:83], a[136:139], v[204:207]
    v_mfma_f32_16x16x32_bf16 v[208:211], v[80:83], a[140:143], v[208:211]
    v_mfma_f32_16x16x32_bf16 v[220:223], v[80:83], a[144:147], v[220:223]
    v_mfma_f32_16x16x32_bf16 v[224:227], v[80:83], a[148:151], v[224:227]
    v_mfma_f32_16x16x32_bf16 v[228:231], v[80:83], a[152:155], v[228:231]
    v_mfma_f32_16x16x32_bf16 v[232:235], v[80:83], a[156:159], v[232:235]
    s_waitcnt vmcnt(0)
    ds_read_b64_tr_b16 v[140:141], v252 offset:14336
    ds_read_b64_tr_b16 v[142:143], v252 offset:20480
    ds_read_b64_tr_b16 v[144:145], v253 offset:14336
    ds_read_b64_tr_b16 v[146:147], v253 offset:20480
    ds_read_b64_tr_b16 v[148:149], v254 offset:14336
    ds_read_b64_tr_b16 v[150:151], v254 offset:20480
    ds_read_b64_tr_b16 v[152:153], v255 offset:14336
    ds_read_b64_tr_b16 v[154:155], v255 offset:20480
    ds_read_b64_tr_b16 v[156:157], v252 offset:26624
    ds_read_b64_tr_b16 v[158:159], v252 offset:32768
    ds_read_b64_tr_b16 v[160:161], v253 offset:26624
    ds_read_b64_tr_b16 v[162:163], v253 offset:32768
    ds_read_b64_tr_b16 v[164:165], v254 offset:26624
    ds_read_b64_tr_b16 v[166:167], v254 offset:32768
    s_waitcnt lgkmcnt(10)
    v_mfma_f32_16x16x32_bf16 v[124:127], v[140:143], v[212:215], v[124:127]
    ds_read_b64_tr_b16 v[168:169], v255 offset:26624
    ds_read_b64_tr_b16 v[170:171], v255 offset:32768
    v_mfma_f32_16x16x32_bf16 v[128:131], v[144:147], v[212:215], v[128:131]
    s_waitcnt lgkmcnt(8)
    v_mfma_f32_16x16x32_bf16 v[132:135], v[148:151], v[212:215], v[132:135]
    v_mfma_f32_16x16x32_bf16 v[136:139], v[152:155], v[212:215], v[136:139]
    s_waitcnt lgkmcnt(4)
    v_mfma_f32_16x16x32_bf16 v[124:127], v[156:159], v[216:219], v[124:127]
    v_mfma_f32_16x16x32_bf16 v[128:131], v[160:163], v[216:219], v[128:131]
    s_waitcnt lgkmcnt(0)
    v_mfma_f32_16x16x32_bf16 v[132:135], v[164:167], v[216:219], v[132:135]
    v_mfma_f32_16x16x32_bf16 v[136:139], v[168:171], v[216:219], v[136:139]
    s_mov_b64 exec, s[62:63]
    s_nop 2
    v_cvt_pk_bf16_f32 v236, v124, v125
    v_cvt_pk_bf16_f32 v237, v126, v127
    v_cvt_pk_bf16_f32 v238, v128, v129
    v_cvt_pk_bf16_f32 v239, v130, v131
    ds_write_b128 v32, v[236:239] offset:4096
    v_cvt_pk_bf16_f32 v240, v132, v133
    v_cvt_pk_bf16_f32 v241, v134, v135
    v_cvt_pk_bf16_f32 v242, v136, v137
    v_cvt_pk_bf16_f32 v243, v138, v139
    ds_write_b128 v32, v[240:243] offset:5120
    s_mov_b64 exec, -1
    s_waitcnt lgkmcnt(0)
    s_barrier
    ds_read_b128 v[84:87], v33 offset:4096
    ds_read_b128 v[88:91], v33 offset:5120
    s_waitcnt lgkmcnt(1)
    v_mfma_f32_16x16x32_bf16 v[228:231], v[84:87], a[192:195], v[228:231]
    v_mfma_f32_16x16x32_bf16 v[232:235], v[84:87], a[196:199], v[232:235]
    s_waitcnt lgkmcnt(0)
    v_mfma_f32_16x16x32_bf16 v[228:231], v[88:91], a[232:235], v[228:231]
    v_mfma_f32_16x16x32_bf16 v[232:235], v[88:91], a[236:239], v[232:235]
    v_mfma_f32_16x16x32_bf16 v[188:191], v[84:87], a[160:163], v[188:191]
    v_mfma_f32_16x16x32_bf16 v[192:195], v[84:87], a[164:167], v[192:195]
    v_mfma_f32_16x16x32_bf16 v[196:199], v[84:87], a[168:171], v[196:199]
    v_mfma_f32_16x16x32_bf16 v[200:203], v[84:87], a[172:175], v[200:203]
    s_nop 3
    v_permlane32_swap_b32 v228, v232
    v_permlane32_swap_b32 v229, v233
    v_permlane32_swap_b32 v230, v234
    v_mfma_f32_16x16x32_bf16 v[188:191], v[88:91], a[200:203], v[188:191]
    v_permlane32_swap_b32 v231, v235
    v_add_f32 v228, v228, v232
    v_add_f32 v229, v229, v233
    v_mfma_f32_16x16x32_bf16 v[192:195], v[88:91], a[204:207], v[192:195]
    v_add_f32 v230, v230, v234
    v_add_f32 v231, v231, v235
    s_nop 0
    v_permlane16_swap_b32 v228, v230
    v_mfma_f32_16x16x32_bf16 v[196:199], v[88:91], a[208:211], v[196:199]
    v_permlane16_swap_b32 v229, v231
    v_add_f32 v60, v228, v230
    v_add_f32 v61, v229, v231
    v_mfma_f32_16x16x32_bf16 v[200:203], v[88:91], a[212:215], v[200:203]
    v_add_u32 v60, 0x800, v60
    v_add_u32 v61, 0x800, v61
    v_and_or_b32 v60, v60, s1, v2
    v_mfma_f32_16x16x32_bf16 v[204:207], v[84:87], a[176:179], v[204:207]
    v_mfma_f32_16x16x32_bf16 v[208:211], v[84:87], a[180:183], v[208:211]
    v_mfma_f32_16x16x32_bf16 v[220:223], v[84:87], a[184:187], v[220:223]
    v_mfma_f32_16x16x32_bf16 v[224:227], v[84:87], a[188:191], v[224:227]
    v_and_or_b32 v61, v61, s1, v0
    buffer_store_dwordx2 v[60:61], v35, s[40:43], s4 offen sc1
    v_permlane32_swap_b32 v188, v196
    v_mfma_f32_16x16x32_bf16 v[204:207], v[88:91], a[216:219], v[204:207]
    v_permlane32_swap_b32 v192, v200
    v_permlane32_swap_b32 v189, v197
    v_permlane32_swap_b32 v193, v201
    v_mfma_f32_16x16x32_bf16 v[208:211], v[88:91], a[220:223], v[208:211]
    v_permlane32_swap_b32 v190, v198
    v_permlane32_swap_b32 v194, v202
    v_permlane32_swap_b32 v191, v199
    v_mfma_f32_16x16x32_bf16 v[220:223], v[88:91], a[224:227], v[220:223]
    v_permlane32_swap_b32 v195, v203
    v_add_f32 v188, v188, v196
    v_add_f32 v192, v192, v200
    v_mfma_f32_16x16x32_bf16 v[224:227], v[88:91], a[228:231], v[224:227]
    v_add_f32 v189, v189, v197
    v_add_f32 v193, v193, v201
    v_add_f32 v190, v190, v198
    v_add_f32 v194, v194, v202
    v_add_f32 v191, v191, v199
    v_add_f32 v195, v195, v203
    v_permlane16_swap_b32 v188, v192
    v_permlane16_swap_b32 v189, v193
    v_permlane16_swap_b32 v190, v194
    v_permlane16_swap_b32 v191, v195
    v_add_f32 v52, v188, v192
    v_add_f32 v53, v189, v193
    v_add_f32 v54, v190, v194
    v_add_f32 v55, v191, v195
    v_add_u32 v52, 0x800, v52
    v_add_u32 v53, 0x800, v53
    v_add_u32 v54, 0x800, v54
    v_add_u32 v55, 0x800, v55
    v_and_or_b32 v52, v52, s1, v2
    v_and_or_b32 v53, v53, s1, v3
    v_and_or_b32 v54, v54, s1, v2
    v_and_or_b32 v55, v55, s1, v4
    buffer_store_dwordx4 v[52:55], v34, s[40:43], 0 offen sc1
    v_permlane32_swap_b32 v204, v220
    v_permlane32_swap_b32 v208, v224
    v_permlane32_swap_b32 v205, v221
    v_permlane32_swap_b32 v209, v225
    v_permlane32_swap_b32 v206, v222
    v_permlane32_swap_b32 v210, v226
    v_permlane32_swap_b32 v207, v223
    v_permlane32_swap_b32 v211, v227
    v_add_f32 v204, v204, v220
    v_add_f32 v208, v208, v224
    v_add_f32 v205, v205, v221
    v_add_f32 v209, v209, v225
    v_add_f32 v206, v206, v222
    v_add_f32 v210, v210, v226
    v_add_f32 v207, v207, v223
    v_add_f32 v211, v211, v227
    v_permlane16_swap_b32 v204, v208
    v_permlane16_swap_b32 v205, v209
    v_permlane16_swap_b32 v206, v210
    v_permlane16_swap_b32 v207, v211
    v_add_f32 v56, v204, v208
    v_add_f32 v57, v205, v209
    v_add_f32 v58, v206, v210
    v_add_f32 v59, v207, v211
    v_add_u32 v56, 0x800, v56
    v_add_u32 v57, 0x800, v57
    v_add_u32 v58, 0x800, v58
    v_add_u32 v59, 0x800, v59
    v_and_or_b32 v56, v56, s1, v2
    v_and_or_b32 v57, v57, s1, v3
    v_and_or_b32 v58, v58, s1, v2
    v_and_or_b32 v59, v59, s1, v4
    buffer_store_dwordx4 v[56:59], v34, s[40:43], s71 offen sc1
    s_cmp_ge_u32 s53, 20
    s_cbranch_scc1 L_fin
    s_mov_b32 s61, 200000
    s_mov_b64 s[20:21], -1
    s_mov_b64 s[22:23], -1
    s_mov_b64 s[24:25], -1
    s_mov_b64 s[26:27], -1
L_poll:
    s_mov_b64 exec, s[20:21]
    s_cbranch_execz L_pl0
    buffer_load_dwordx4 v[92:95], v36, s[44:47], 0 offen sc1
L_pl0:
    s_mov_b64 exec, s[22:23]
    s_cbranch_execz L_pl1
    buffer_load_dwordx4 v[96:99], v36, s[44:47], s68 offen sc1
L_pl1:
    s_mov_b64 exec, s[24:25]
    s_cbranch_execz L_pl2
    buffer_load_dwordx4 v[100:103], v36, s[44:47], s69 offen sc1
L_pl2:
    s_mov_b64 exec, s[26:27]
    s_cbranch_execz L_pl3
    buffer_load_dwordx4 v[104:107], v36, s[44:47], s70 offen sc1
L_pl3:
    s_waitcnt vmcnt(0)
    s_mov_b64 exec, s[20:21]
    s_cbranch_execz L_pc0
    v_xor_b32 v92, v2, v92
    v_xor_b32 v93, v3, v93
    v_xor_b32 v94, v2, v94
    v_xor_b32 v95, v4, v95
    v_or3_b32 v40, v92, v93, v94
    v_or_b32 v40, v40, v95
    v_and_b32 v40, 0xfff, v40
    v_cmp_ne_u32 s[20:21], 0, v40
L_pc0:
    s_mov_b64 exec, s[22:23]
    s_cbranch_execz L_pc1
    v_xor_b32 v96, v2, v96
    v_xor_b32 v97, v3, v97
    v_xor_b32 v98, v2, v98
    v_xor_b32 v99, v4, v99
    v_or3_b32 v40, v96, v97, v98
    v_or_b32 v40, v40, v99
    v_and_b32 v40, 0xfff, v40
    v_cmp_ne_u32 s[22:23], 0, v40
L_pc1:
    s_mov_b64 exec, s[24:25]
    s_cbranch_execz L_pc2
    v_xor_b32 v100, v2, v100
    v_xor_b32 v101, v3, v101
    v_xor_b32 v102, v2, v102
    v_xor_b32 v103, v4, v103
    v_or3_b32 v40, v100, v101, v102
    v_or_b32 v40, v40, v103
    v_and_b32 v40, 0xfff, v40
    v_cmp_ne_u32 s[24:25], 0, v40
L_pc2:
    s_mov_b64 exec, s[26:27]
    s_cbranch_execz L_pc3
    v_xor_b32 v104, v2, v104
    v_xor_b32 v105, v3, v105
    v_xor_b32 v106, v2, v106
    v_xor_b32 v107, v4, v107
    v_or3_b32 v40, v104, v105, v106
    v_or_b32 v40, v40, v107
    v_and_b32 v40, 0xfff, v40
    v_cmp_ne_u32 s[26:27], 0, v40
L_pc3:
    s_mov_b64 exec, -1
    s_or_b64 s[28:29], s[20:21], s[22:23]
    s_nop 1
    s_or_b64 s[30:31], s[24:25], s[26:27]
    s_or_b64 s[28:29], s[28:29], s[30:31]
    s_cbranch_scc0 L_sum
    s_sub_u32 s61, s61, 1
    s_cbranch_scc0 L_poll
L_sum:
    v_add_f32 v92, v92, v96
    v_add_f32 v100, v100, v104
    v_add_f32 v93, v93, v97
    v_add_f32 v101, v101, v105
    v_add_f32 v94, v94, v98
    v_add_f32 v102, v102, v106
    v_add_f32 v95, v95, v99
    v_add_f32 v103, v103, v107
    v_add_f32 v92, v92, v100
    v_add_f32 v93, v93, v101
    v_add_f32 v94, v94, v102
    v_add_f32 v95, v95, v103
    s_nop 0
    v_permlane32_swap_b32 v92, v94
    v_permlane32_swap_b32 v93, v95
    v_add_f32 v92, v92, v94
    v_add_f32 v93, v93, v95
    s_nop 1
    v_permlane16_swap_b32 v92, v93
    v_add_f32 v92, v92, v93
    s_nop 1
    v_add_f32_dpp v92, v92, v92 row_ror:8 row_mask:0xf bank_mask:0xf
    s_nop 1
    v_mov_b32_dpp v93, v92 quad_perm:[1,0,3,2] row_mask:0xf bank_mask:0xf
    v_cvt_pk_bf16_f32 v92, v92, v93
    s_mov_b64 exec, s[66:67]
    buffer_store_dword v92, v37, s[48:51], 0 offen
    s_or_b32 s58, s53, s52
    s_cbranch_scc1 L_fin
    s_mov_b64 exec, 1
    global_store_dword v38, v39, s[18:19]
L_fin:
L_end:
    s_endpgm
.section .rodata,"a"
.p2align 6
.amdhsa_kernel standalone__sliding_block_cached__sampling_kernel
  .amdhsa_next_free_vgpr 512
  .amdhsa_next_free_sgpr 102
  .amdhsa_accum_offset 256
  .amdhsa_group_segment_fixed_size 0
  .amdhsa_kernarg_size 64
  .amdhsa_user_sgpr_count 2
  .amdhsa_user_sgpr_kernarg_segment_ptr 1
  .amdhsa_system_sgpr_workgroup_id_x 1
  .amdhsa_float_denorm_mode_32 3
.end_amdhsa_kernel
```
